```python
import torch

def _softmax(x, axis=-1):
    return torch.softmax(x, dim=axis)

def _gelu(x):
    return torch.nn.functional.gelu(x, approximate='tanh')

def _silu(x):
    return torch.nn.functional.silu(x)

def _sigmoid(x):
    return torch.sigmoid(x)

def _layernorm(x, axis=-1, eps=1e-05):
    m = x.mean(dim=axis, keepdim=True)
    v = x.var(dim=axis, keepdim=True, unbiased=False)
    return (x - m) / torch.sqrt(v + eps)

def _scatter_add(tgt, idx, src, axis=0):
    return tgt.clone().index_add_(axis, idx, src)

def _segment_sum(src, seg, n):
    out = torch.zeros((n,) + src.shape[1:], dtype=src.dtype)
    return out.index_add_(0, seg, src)

def _pad(x, pw):
    flat = tuple((v for pair in reversed(pw) for v in pair))
    return torch.nn.functional.pad(x, flat)
kernel_name = 'sequential_preLN__memory_aug_recurrent_mem_tr__mixer_s_mlp__prompt'

def setup_inputs():

    _w = lambda a: (lambda t: t.to(torch.bfloat16) if t.is_floating_point() else t)(torch.as_tensor(a))

    def _A_setup():
        B, S, Dm = (1, 2048, 576)
        H, Dh = (32, 128)
        M, seg = (8, 32)
        seg = min(seg, S)
        S = S // seg * seg
        return {'x': _w((lambda *s: torch.randn(*s, dtype=torch.bfloat16) * 0.05)(B, S, Dm)), 'mem0': _w((lambda *s: torch.randn(*s, dtype=torch.bfloat16) * 0.2)(B, M, Dm)), 'Wq': _w((lambda *s: torch.randn(*s, dtype=torch.bfloat16) * 1.6)(Dm, H, Dh) * Dm ** (-0.5)), 'Wk': _w((lambda *s: torch.randn(*s, dtype=torch.bfloat16) * 1.6)(Dm, H, Dh) * Dm ** (-0.5)), 'Wv': _w((lambda *s: torch.randn(*s, dtype=torch.bfloat16) * 0.2)(Dm, H, Dh) * Dm ** (-0.5)), 'Wo': _w((lambda *s: torch.randn(*s, dtype=torch.bfloat16) * 0.2)(H, Dh, Dm) * (H * Dh) ** (-0.5)), 'seg_len': seg}
    _A_in = _A_setup()

    def _B_setup():
        B, S, D, F = (1, 2048, 576, 4608)
        return {'x': _w((lambda *s: torch.randn(*s, dtype=torch.bfloat16) * 0.05)(B, S, D)), 'w1': _w((lambda *s: torch.randn(*s, dtype=torch.bfloat16) * 0.8)(D, D) * D ** (-0.5)), 'w2': _w((lambda *s: torch.randn(*s, dtype=torch.bfloat16) * 0.8)(D, D) * D ** (-0.5)), 'w3': _w((lambda *s: torch.randn(*s, dtype=torch.bfloat16) * 0.8)(D, F) * D ** (-0.5)), 'w4': _w((lambda *s: torch.randn(*s, dtype=torch.bfloat16) * 0.8)(F, D) * F ** (-0.5))}
    _B_in = _B_setup()
    return {'A_x': _A_in['x'], 'A_mem0': _A_in['mem0'], 'A_Wq': _A_in['Wq'], 'A_Wk': _A_in['Wk'], 'A_Wv': _A_in['Wv'], 'A_Wo': _A_in['Wo'], 'A_seg_len': _A_in['seg_len'], 'B_x': _B_in['x'], 'B_w1': _B_in['w1'], 'B_w2': _B_in['w2'], 'B_w3': _B_in['w3'], 'B_w4': _B_in['w4']}

def reference(A_x, A_mem0, A_Wq, A_Wk, A_Wv, A_Wo, A_seg_len, B_x, B_w1, B_w2, B_w3, B_w4):

    def _A_ref(x, mem0, Wq, Wk, Wv, Wo, seg_len):
        B, S, Dm = x.shape
        H, Dh = (Wq.shape[1], Wq.shape[2])
        M = mem0.shape[1]
        scale = Dh ** (-0.5)
        n_seg = S // seg_len
        L = M + seg_len
        idx = torch.arange(L)
        mask = (idx[:, None] < M) | (idx[:, None] >= idx[None, :])
        mem = mem0
        outs = []
        for s in range(n_seg):
            xs = x[:, s * seg_len:(s + 1) * seg_len, :].clone()
            h = torch.concatenate([mem, xs], axis=1)
            q = torch.einsum('btd,dhe->bhte', h, Wq)
            k = torch.einsum('btd,dhe->bhte', h, Wk)
            v = torch.einsum('btd,dhe->bhte', h, Wv)
            scores = torch.einsum('bhqe,bhke->bhqk', q, k) * scale
            scores = torch.where(mask[None, None], scores, -1000000000.0)
            p = _softmax(scores, axis=-1)
            o = torch.einsum('bhqk,bhke->bhqe', p, v)
            o = torch.einsum('bhte,hed->btd', o, Wo)
            mem = o[:, :M, :].clone()
            outs.append(o[:, M:, :])
        return torch.concatenate(outs, axis=1)

    def _B_ref(x, w1, w2, w3, w4):
        B, S, D = x.shape
        h = _gelu(_layernorm(x, axis=-1) @ w1)
        c = D // 4
        g0 = _pad(h[:, :, 0 * c:1 * c], ((0, 0), (1, 0), (0, 0)))[:, :S, :]
        g1 = _pad(h[:, :, 1 * c:2 * c], ((0, 0), (0, 1), (0, 0)))[:, 1:, :]
        g2 = _pad(h[:, :, 2 * c:3 * c], ((0, 0), (2, 0), (0, 0)))[:, :S, :]
        g3 = _pad(h[:, :, 3 * c:], ((0, 0), (0, 2), (0, 0)))[:, 2:, :]
        hs = torch.concatenate([g0, g1, g2, g3], axis=-1) @ w2
        x1 = x + hs
        h2 = _gelu(_layernorm(x1, axis=-1) @ w3) @ w4
        return x1 + h2
    x = A_x
    h = x + _A_ref(_layernorm(x, axis=-1), A_mem0, A_Wq, A_Wk, A_Wv, A_Wo, A_seg_len)
    h2 = h + _B_ref(_layernorm(h, axis=-1), B_w1, B_w2, B_w3, B_w4)
    return h2
```

```asm
; @launch grid=(256,1,1) block=(256,1,1) lds=163840
.amdgcn_target "amdgcn-amd-amdhsa--gfx950"
.text
.globl sequential_preLN__memory_aug_recurrent_mem_tr__mixer_s_mlp__prompt_kernel
.p2align 8
.type sequential_preLN__memory_aug_recurrent_mem_tr__mixer_s_mlp__prompt_kernel,@function
sequential_preLN__memory_aug_recurrent_mem_tr__mixer_s_mlp__prompt_kernel:
    s_cmp_ge_u32 s2, 256
    s_cbranch_scc1 L_exit
    s_load_dwordx2 s[16:17], s[0:1], 104
    s_getreg_b32 s78, hwreg(HW_REG_XCC_ID)
    s_and_b32 s78, s78, 7
    s_waitcnt lgkmcnt(0)
    s_and_b32 s17, s17, 0xffff
    s_mov_b32 s18, 256
    s_mov_b32 s19, 0x20000
    v_cmp_eq_u32 vcc, 0, v0
    s_and_saveexec_b64 s[20:21], vcc
    s_cbranch_execz main_tk_skip
    v_mov_b32 v1, 1
    s_lshl_b32 s22, s78, 2
    s_cmp_eq_u32 s78, 0
    s_cselect_b32 s23, 128, 0
    s_add_u32 s22, s22, s23
    s_cmp_eq_u32 s78, 2
    s_cselect_b32 s23, 128, 0
    s_add_u32 s22, s22, s23
    v_mov_b32 v2, s22
    buffer_atomic_add v1, v2, s[16:19], 0 offen sc0
    s_waitcnt vmcnt(0)
    v_mov_b32 v2, 0
    ds_write_b32 v2, v1
    s_waitcnt lgkmcnt(0)
main_tk_skip:
    s_mov_b64 exec, s[20:21]
    s_barrier
    v_mov_b32 v2, 0
    ds_read_b32 v1, v2
    s_waitcnt lgkmcnt(0)
    v_readfirstlane_b32 s79, v1
    s_barrier
    s_cmp_ge_u32 s79, 32
    s_cbranch_scc1 L_exit
    s_load_dwordx2 s[8:9], s[0:1], 112
    s_waitcnt lgkmcnt(0)
    s_and_b32 s9, s9, 0xffff
    s_mov_b32 s10, 268435456
    s_mov_b32 s11, 0x20000
    v_lshrrev_b32 v2, 6, v0
    s_nop 0
    v_readfirstlane_b32 s22, v2
    s_lshl_b32 s80, s79, 7
    s_lshl_b32 s89, s78, 5
    s_add_u32 s89, s89, s79
    s_mov_b32 s88, 100
    s_mov_b32 s82, 0
    s_cmp_eq_u32 s78, 0
    s_cbranch_scc1 L_rec_in
    s_mov_b32 s82, 0
    s_cmp_eq_u32 s78, 1
    s_cbranch_scc1 L_att_in
    s_mov_b32 s82, 0
    s_cmp_eq_u32 s78, 2
    s_cbranch_scc1 L_kv_in
    s_mov_b32 s82, 1
    s_cmp_eq_u32 s78, 3
    s_cbranch_scc1 L_att_in
    s_mov_b32 s82, 2
    s_cmp_eq_u32 s78, 4
    s_cbranch_scc1 L_att_in
    s_mov_b32 s82, 0
    s_cmp_eq_u32 s78, 5
    s_cbranch_scc1 L_mlp_in
    s_mov_b32 s82, 1
    s_cmp_eq_u32 s78, 6
    s_cbranch_scc1 L_mlp_in
    s_mov_b32 s82, 2
    s_cmp_eq_u32 s78, 7
    s_cbranch_scc1 L_mlp_in
    s_branch L_exit
L_mlp_in:
    s_cmp_lt_u32 s79, 24
    s_cbranch_scc1 L_mlp
    s_branch L_small
L_rec_in:
    s_load_dwordx2 s[4:5], s[0:1], 8
    s_load_dwordx2 s[40:41], s[0:1], 16
    s_load_dwordx2 s[42:43], s[0:1], 24
    s_load_dwordx2 s[44:45], s[0:1], 32
    s_load_dwordx2 s[46:47], s[0:1], 40
    s_waitcnt lgkmcnt(0)
    s_and_b32 s5, s5, 0xffff
    s_mov_b32 s6, 9216
    s_mov_b32 s7, 0x20000
    s_mov_b32 s49, s79
    s_add_u32 s81, s80, 73412608
    v_mov_b32 v1, 0
    v_mov_b32 v2, 0
    buffer_store_dword v1, v2, s[8:11], s81 offen sc1
    v_and_b32 v14, 63, v0
    v_lshrrev_b32 v15, 6, v0
    v_lshrrev_b32 v16, 4, v14
    v_and_b32 v17, 15, v14
    v_lshrrev_b32 v18, 2, v17
    v_and_b32 v19, 3, v14
    v_bfe_u32 v20, v17, 1, 1
    v_and_b32 v21, 1, v17
    v_lshlrev_b32 v1, 4, v14
    v_lshlrev_b32 v2, 4, v0
    v_lshl_add_u32 v3, v15, 11, v1
    v_mov_b32 v4, 0x4444
    v_mov_b32 v24, 0xeeee
    v_cmp_ne_u32 vcc, 0, v20
    s_nop 1
    v_cndmask_b32 v4, v4, v24, vcc
    v_lshl_add_u32 v23, v15, 5, v17
    v_mul_u32_u24 v23, 40, v23
    v_lshl_add_u32 v23, v16, 3, v23
    v_add_u32 v5, 9216, v23
    v_lshl_add_u32 v23, v16, 3, v18
    v_mul_u32_u24 v23, 40, v23
    v_lshl_add_u32 v6, v19, 3, v23
    v_mul_u32_u24 v23, 1280, v15
    v_add_u32 v13, v23, v6
    v_and_b32 v22, 7, v17
    v_lshlrev_b32 v23, 9, v15
    v_lshl_add_u32 v23, v22, 5, v23
    v_lshl_add_u32 v23, v16, 3, v23
    v_lshrrev_b32 v24, 3, v17
    v_lshl_add_u32 v23, v24, 2, v23
    v_add_u32 v7, 19456, v23
    v_lshl_add_u32 v22, v18, 1, v21
    v_lshl_add_u32 v23, v16, 3, v22
    v_lshlrev_b32 v23, 4, v23
    v_mul_u32_u24 v24, 1152, v15
    v_add_u32 v24, v24, v23
    v_add_u32 v8, 19456, v24
    v_mul_u32_u24 v24, 1152, v20
    v_add_u32 v24, v24, v23
    v_add_u32 v9, 19456, v24
    s_lshr_b32 s62, s49, 3
    s_lshr_b32 s63, s49, 1
    s_and_b32 s63, s63, 3
    s_and_b32 s67, s49, 1
    s_lshl_b32 s69, s62, 6
    s_lshl_b32 s61, s63, 4
    s_add_u32 s69, s69, s61
    s_lshl_b32 s61, s67, 3
    s_add_u32 s69, s69, s61
    s_mul_i32 s27, s69, 12
    s_mul_i32 s61, s22, 3072
    s_add_u32 s27, s27, s61
    v_add_u32 v23, s69, v22
    v_mul_u32_u24 v23, 12, v23
    v_lshl_add_u32 v24, v16, 1, v20
    v_mul_u32_u24 v24, 9216, v24
    v_add_u32 v23, v23, v24
    s_mul_i32 s69, s22, 3072
    s_cmp_eq_u32 s22, 3
    s_cselect_b32 s69, 0x7fff0000, s69
    v_add_u32 v10, s69, v23
    s_lshl_b32 s69, s62, 4
    s_lshl_b32 s61, s63, 2
    s_add_u32 s69, s69, s61
    s_lshl_b32 s61, s67, 1
    s_add_u32 s69, s69, s61
    v_add_u32 v23, s69, v21
    v_lshlrev_b32 v23, 4, v23
    v_lshl_add_u32 v23, v16, 2, v23
    v_lshrrev_b32 v24, 1, v17
    v_lshl_add_u32 v23, v24, 10, v23
    s_mul_i32 s69, s22, 3072
    s_cmp_eq_u32 s22, 3
    s_cselect_b32 s69, 0x7fff0000, s69
    v_add_u32 v11, s69, v23
    v_mov_b32 v24, 0x7fff0000
    v_cmp_gt_u32 vcc, 6, v17
    s_nop 1
    v_cndmask_b32 v11, v24, v11, vcc
    v_lshlrev_b32 v23, 7, v17
    v_lshl_add_u32 v23, v15, 11, v23
    v_and_b32 v24, 1, v16
    v_mul_u32_u24 v24, 1048576, v24
    v_lshl_add_u32 v12, v24, 4, v23
    s_lshl_b32 s62, s49, 13
    s_add_u32 s56, s62, 20971520
    s_lshl_b32 s62, s49, 12
    s_add_u32 s57, s62, 54525952
    s_mul_i32 s62, s49, 9216
    s_add_u32 s65, s62, 71303168
    s_lshl_b32 s62, s49, 7
    s_add_u32 s64, s62, 73400320
    s_mov_b32 s50, 0
    s_mov_b32 s58, 0
    s_mov_b32 s66, 0
    s_mov_b32 s51, 72351744
    s_mov_b32 s52, 72360960
    s_mov_b32 s54, 0
    s_mov_b32 s76, 72379392
    s_mov_b32 s77, 589824
    s_lshl_b32 s70, s22, 10
    s_mov_b32 s72, 0x3e0293ee
    s_mov_b32 s73, 0x3e0293ee
    s_mov_b32 s98, 0x3f803f80
    s_mov_b32 s99, 0x3f803f80
    s_mov_b32 s100, 0x3f003f00
    s_mov_b32 s101, 0x3f003f00
    s_cmp_eq_u32 s22, 3
    s_cbranch_scc1 rec_noreset
    v_mov_b32 v16, -1
    v_mov_b32 v17, -1
    v_mov_b32 v18, -1
    v_mov_b32 v19, -1
    s_mov_b32 s62, 71303168
    buffer_store_dwordx3 v[16:18], v10, s[8:11], s62 offen
    s_mov_b32 s62, 71376896
    buffer_store_dwordx3 v[16:18], v10, s[8:11], s62 offen
    s_mov_b32 s62, 71450624
    buffer_store_dwordx3 v[16:18], v10, s[8:11], s62 offen
    s_mov_b32 s62, 71524352
    buffer_store_dwordx3 v[16:18], v10, s[8:11], s62 offen
    s_mov_b32 s62, 71598080
    buffer_store_dwordx3 v[16:18], v10, s[8:11], s62 offen
    s_mov_b32 s62, 71671808
    buffer_store_dwordx3 v[16:18], v10, s[8:11], s62 offen
    s_mov_b32 s62, 71745536
    buffer_store_dwordx3 v[16:18], v10, s[8:11], s62 offen
    s_mov_b32 s62, 71819264
    buffer_store_dwordx3 v[16:18], v10, s[8:11], s62 offen
    s_mov_b32 s62, 71892992
    buffer_store_dwordx3 v[16:18], v10, s[8:11], s62 offen
    s_mov_b32 s62, 71966720
    buffer_store_dwordx3 v[16:18], v10, s[8:11], s62 offen
    s_mov_b32 s62, 72040448
    buffer_store_dwordx3 v[16:18], v10, s[8:11], s62 offen
    s_mov_b32 s62, 72114176
    buffer_store_dwordx3 v[16:18], v10, s[8:11], s62 offen
    s_mov_b32 s62, 72351744
    buffer_store_dword v16, v11, s[8:11], s62 offen
    s_mov_b32 s62, 72360960
    buffer_store_dword v16, v11, s[8:11], s62 offen
    s_mov_b32 s62, 72370176
    buffer_store_dword v16, v11, s[8:11], s62 offen
    s_mov_b32 s62, 72379392
    buffer_store_dword v16, v11, s[8:11], s62 offen
rec_noreset:
    s_waitcnt vmcnt(0)
    s_waitcnt vmcnt(0)
    s_barrier
    v_cmp_eq_u32 vcc, 0, v0
    s_and_saveexec_b64 s[20:21], vcc
    s_cbranch_execz rec_arr
    v_mov_b32 v1, 1
    v_mov_b32 v2, 192
    buffer_atomic_add v1, v2, s[16:19], 0 offen
rec_arr:
    s_mov_b64 exec, s[20:21]
    v_and_b32 v1, 63, v0
    v_lshrrev_b32 v2, 6, v0
    v_lshrrev_b32 v3, 4, v1
    v_and_b32 v4, 15, v1
    v_lshl_add_u32 v5, v2, 2, v3
    v_and_b32 v6, 12, v5
    v_and_b32 v7, 1, v5
    v_lshl_or_b32 v6, v7, 1, v6
    v_xor_b32 v6, v4, v6
    v_lshlrev_b32 v5, 13, v5
    v_lshl_add_u32 v5, v6, 4, v5
    s_lshl_b32 s23, s49, 8
    v_add_u32 v5, s23, v5
    v_lshrrev_b32 v6, 3, v1
    v_lshl_add_u32 v6, v2, 3, v6
    v_lshrrev_b32 v7, 2, v6
    v_and_b32 v7, 3, v7
    v_lshlrev_b32 v7, 1, v7
    v_and_b32 v8, 7, v1
    v_xor_b32 v7, v8, v7
    v_mul_u32_u24 v6, 1152, v6
    v_lshl_add_u32 v6, v7, 4, v6
    s_mul_i32 s23, s49, 147456
    v_add_u32 v6, s23, v6
    v_lshrrev_b32 v8, 2, v4
    v_and_b32 v9, 3, v1
    v_and_b32 v11, 1, v3
    v_lshrrev_b32 v10, 1, v3
    v_lshlrev_b32 v10, 4, v10
    v_lshl_add_u32 v10, v11, 2, v10
    v_and_b32 v12, 1, v8
    v_add_u32 v10, v10, v12
    v_lshrrev_b32 v12, 1, v8
    v_lshl_add_u32 v10, v12, 3, v10
    v_and_b32 v12, 12, v10
    v_and_b32 v13, 1, v10
    v_lshl_or_b32 v12, v13, 1, v12
    v_lshrrev_b32 v13, 1, v9
    v_lshl_add_u32 v13, v2, 2, v13
    v_xor_b32 v12, v12, v13
    v_lshlrev_b32 v7, 8, v10
    v_lshl_add_u32 v7, v12, 4, v7
    v_and_b32 v13, 1, v9
    v_lshl_add_u32 v7, v13, 3, v7
    v_mov_b32 v11, v7
    v_add_u32 v7, 114688, v7
    v_xor_b32 v14, 32, v7
    v_lshrrev_b32 v12, 2, v10
    v_and_b32 v12, 3, v12
    v_lshlrev_b32 v12, 1, v12
    v_lshrrev_b32 v13, 1, v9
    v_lshl_add_u32 v13, v2, 1, v13
    v_xor_b32 v12, v12, v13
    v_lshlrev_b32 v15, 7, v10
    v_lshl_add_u32 v15, v12, 4, v15
    v_and_b32 v13, 1, v9
    v_lshl_add_u32 v15, v13, 3, v15
    v_mov_b32 v10, v15
    v_add_u32 v15, 114688, v15
    v_xor_b32 v12, 32, v11
    v_lshlrev_b32 v3, 4, v1
    v_lshl_add_u32 v3, v2, 11, v3
    s_lshl_b32 s24, s22, 10
    s_mov_b32 s14, 4718592
    s_mov_b32 s15, 0x20000
    s_mov_b32 s12, s40
    s_and_b32 s13, s41, 0xffff
    s_add_u32 m0, s24, 0
    s_mov_b32 s25, 0
    buffer_load_dwordx4 v5, s[12:15], s25 offen nt lds
    s_add_u32 m0, s24, 4096
    s_mov_b32 s25, 131072
    buffer_load_dwordx4 v5, s[12:15], s25 offen nt lds
    s_add_u32 m0, s24, 8192
    s_mov_b32 s25, 262144
    buffer_load_dwordx4 v5, s[12:15], s25 offen nt lds
    s_add_u32 m0, s24, 12288
    s_mov_b32 s25, 393216
    buffer_load_dwordx4 v5, s[12:15], s25 offen nt lds
    s_add_u32 m0, s24, 114688
    s_mov_b32 s25, 524288
    buffer_load_dwordx4 v5, s[12:15], s25 offen nt lds
    s_add_u32 m0, s24, 118784
    s_mov_b32 s25, 655360
    buffer_load_dwordx4 v5, s[12:15], s25 offen nt lds
    s_add_u32 m0, s24, 122880
    s_mov_b32 s25, 786432
    buffer_load_dwordx4 v5, s[12:15], s25 offen nt lds
    s_add_u32 m0, s24, 126976
    s_mov_b32 s25, 917504
    buffer_load_dwordx4 v5, s[12:15], s25 offen nt lds
    s_add_u32 m0, s24, 131072
    s_mov_b32 s25, 1048576
    buffer_load_dwordx4 v5, s[12:15], s25 offen nt lds
    s_add_u32 m0, s24, 135168
    s_mov_b32 s25, 1179648
    buffer_load_dwordx4 v5, s[12:15], s25 offen nt lds
    s_add_u32 m0, s24, 139264
    s_mov_b32 s25, 1310720
    buffer_load_dwordx4 v5, s[12:15], s25 offen nt lds
    s_add_u32 m0, s24, 143360
    s_mov_b32 s25, 1441792
    buffer_load_dwordx4 v5, s[12:15], s25 offen nt lds
    s_waitcnt vmcnt(8)
    s_barrier
    s_add_u32 m0, s24, 147456
    s_mov_b32 s25, 1572864
    buffer_load_dwordx4 v5, s[12:15], s25 offen nt lds
    s_add_u32 m0, s24, 151552
    s_mov_b32 s25, 1703936
    buffer_load_dwordx4 v5, s[12:15], s25 offen nt lds
    s_add_u32 m0, s24, 155648
    s_mov_b32 s25, 1835008
    buffer_load_dwordx4 v5, s[12:15], s25 offen nt lds
    s_add_u32 m0, s24, 159744
    s_mov_b32 s25, 1966080
    buffer_load_dwordx4 v5, s[12:15], s25 offen nt lds
    ds_read_b64_tr_b16 a[0:1], v11 offset:0
    ds_read_b64_tr_b16 a[2:3], v11 offset:512
    ds_read_b64_tr_b16 a[4:5], v11 offset:8192
    ds_read_b64_tr_b16 a[6:7], v11 offset:8704
    ds_read_b64_tr_b16 a[8:9], v12 offset:0
    ds_read_b64_tr_b16 a[10:11], v12 offset:512
    ds_read_b64_tr_b16 a[12:13], v12 offset:8192
    ds_read_b64_tr_b16 a[14:15], v12 offset:8704
    s_waitcnt lgkmcnt(0)
    s_waitcnt vmcnt(8)
    s_barrier
    s_add_u32 m0, s24, 0
    s_mov_b32 s25, 2097152
    buffer_load_dwordx4 v5, s[12:15], s25 offen nt lds
    s_add_u32 m0, s24, 4096
    s_mov_b32 s25, 2228224
    buffer_load_dwordx4 v5, s[12:15], s25 offen nt lds
    s_add_u32 m0, s24, 8192
    s_mov_b32 s25, 2359296
    buffer_load_dwordx4 v5, s[12:15], s25 offen nt lds
    s_add_u32 m0, s24, 12288
    s_mov_b32 s25, 2490368
    buffer_load_dwordx4 v5, s[12:15], s25 offen nt lds
    ds_read_b64_tr_b16 a[16:17], v7 offset:0
    ds_read_b64_tr_b16 a[18:19], v7 offset:512
    ds_read_b64_tr_b16 a[20:21], v7 offset:8192
    ds_read_b64_tr_b16 a[22:23], v7 offset:8704
    ds_read_b64_tr_b16 v[64:65], v14 offset:0
    ds_read_b64_tr_b16 v[66:67], v14 offset:512
    ds_read_b64_tr_b16 v[68:69], v14 offset:8192
    ds_read_b64_tr_b16 v[70:71], v14 offset:8704
    s_waitcnt lgkmcnt(0)
    ds_write_b128 v3, v[64:67] offset:24576
    ds_write_b128 v3, v[68:71] offset:25600
    s_waitcnt lgkmcnt(0)
    s_waitcnt vmcnt(8)
    s_barrier
    s_add_u32 m0, s24, 114688
    s_mov_b32 s25, 2621440
    buffer_load_dwordx4 v5, s[12:15], s25 offen nt lds
    s_add_u32 m0, s24, 118784
    s_mov_b32 s25, 2752512
    buffer_load_dwordx4 v5, s[12:15], s25 offen nt lds
    s_add_u32 m0, s24, 122880
    s_mov_b32 s25, 2883584
    buffer_load_dwordx4 v5, s[12:15], s25 offen nt lds
    s_add_u32 m0, s24, 126976
    s_mov_b32 s25, 3014656
    buffer_load_dwordx4 v5, s[12:15], s25 offen nt lds
    ds_read_b64_tr_b16 a[24:25], v7 offset:16384
    ds_read_b64_tr_b16 a[26:27], v7 offset:16896
    ds_read_b64_tr_b16 a[28:29], v7 offset:24576
    ds_read_b64_tr_b16 a[30:31], v7 offset:25088
    ds_read_b64_tr_b16 v[64:65], v14 offset:16384
    ds_read_b64_tr_b16 v[66:67], v14 offset:16896
    ds_read_b64_tr_b16 v[68:69], v14 offset:24576
    ds_read_b64_tr_b16 v[70:71], v14 offset:25088
    s_waitcnt lgkmcnt(0)
    ds_write_b128 v3, v[64:67] offset:32768
    ds_write_b128 v3, v[68:71] offset:33792
    s_waitcnt lgkmcnt(0)
    s_waitcnt vmcnt(8)
    s_barrier
    s_add_u32 m0, s24, 131072
    s_mov_b32 s25, 3145728
    buffer_load_dwordx4 v5, s[12:15], s25 offen nt lds
    s_add_u32 m0, s24, 135168
    s_mov_b32 s25, 3276800
    buffer_load_dwordx4 v5, s[12:15], s25 offen nt lds
    s_add_u32 m0, s24, 139264
    s_mov_b32 s25, 3407872
    buffer_load_dwordx4 v5, s[12:15], s25 offen nt lds
    s_add_u32 m0, s24, 143360
    s_mov_b32 s25, 3538944
    buffer_load_dwordx4 v5, s[12:15], s25 offen nt lds
    ds_read_b64_tr_b16 a[32:33], v7 offset:32768
    ds_read_b64_tr_b16 a[34:35], v7 offset:33280
    ds_read_b64_tr_b16 a[36:37], v7 offset:40960
    ds_read_b64_tr_b16 a[38:39], v7 offset:41472
    ds_read_b64_tr_b16 v[64:65], v14 offset:32768
    ds_read_b64_tr_b16 v[66:67], v14 offset:33280
    ds_read_b64_tr_b16 v[68:69], v14 offset:40960
    ds_read_b64_tr_b16 v[70:71], v14 offset:41472
    s_waitcnt lgkmcnt(0)
    ds_write_b128 v3, v[64:67] offset:40960
    ds_write_b128 v3, v[68:71] offset:41984
    s_waitcnt lgkmcnt(0)
    s_waitcnt vmcnt(8)
    s_barrier
    s_add_u32 m0, s24, 147456
    s_mov_b32 s25, 3670016
    buffer_load_dwordx4 v5, s[12:15], s25 offen nt lds
    s_add_u32 m0, s24, 151552
    s_mov_b32 s25, 3801088
    buffer_load_dwordx4 v5, s[12:15], s25 offen nt lds
    s_add_u32 m0, s24, 155648
    s_mov_b32 s25, 3932160
    buffer_load_dwordx4 v5, s[12:15], s25 offen nt lds
    s_add_u32 m0, s24, 159744
    s_mov_b32 s25, 4063232
    buffer_load_dwordx4 v5, s[12:15], s25 offen nt lds
    ds_read_b64_tr_b16 a[40:41], v11 offset:0
    ds_read_b64_tr_b16 a[42:43], v11 offset:512
    ds_read_b64_tr_b16 a[44:45], v11 offset:8192
    ds_read_b64_tr_b16 a[46:47], v11 offset:8704
    ds_read_b64_tr_b16 v[64:65], v12 offset:0
    ds_read_b64_tr_b16 v[66:67], v12 offset:512
    ds_read_b64_tr_b16 v[68:69], v12 offset:8192
    ds_read_b64_tr_b16 v[70:71], v12 offset:8704
    s_waitcnt lgkmcnt(0)
    ds_write_b128 v3, v[64:67] offset:49152
    ds_write_b128 v3, v[68:71] offset:50176
    s_waitcnt lgkmcnt(0)
    s_waitcnt vmcnt(8)
    s_barrier
    s_add_u32 m0, s24, 0
    s_mov_b32 s25, 4194304
    buffer_load_dwordx4 v5, s[12:15], s25 offen nt lds
    s_add_u32 m0, s24, 4096
    s_mov_b32 s25, 4325376
    buffer_load_dwordx4 v5, s[12:15], s25 offen nt lds
    s_add_u32 m0, s24, 8192
    s_mov_b32 s25, 4456448
    buffer_load_dwordx4 v5, s[12:15], s25 offen nt lds
    s_add_u32 m0, s24, 12288
    s_mov_b32 s25, 4587520
    buffer_load_dwordx4 v5, s[12:15], s25 offen nt lds
    ds_read_b64_tr_b16 a[48:49], v7 offset:0
    ds_read_b64_tr_b16 a[50:51], v7 offset:512
    ds_read_b64_tr_b16 a[52:53], v7 offset:8192
    ds_read_b64_tr_b16 a[54:55], v7 offset:8704
    ds_read_b64_tr_b16 v[64:65], v14 offset:0
    ds_read_b64_tr_b16 v[66:67], v14 offset:512
    ds_read_b64_tr_b16 v[68:69], v14 offset:8192
    ds_read_b64_tr_b16 v[70:71], v14 offset:8704
    s_waitcnt lgkmcnt(0)
    ds_write_b128 v3, v[64:67] offset:57344
    ds_write_b128 v3, v[68:71] offset:58368
    s_waitcnt lgkmcnt(0)
    s_waitcnt vmcnt(8)
    s_barrier
    s_mov_b32 s12, s42
    s_and_b32 s13, s43, 0xffff
    s_add_u32 m0, s24, 114688
    s_mov_b32 s25, 0
    buffer_load_dwordx4 v5, s[12:15], s25 offen nt lds
    s_add_u32 m0, s24, 118784
    s_mov_b32 s25, 131072
    buffer_load_dwordx4 v5, s[12:15], s25 offen nt lds
    s_add_u32 m0, s24, 122880
    s_mov_b32 s25, 262144
    buffer_load_dwordx4 v5, s[12:15], s25 offen nt lds
    s_add_u32 m0, s24, 126976
    s_mov_b32 s25, 393216
    buffer_load_dwordx4 v5, s[12:15], s25 offen nt lds
    ds_read_b64_tr_b16 a[56:57], v7 offset:16384
    ds_read_b64_tr_b16 a[58:59], v7 offset:16896
    ds_read_b64_tr_b16 a[60:61], v7 offset:24576
    ds_read_b64_tr_b16 a[62:63], v7 offset:25088
    ds_read_b64_tr_b16 v[64:65], v14 offset:16384
    ds_read_b64_tr_b16 v[66:67], v14 offset:16896
    ds_read_b64_tr_b16 v[68:69], v14 offset:24576
    ds_read_b64_tr_b16 v[70:71], v14 offset:25088
    s_waitcnt lgkmcnt(0)
    v_add_u32 v13, 65536, v3
    ds_write_b128 v13, v[64:67] offset:0
    ds_write_b128 v13, v[68:71] offset:1024
    s_waitcnt lgkmcnt(0)
    s_waitcnt vmcnt(8)
    s_barrier
    s_add_u32 m0, s24, 131072
    s_mov_b32 s25, 524288
    buffer_load_dwordx4 v5, s[12:15], s25 offen nt lds
    s_add_u32 m0, s24, 135168
    s_mov_b32 s25, 655360
    buffer_load_dwordx4 v5, s[12:15], s25 offen nt lds
    s_add_u32 m0, s24, 139264
    s_mov_b32 s25, 786432
    buffer_load_dwordx4 v5, s[12:15], s25 offen nt lds
    s_add_u32 m0, s24, 143360
    s_mov_b32 s25, 917504
    buffer_load_dwordx4 v5, s[12:15], s25 offen nt lds
    ds_read_b64_tr_b16 a[64:65], v7 offset:32768
    ds_read_b64_tr_b16 a[66:67], v7 offset:33280
    ds_read_b64_tr_b16 a[68:69], v7 offset:40960
    ds_read_b64_tr_b16 a[70:71], v7 offset:41472
    ds_read_b64_tr_b16 v[64:65], v14 offset:32768
    ds_read_b64_tr_b16 v[66:67], v14 offset:33280
    ds_read_b64_tr_b16 v[68:69], v14 offset:40960
    ds_read_b64_tr_b16 v[70:71], v14 offset:41472
    s_waitcnt lgkmcnt(0)
    v_add_u32 v13, 65536, v3
    ds_write_b128 v13, v[64:67] offset:8192
    ds_write_b128 v13, v[68:71] offset:9216
    s_waitcnt lgkmcnt(0)
    s_waitcnt vmcnt(8)
    s_barrier
    s_add_u32 m0, s24, 147456
    s_mov_b32 s25, 1048576
    buffer_load_dwordx4 v5, s[12:15], s25 offen nt lds
    s_add_u32 m0, s24, 151552
    s_mov_b32 s25, 1179648
    buffer_load_dwordx4 v5, s[12:15], s25 offen nt lds
    s_add_u32 m0, s24, 155648
    s_mov_b32 s25, 1310720
    buffer_load_dwordx4 v5, s[12:15], s25 offen nt lds
    s_add_u32 m0, s24, 159744
    s_mov_b32 s25, 1441792
    buffer_load_dwordx4 v5, s[12:15], s25 offen nt lds
    ds_read_b64_tr_b16 a[72:73], v11 offset:0
    ds_read_b64_tr_b16 a[74:75], v11 offset:512
    ds_read_b64_tr_b16 a[76:77], v11 offset:8192
    ds_read_b64_tr_b16 a[78:79], v11 offset:8704
    ds_read_b64_tr_b16 v[64:65], v12 offset:0
    ds_read_b64_tr_b16 v[66:67], v12 offset:512
    ds_read_b64_tr_b16 v[68:69], v12 offset:8192
    ds_read_b64_tr_b16 v[70:71], v12 offset:8704
    s_waitcnt lgkmcnt(0)
    v_add_u32 v13, 65536, v3
    ds_write_b128 v13, v[64:67] offset:16384
    ds_write_b128 v13, v[68:71] offset:17408
    s_waitcnt lgkmcnt(0)
    s_waitcnt vmcnt(8)
    s_barrier
    s_add_u32 m0, s24, 0
    s_mov_b32 s25, 1572864
    buffer_load_dwordx4 v5, s[12:15], s25 offen nt lds
    s_add_u32 m0, s24, 4096
    s_mov_b32 s25, 1703936
    buffer_load_dwordx4 v5, s[12:15], s25 offen nt lds
    s_add_u32 m0, s24, 8192
    s_mov_b32 s25, 1835008
    buffer_load_dwordx4 v5, s[12:15], s25 offen nt lds
    s_add_u32 m0, s24, 12288
    s_mov_b32 s25, 1966080
    buffer_load_dwordx4 v5, s[12:15], s25 offen nt lds
    ds_read_b64_tr_b16 a[80:81], v7 offset:0
    ds_read_b64_tr_b16 a[82:83], v7 offset:512
    ds_read_b64_tr_b16 a[84:85], v7 offset:8192
    ds_read_b64_tr_b16 a[86:87], v7 offset:8704
    ds_read_b64_tr_b16 a[88:89], v14 offset:0
    ds_read_b64_tr_b16 a[90:91], v14 offset:512
    ds_read_b64_tr_b16 a[92:93], v14 offset:8192
    ds_read_b64_tr_b16 a[94:95], v14 offset:8704
    s_waitcnt lgkmcnt(0)
    s_waitcnt vmcnt(8)
    s_barrier
    s_add_u32 m0, s24, 114688
    s_mov_b32 s25, 2097152
    buffer_load_dwordx4 v5, s[12:15], s25 offen nt lds
    s_add_u32 m0, s24, 118784
    s_mov_b32 s25, 2228224
    buffer_load_dwordx4 v5, s[12:15], s25 offen nt lds
    s_add_u32 m0, s24, 122880
    s_mov_b32 s25, 2359296
    buffer_load_dwordx4 v5, s[12:15], s25 offen nt lds
    s_add_u32 m0, s24, 126976
    s_mov_b32 s25, 2490368
    buffer_load_dwordx4 v5, s[12:15], s25 offen nt lds
    ds_read_b64_tr_b16 a[96:97], v7 offset:16384
    ds_read_b64_tr_b16 a[98:99], v7 offset:16896
    ds_read_b64_tr_b16 a[100:101], v7 offset:24576
    ds_read_b64_tr_b16 a[102:103], v7 offset:25088
    ds_read_b64_tr_b16 a[104:105], v14 offset:16384
    ds_read_b64_tr_b16 a[106:107], v14 offset:16896
    ds_read_b64_tr_b16 a[108:109], v14 offset:24576
    ds_read_b64_tr_b16 a[110:111], v14 offset:25088
    s_waitcnt lgkmcnt(0)
    s_waitcnt vmcnt(8)
    s_barrier
    s_add_u32 m0, s24, 131072
    s_mov_b32 s25, 2621440
    buffer_load_dwordx4 v5, s[12:15], s25 offen nt lds
    s_add_u32 m0, s24, 135168
    s_mov_b32 s25, 2752512
    buffer_load_dwordx4 v5, s[12:15], s25 offen nt lds
    s_add_u32 m0, s24, 139264
    s_mov_b32 s25, 2883584
    buffer_load_dwordx4 v5, s[12:15], s25 offen nt lds
    s_add_u32 m0, s24, 143360
    s_mov_b32 s25, 3014656
    buffer_load_dwordx4 v5, s[12:15], s25 offen nt lds
    ds_read_b64_tr_b16 a[112:113], v7 offset:32768
    ds_read_b64_tr_b16 a[114:115], v7 offset:33280
    ds_read_b64_tr_b16 a[116:117], v7 offset:40960
    ds_read_b64_tr_b16 a[118:119], v7 offset:41472
    ds_read_b64_tr_b16 a[120:121], v14 offset:32768
    ds_read_b64_tr_b16 a[122:123], v14 offset:33280
    ds_read_b64_tr_b16 a[124:125], v14 offset:40960
    ds_read_b64_tr_b16 a[126:127], v14 offset:41472
    s_waitcnt lgkmcnt(0)
    s_waitcnt vmcnt(8)
    s_barrier
    s_add_u32 m0, s24, 147456
    s_mov_b32 s25, 3145728
    buffer_load_dwordx4 v5, s[12:15], s25 offen nt lds
    s_add_u32 m0, s24, 151552
    s_mov_b32 s25, 3276800
    buffer_load_dwordx4 v5, s[12:15], s25 offen nt lds
    s_add_u32 m0, s24, 155648
    s_mov_b32 s25, 3407872
    buffer_load_dwordx4 v5, s[12:15], s25 offen nt lds
    s_add_u32 m0, s24, 159744
    s_mov_b32 s25, 3538944
    buffer_load_dwordx4 v5, s[12:15], s25 offen nt lds
    ds_read_b64_tr_b16 a[128:129], v11 offset:0
    ds_read_b64_tr_b16 a[130:131], v11 offset:512
    ds_read_b64_tr_b16 a[132:133], v11 offset:8192
    ds_read_b64_tr_b16 a[134:135], v11 offset:8704
    ds_read_b64_tr_b16 a[136:137], v12 offset:0
    ds_read_b64_tr_b16 a[138:139], v12 offset:512
    ds_read_b64_tr_b16 a[140:141], v12 offset:8192
    ds_read_b64_tr_b16 a[142:143], v12 offset:8704
    s_waitcnt lgkmcnt(0)
    s_waitcnt vmcnt(8)
    s_barrier
    s_add_u32 m0, s24, 0
    s_mov_b32 s25, 3670016
    buffer_load_dwordx4 v5, s[12:15], s25 offen nt lds
    s_add_u32 m0, s24, 4096
    s_mov_b32 s25, 3801088
    buffer_load_dwordx4 v5, s[12:15], s25 offen nt lds
    s_add_u32 m0, s24, 8192
    s_mov_b32 s25, 3932160
    buffer_load_dwordx4 v5, s[12:15], s25 offen nt lds
    s_add_u32 m0, s24, 12288
    s_mov_b32 s25, 4063232
    buffer_load_dwordx4 v5, s[12:15], s25 offen nt lds
    ds_read_b64_tr_b16 a[144:145], v7 offset:0
    ds_read_b64_tr_b16 a[146:147], v7 offset:512
    ds_read_b64_tr_b16 a[148:149], v7 offset:8192
    ds_read_b64_tr_b16 a[150:151], v7 offset:8704
    ds_read_b64_tr_b16 a[152:153], v14 offset:0
    ds_read_b64_tr_b16 a[154:155], v14 offset:512
    ds_read_b64_tr_b16 a[156:157], v14 offset:8192
    ds_read_b64_tr_b16 a[158:159], v14 offset:8704
    s_waitcnt lgkmcnt(0)
    s_waitcnt vmcnt(8)
    s_barrier
    s_add_u32 m0, s24, 114688
    s_mov_b32 s25, 4194304
    buffer_load_dwordx4 v5, s[12:15], s25 offen nt lds
    s_add_u32 m0, s24, 118784
    s_mov_b32 s25, 4325376
    buffer_load_dwordx4 v5, s[12:15], s25 offen nt lds
    s_add_u32 m0, s24, 122880
    s_mov_b32 s25, 4456448
    buffer_load_dwordx4 v5, s[12:15], s25 offen nt lds
    s_add_u32 m0, s24, 126976
    s_mov_b32 s25, 4587520
    buffer_load_dwordx4 v5, s[12:15], s25 offen nt lds
    ds_read_b64_tr_b16 a[160:161], v7 offset:16384
    ds_read_b64_tr_b16 a[162:163], v7 offset:16896
    ds_read_b64_tr_b16 a[164:165], v7 offset:24576
    ds_read_b64_tr_b16 a[166:167], v7 offset:25088
    ds_read_b64_tr_b16 a[168:169], v14 offset:16384
    ds_read_b64_tr_b16 a[170:171], v14 offset:16896
    ds_read_b64_tr_b16 a[172:173], v14 offset:24576
    ds_read_b64_tr_b16 a[174:175], v14 offset:25088
    s_waitcnt lgkmcnt(0)
    s_waitcnt vmcnt(8)
    s_barrier
    s_mov_b32 s12, s44
    s_and_b32 s13, s45, 0xffff
    s_add_u32 m0, s24, 131072
    s_mov_b32 s25, 0
    buffer_load_dwordx4 v5, s[12:15], s25 offen nt lds
    s_add_u32 m0, s24, 135168
    s_mov_b32 s25, 131072
    buffer_load_dwordx4 v5, s[12:15], s25 offen nt lds
    s_add_u32 m0, s24, 139264
    s_mov_b32 s25, 262144
    buffer_load_dwordx4 v5, s[12:15], s25 offen nt lds
    s_add_u32 m0, s24, 143360
    s_mov_b32 s25, 393216
    buffer_load_dwordx4 v5, s[12:15], s25 offen nt lds
    ds_read_b64_tr_b16 a[176:177], v7 offset:32768
    ds_read_b64_tr_b16 a[178:179], v7 offset:33280
    ds_read_b64_tr_b16 a[180:181], v7 offset:40960
    ds_read_b64_tr_b16 a[182:183], v7 offset:41472
    ds_read_b64_tr_b16 a[184:185], v14 offset:32768
    ds_read_b64_tr_b16 a[186:187], v14 offset:33280
    ds_read_b64_tr_b16 a[188:189], v14 offset:40960
    ds_read_b64_tr_b16 a[190:191], v14 offset:41472
    s_waitcnt lgkmcnt(0)
    s_waitcnt vmcnt(8)
    s_barrier
    s_add_u32 m0, s24, 147456
    s_mov_b32 s25, 524288
    buffer_load_dwordx4 v5, s[12:15], s25 offen nt lds
    s_add_u32 m0, s24, 151552
    s_mov_b32 s25, 655360
    buffer_load_dwordx4 v5, s[12:15], s25 offen nt lds
    s_add_u32 m0, s24, 155648
    s_mov_b32 s25, 786432
    buffer_load_dwordx4 v5, s[12:15], s25 offen nt lds
    s_add_u32 m0, s24, 159744
    s_mov_b32 s25, 917504
    buffer_load_dwordx4 v5, s[12:15], s25 offen nt lds
    ds_read_b64_tr_b16 a[192:193], v11 offset:0
    ds_read_b64_tr_b16 a[194:195], v11 offset:512
    ds_read_b64_tr_b16 a[196:197], v11 offset:8192
    ds_read_b64_tr_b16 a[198:199], v11 offset:8704
    ds_read_b64_tr_b16 a[200:201], v12 offset:0
    ds_read_b64_tr_b16 a[202:203], v12 offset:512
    ds_read_b64_tr_b16 a[204:205], v12 offset:8192
    ds_read_b64_tr_b16 a[206:207], v12 offset:8704
    s_waitcnt lgkmcnt(0)
    s_waitcnt vmcnt(8)
    s_barrier
    s_add_u32 m0, s24, 0
    s_mov_b32 s25, 1048576
    buffer_load_dwordx4 v5, s[12:15], s25 offen nt lds
    s_add_u32 m0, s24, 4096
    s_mov_b32 s25, 1179648
    buffer_load_dwordx4 v5, s[12:15], s25 offen nt lds
    s_add_u32 m0, s24, 8192
    s_mov_b32 s25, 1310720
    buffer_load_dwordx4 v5, s[12:15], s25 offen nt lds
    s_add_u32 m0, s24, 12288
    s_mov_b32 s25, 1441792
    buffer_load_dwordx4 v5, s[12:15], s25 offen nt lds
    ds_read_b64_tr_b16 a[208:209], v7 offset:0
    ds_read_b64_tr_b16 a[210:211], v7 offset:512
    ds_read_b64_tr_b16 a[212:213], v7 offset:8192
    ds_read_b64_tr_b16 a[214:215], v7 offset:8704
    ds_read_b64_tr_b16 a[216:217], v14 offset:0
    ds_read_b64_tr_b16 a[218:219], v14 offset:512
    ds_read_b64_tr_b16 a[220:221], v14 offset:8192
    ds_read_b64_tr_b16 a[222:223], v14 offset:8704
    s_waitcnt lgkmcnt(0)
    s_waitcnt vmcnt(8)
    s_barrier
    s_add_u32 m0, s24, 114688
    s_mov_b32 s25, 1572864
    buffer_load_dwordx4 v5, s[12:15], s25 offen nt lds
    s_add_u32 m0, s24, 118784
    s_mov_b32 s25, 1703936
    buffer_load_dwordx4 v5, s[12:15], s25 offen nt lds
    s_add_u32 m0, s24, 122880
    s_mov_b32 s25, 1835008
    buffer_load_dwordx4 v5, s[12:15], s25 offen nt lds
    s_add_u32 m0, s24, 126976
    s_mov_b32 s25, 1966080
    buffer_load_dwordx4 v5, s[12:15], s25 offen nt lds
    ds_read_b64_tr_b16 a[224:225], v7 offset:16384
    ds_read_b64_tr_b16 a[226:227], v7 offset:16896
    ds_read_b64_tr_b16 a[228:229], v7 offset:24576
    ds_read_b64_tr_b16 a[230:231], v7 offset:25088
    ds_read_b64_tr_b16 a[232:233], v14 offset:16384
    ds_read_b64_tr_b16 a[234:235], v14 offset:16896
    ds_read_b64_tr_b16 a[236:237], v14 offset:24576
    ds_read_b64_tr_b16 a[238:239], v14 offset:25088
    s_waitcnt lgkmcnt(0)
    s_waitcnt vmcnt(8)
    s_barrier
    s_add_u32 m0, s24, 131072
    s_mov_b32 s25, 2097152
    buffer_load_dwordx4 v5, s[12:15], s25 offen nt lds
    s_add_u32 m0, s24, 135168
    s_mov_b32 s25, 2228224
    buffer_load_dwordx4 v5, s[12:15], s25 offen nt lds
    s_add_u32 m0, s24, 139264
    s_mov_b32 s25, 2359296
    buffer_load_dwordx4 v5, s[12:15], s25 offen nt lds
    s_add_u32 m0, s24, 143360
    s_mov_b32 s25, 2490368
    buffer_load_dwordx4 v5, s[12:15], s25 offen nt lds
    ds_read_b64_tr_b16 a[240:241], v7 offset:32768
    ds_read_b64_tr_b16 a[242:243], v7 offset:33280
    ds_read_b64_tr_b16 a[244:245], v7 offset:40960
    ds_read_b64_tr_b16 a[246:247], v7 offset:41472
    ds_read_b64_tr_b16 v[64:65], v14 offset:32768
    ds_read_b64_tr_b16 v[66:67], v14 offset:33280
    ds_read_b64_tr_b16 v[68:69], v14 offset:40960
    ds_read_b64_tr_b16 v[70:71], v14 offset:41472
    s_waitcnt lgkmcnt(0)
    v_add_u32 v13, 65536, v3
    ds_write_b128 v13, v[64:67] offset:24576
    ds_write_b128 v13, v[68:71] offset:25600
    s_waitcnt lgkmcnt(0)
    s_waitcnt vmcnt(8)
    s_barrier
    s_add_u32 m0, s24, 147456
    s_mov_b32 s25, 2621440
    buffer_load_dwordx4 v5, s[12:15], s25 offen nt lds
    s_add_u32 m0, s24, 151552
    s_mov_b32 s25, 2752512
    buffer_load_dwordx4 v5, s[12:15], s25 offen nt lds
    s_add_u32 m0, s24, 155648
    s_mov_b32 s25, 2883584
    buffer_load_dwordx4 v5, s[12:15], s25 offen nt lds
    s_add_u32 m0, s24, 159744
    s_mov_b32 s25, 3014656
    buffer_load_dwordx4 v5, s[12:15], s25 offen nt lds
    ds_read_b64_tr_b16 a[248:249], v11 offset:0
    ds_read_b64_tr_b16 a[250:251], v11 offset:512
    ds_read_b64_tr_b16 a[252:253], v11 offset:8192
    ds_read_b64_tr_b16 a[254:255], v11 offset:8704
    ds_read_b64_tr_b16 v[72:73], v12 offset:0
    ds_read_b64_tr_b16 v[74:75], v12 offset:512
    ds_read_b64_tr_b16 v[76:77], v12 offset:8192
    ds_read_b64_tr_b16 v[78:79], v12 offset:8704
    s_waitcnt lgkmcnt(0)
    s_waitcnt vmcnt(8)
    s_barrier
    s_add_u32 m0, s24, 0
    s_mov_b32 s25, 3145728
    buffer_load_dwordx4 v5, s[12:15], s25 offen nt lds
    s_add_u32 m0, s24, 4096
    s_mov_b32 s25, 3276800
    buffer_load_dwordx4 v5, s[12:15], s25 offen nt lds
    s_add_u32 m0, s24, 8192
    s_mov_b32 s25, 3407872
    buffer_load_dwordx4 v5, s[12:15], s25 offen nt lds
    s_add_u32 m0, s24, 12288
    s_mov_b32 s25, 3538944
    buffer_load_dwordx4 v5, s[12:15], s25 offen nt lds
    ds_read_b64_tr_b16 v[64:65], v7 offset:0
    ds_read_b64_tr_b16 v[66:67], v7 offset:512
    ds_read_b64_tr_b16 v[68:69], v7 offset:8192
    ds_read_b64_tr_b16 v[70:71], v7 offset:8704
    s_waitcnt lgkmcnt(0)
    v_add_u32 v13, 65536, v3
    ds_write_b128 v13, v[64:67] offset:32768
    ds_write_b128 v13, v[68:71] offset:33792
    ds_read_b64_tr_b16 v[80:81], v14 offset:0
    ds_read_b64_tr_b16 v[82:83], v14 offset:512
    ds_read_b64_tr_b16 v[84:85], v14 offset:8192
    ds_read_b64_tr_b16 v[86:87], v14 offset:8704
    s_waitcnt lgkmcnt(0)
    s_waitcnt vmcnt(8)
    s_barrier
    s_add_u32 m0, s24, 114688
    s_mov_b32 s25, 3670016
    buffer_load_dwordx4 v5, s[12:15], s25 offen nt lds
    s_add_u32 m0, s24, 118784
    s_mov_b32 s25, 3801088
    buffer_load_dwordx4 v5, s[12:15], s25 offen nt lds
    s_add_u32 m0, s24, 122880
    s_mov_b32 s25, 3932160
    buffer_load_dwordx4 v5, s[12:15], s25 offen nt lds
    s_add_u32 m0, s24, 126976
    s_mov_b32 s25, 4063232
    buffer_load_dwordx4 v5, s[12:15], s25 offen nt lds
    ds_read_b64_tr_b16 v[88:89], v7 offset:16384
    ds_read_b64_tr_b16 v[90:91], v7 offset:16896
    ds_read_b64_tr_b16 v[92:93], v7 offset:24576
    ds_read_b64_tr_b16 v[94:95], v7 offset:25088
    ds_read_b64_tr_b16 v[64:65], v14 offset:16384
    ds_read_b64_tr_b16 v[66:67], v14 offset:16896
    ds_read_b64_tr_b16 v[68:69], v14 offset:24576
    ds_read_b64_tr_b16 v[70:71], v14 offset:25088
    s_waitcnt lgkmcnt(0)
    v_add_u32 v13, 65536, v3
    ds_write_b128 v13, v[64:67] offset:40960
    ds_write_b128 v13, v[68:71] offset:41984
    s_waitcnt lgkmcnt(0)
    s_waitcnt vmcnt(8)
    s_barrier
    s_add_u32 m0, s24, 131072
    s_mov_b32 s25, 4194304
    buffer_load_dwordx4 v5, s[12:15], s25 offen nt lds
    s_add_u32 m0, s24, 135168
    s_mov_b32 s25, 4325376
    buffer_load_dwordx4 v5, s[12:15], s25 offen nt lds
    s_add_u32 m0, s24, 139264
    s_mov_b32 s25, 4456448
    buffer_load_dwordx4 v5, s[12:15], s25 offen nt lds
    s_add_u32 m0, s24, 143360
    s_mov_b32 s25, 4587520
    buffer_load_dwordx4 v5, s[12:15], s25 offen nt lds
    ds_read_b64_tr_b16 v[96:97], v7 offset:32768
    ds_read_b64_tr_b16 v[98:99], v7 offset:33280
    ds_read_b64_tr_b16 v[100:101], v7 offset:40960
    ds_read_b64_tr_b16 v[102:103], v7 offset:41472
    ds_read_b64_tr_b16 v[104:105], v14 offset:32768
    ds_read_b64_tr_b16 v[106:107], v14 offset:33280
    ds_read_b64_tr_b16 v[108:109], v14 offset:40960
    ds_read_b64_tr_b16 v[110:111], v14 offset:41472
    s_waitcnt lgkmcnt(0)
    s_waitcnt vmcnt(8)
    s_barrier
    s_mov_b32 s12, s46
    s_and_b32 s13, s47, 0xffff
    s_add_u32 m0, s24, 147456
    s_mov_b32 s25, 0
    buffer_load_dwordx4 v6, s[12:15], s25 offen nt lds
    s_add_u32 m0, s24, 151552
    s_mov_b32 s25, 36864
    buffer_load_dwordx4 v6, s[12:15], s25 offen nt lds
    s_add_u32 m0, s24, 155648
    s_mov_b32 s25, 73728
    buffer_load_dwordx4 v6, s[12:15], s25 offen nt lds
    s_add_u32 m0, s24, 159744
    s_mov_b32 s25, 110592
    buffer_load_dwordx4 v6, s[12:15], s25 offen nt lds
    ds_read_b64_tr_b16 v[16:17], v11 offset:0
    ds_read_b64_tr_b16 v[18:19], v11 offset:512
    ds_read_b64_tr_b16 v[20:21], v11 offset:8192
    ds_read_b64_tr_b16 v[22:23], v11 offset:8704
    ds_read_b64_tr_b16 v[112:113], v12 offset:0
    ds_read_b64_tr_b16 v[114:115], v12 offset:512
    ds_read_b64_tr_b16 v[116:117], v12 offset:8192
    ds_read_b64_tr_b16 v[118:119], v12 offset:8704
    s_waitcnt lgkmcnt(0)
    s_waitcnt vmcnt(8)
    s_barrier
    s_add_u32 m0, s24, 0
    s_mov_b32 s25, 128
    buffer_load_dwordx4 v6, s[12:15], s25 offen nt lds
    s_add_u32 m0, s24, 4096
    s_mov_b32 s25, 36992
    buffer_load_dwordx4 v6, s[12:15], s25 offen nt lds
    s_add_u32 m0, s24, 8192
    s_mov_b32 s25, 73856
    buffer_load_dwordx4 v6, s[12:15], s25 offen nt lds
    s_add_u32 m0, s24, 12288
    s_mov_b32 s25, 110720
    buffer_load_dwordx4 v6, s[12:15], s25 offen nt lds
    ds_read_b64_tr_b16 v[120:121], v7 offset:0
    ds_read_b64_tr_b16 v[122:123], v7 offset:512
    ds_read_b64_tr_b16 v[124:125], v7 offset:8192
    ds_read_b64_tr_b16 v[126:127], v7 offset:8704
    ds_read_b64_tr_b16 v[24:25], v14 offset:0
    ds_read_b64_tr_b16 v[26:27], v14 offset:512
    ds_read_b64_tr_b16 v[28:29], v14 offset:8192
    ds_read_b64_tr_b16 v[30:31], v14 offset:8704
    s_waitcnt lgkmcnt(0)
    s_waitcnt vmcnt(8)
    s_barrier
    s_add_u32 m0, s24, 114688
    s_mov_b32 s25, 256
    buffer_load_dwordx4 v6, s[12:15], s25 offen nt lds
    s_add_u32 m0, s24, 118784
    s_mov_b32 s25, 37120
    buffer_load_dwordx4 v6, s[12:15], s25 offen nt lds
    s_add_u32 m0, s24, 122880
    s_mov_b32 s25, 73984
    buffer_load_dwordx4 v6, s[12:15], s25 offen nt lds
    s_add_u32 m0, s24, 126976
    s_mov_b32 s25, 110848
    buffer_load_dwordx4 v6, s[12:15], s25 offen nt lds
    ds_read_b64_tr_b16 v[128:129], v7 offset:16384
    ds_read_b64_tr_b16 v[130:131], v7 offset:16896
    ds_read_b64_tr_b16 v[132:133], v7 offset:24576
    ds_read_b64_tr_b16 v[134:135], v7 offset:25088
    ds_read_b64_tr_b16 v[32:33], v14 offset:16384
    ds_read_b64_tr_b16 v[34:35], v14 offset:16896
    ds_read_b64_tr_b16 v[36:37], v14 offset:24576
    ds_read_b64_tr_b16 v[38:39], v14 offset:25088
    s_waitcnt lgkmcnt(0)
    s_waitcnt vmcnt(8)
    s_barrier
    s_add_u32 m0, s24, 131072
    s_mov_b32 s25, 384
    buffer_load_dwordx4 v6, s[12:15], s25 offen nt lds
    s_add_u32 m0, s24, 135168
    s_mov_b32 s25, 37248
    buffer_load_dwordx4 v6, s[12:15], s25 offen nt lds
    s_add_u32 m0, s24, 139264
    s_mov_b32 s25, 74112
    buffer_load_dwordx4 v6, s[12:15], s25 offen nt lds
    s_add_u32 m0, s24, 143360
    s_mov_b32 s25, 110976
    buffer_load_dwordx4 v6, s[12:15], s25 offen nt lds
    ds_read_b64_tr_b16 v[136:137], v15 offset:32768
    ds_read_b64_tr_b16 v[138:139], v15 offset:33024
    ds_read_b64_tr_b16 v[140:141], v15 offset:36864
    ds_read_b64_tr_b16 v[142:143], v15 offset:37120
    ds_read_b64_tr_b16 v[144:145], v15 offset:40960
    ds_read_b64_tr_b16 v[146:147], v15 offset:41216
    ds_read_b64_tr_b16 v[148:149], v15 offset:45056
    ds_read_b64_tr_b16 v[150:151], v15 offset:45312
    s_waitcnt lgkmcnt(0)
    s_waitcnt vmcnt(8)
    s_barrier
    s_add_u32 m0, s24, 147456
    s_mov_b32 s25, 512
    buffer_load_dwordx4 v6, s[12:15], s25 offen nt lds
    s_add_u32 m0, s24, 151552
    s_mov_b32 s25, 37376
    buffer_load_dwordx4 v6, s[12:15], s25 offen nt lds
    s_add_u32 m0, s24, 155648
    s_mov_b32 s25, 74240
    buffer_load_dwordx4 v6, s[12:15], s25 offen nt lds
    s_add_u32 m0, s24, 159744
    s_mov_b32 s25, 111104
    buffer_load_dwordx4 v6, s[12:15], s25 offen nt lds
    ds_read_b64_tr_b16 v[152:153], v10 offset:0
    ds_read_b64_tr_b16 v[154:155], v10 offset:256
    ds_read_b64_tr_b16 v[156:157], v10 offset:4096
    ds_read_b64_tr_b16 v[158:159], v10 offset:4352
    ds_read_b64_tr_b16 v[160:161], v10 offset:8192
    ds_read_b64_tr_b16 v[162:163], v10 offset:8448
    ds_read_b64_tr_b16 v[164:165], v10 offset:12288
    ds_read_b64_tr_b16 v[166:167], v10 offset:12544
    s_waitcnt lgkmcnt(0)
    s_waitcnt vmcnt(8)
    s_barrier
    s_add_u32 m0, s24, 0
    s_mov_b32 s25, 640
    buffer_load_dwordx4 v6, s[12:15], s25 offen nt lds
    s_add_u32 m0, s24, 4096
    s_mov_b32 s25, 37504
    buffer_load_dwordx4 v6, s[12:15], s25 offen nt lds
    s_add_u32 m0, s24, 8192
    s_mov_b32 s25, 74368
    buffer_load_dwordx4 v6, s[12:15], s25 offen nt lds
    s_add_u32 m0, s24, 12288
    s_mov_b32 s25, 111232
    buffer_load_dwordx4 v6, s[12:15], s25 offen nt lds
    ds_read_b64_tr_b16 v[40:41], v15 offset:0
    ds_read_b64_tr_b16 v[42:43], v15 offset:256
    ds_read_b64_tr_b16 v[44:45], v15 offset:4096
    ds_read_b64_tr_b16 v[46:47], v15 offset:4352
    ds_read_b64_tr_b16 v[168:169], v15 offset:8192
    ds_read_b64_tr_b16 v[170:171], v15 offset:8448
    ds_read_b64_tr_b16 v[172:173], v15 offset:12288
    ds_read_b64_tr_b16 v[174:175], v15 offset:12544
    s_waitcnt lgkmcnt(0)
    s_waitcnt vmcnt(8)
    s_barrier
    s_add_u32 m0, s24, 114688
    s_mov_b32 s25, 768
    buffer_load_dwordx4 v6, s[12:15], s25 offen nt lds
    s_add_u32 m0, s24, 118784
    s_mov_b32 s25, 37632
    buffer_load_dwordx4 v6, s[12:15], s25 offen nt lds
    s_add_u32 m0, s24, 122880
    s_mov_b32 s25, 74496
    buffer_load_dwordx4 v6, s[12:15], s25 offen nt lds
    s_add_u32 m0, s24, 126976
    s_mov_b32 s25, 111360
    buffer_load_dwordx4 v6, s[12:15], s25 offen nt lds
    ds_read_b64_tr_b16 v[176:177], v15 offset:16384
    ds_read_b64_tr_b16 v[178:179], v15 offset:16640
    ds_read_b64_tr_b16 v[180:181], v15 offset:20480
    ds_read_b64_tr_b16 v[182:183], v15 offset:20736
    ds_read_b64_tr_b16 v[184:185], v15 offset:24576
    ds_read_b64_tr_b16 v[186:187], v15 offset:24832
    ds_read_b64_tr_b16 v[188:189], v15 offset:28672
    ds_read_b64_tr_b16 v[190:191], v15 offset:28928
    s_waitcnt lgkmcnt(0)
    s_waitcnt vmcnt(8)
    s_barrier
    s_add_u32 m0, s24, 131072
    s_mov_b32 s25, 896
    buffer_load_dwordx4 v6, s[12:15], s25 offen nt lds
    s_add_u32 m0, s24, 135168
    s_mov_b32 s25, 37760
    buffer_load_dwordx4 v6, s[12:15], s25 offen nt lds
    s_add_u32 m0, s24, 139264
    s_mov_b32 s25, 74624
    buffer_load_dwordx4 v6, s[12:15], s25 offen nt lds
    s_add_u32 m0, s24, 143360
    s_mov_b32 s25, 111488
    buffer_load_dwordx4 v6, s[12:15], s25 offen nt lds
    ds_read_b64_tr_b16 v[192:193], v15 offset:32768
    ds_read_b64_tr_b16 v[194:195], v15 offset:33024
    ds_read_b64_tr_b16 v[196:197], v15 offset:36864
    ds_read_b64_tr_b16 v[198:199], v15 offset:37120
    ds_read_b64_tr_b16 v[48:49], v15 offset:40960
    ds_read_b64_tr_b16 v[50:51], v15 offset:41216
    ds_read_b64_tr_b16 v[52:53], v15 offset:45056
    ds_read_b64_tr_b16 v[54:55], v15 offset:45312
    s_waitcnt lgkmcnt(0)
    s_waitcnt vmcnt(8)
    s_barrier
    s_add_u32 m0, s24, 147456
    s_mov_b32 s25, 1024
    buffer_load_dwordx4 v6, s[12:15], s25 offen nt lds
    s_add_u32 m0, s24, 151552
    s_mov_b32 s25, 37888
    buffer_load_dwordx4 v6, s[12:15], s25 offen nt lds
    s_add_u32 m0, s24, 155648
    s_mov_b32 s25, 74752
    buffer_load_dwordx4 v6, s[12:15], s25 offen nt lds
    s_add_u32 m0, s24, 159744
    s_mov_b32 s25, 111616
    buffer_load_dwordx4 v6, s[12:15], s25 offen nt lds
    ds_read_b64_tr_b16 v[200:201], v10 offset:0
    ds_read_b64_tr_b16 v[202:203], v10 offset:256
    ds_read_b64_tr_b16 v[204:205], v10 offset:4096
    ds_read_b64_tr_b16 v[206:207], v10 offset:4352
    ds_read_b64_tr_b16 v[208:209], v10 offset:8192
    ds_read_b64_tr_b16 v[210:211], v10 offset:8448
    ds_read_b64_tr_b16 v[212:213], v10 offset:12288
    ds_read_b64_tr_b16 v[214:215], v10 offset:12544
    s_waitcnt lgkmcnt(0)
    s_waitcnt vmcnt(8)
    s_barrier
    ds_read_b64_tr_b16 v[216:217], v15 offset:0
    ds_read_b64_tr_b16 v[218:219], v15 offset:256
    ds_read_b64_tr_b16 v[220:221], v15 offset:4096
    ds_read_b64_tr_b16 v[222:223], v15 offset:4352
    ds_read_b64_tr_b16 v[224:225], v15 offset:8192
    ds_read_b64_tr_b16 v[226:227], v15 offset:8448
    ds_read_b64_tr_b16 v[228:229], v15 offset:12288
    ds_read_b64_tr_b16 v[230:231], v15 offset:12544
    s_waitcnt lgkmcnt(0)
    s_waitcnt vmcnt(4)
    s_barrier
    ds_read_b64_tr_b16 v[56:57], v15 offset:16384
    ds_read_b64_tr_b16 v[58:59], v15 offset:16640
    ds_read_b64_tr_b16 v[60:61], v15 offset:20480
    ds_read_b64_tr_b16 v[62:63], v15 offset:20736
    ds_read_b64_tr_b16 v[232:233], v15 offset:24576
    ds_read_b64_tr_b16 v[234:235], v15 offset:24832
    ds_read_b64_tr_b16 v[236:237], v15 offset:28672
    ds_read_b64_tr_b16 v[238:239], v15 offset:28928
    s_waitcnt lgkmcnt(0)
    s_waitcnt vmcnt(0)
    s_barrier
    ds_read_b64_tr_b16 v[240:241], v15 offset:32768
    ds_read_b64_tr_b16 v[242:243], v15 offset:33024
    ds_read_b64_tr_b16 v[244:245], v15 offset:36864
    ds_read_b64_tr_b16 v[246:247], v15 offset:37120
    ds_read_b64_tr_b16 v[248:249], v15 offset:40960
    ds_read_b64_tr_b16 v[250:251], v15 offset:41216
    ds_read_b64_tr_b16 v[252:253], v15 offset:45056
    ds_read_b64_tr_b16 v[254:255], v15 offset:45312
    s_waitcnt lgkmcnt(0)
    s_barrier
    v_add_u32 v13, 65536, v3
    ds_write_b128 v13, v[16:19] offset:49152
    ds_write_b128 v13, v[20:23] offset:50176
    v_add_u32 v13, 65536, v3
    ds_write_b128 v13, v[24:27] offset:57344
    ds_write_b128 v13, v[28:31] offset:58368
    v_add_u32 v13, 131072, v3
    ds_write_b128 v13, v[32:35] offset:0
    ds_write_b128 v13, v[36:39] offset:1024
    v_add_u32 v13, 131072, v3
    ds_write_b128 v13, v[40:43] offset:8192
    ds_write_b128 v13, v[44:47] offset:9216
    v_add_u32 v13, 131072, v3
    ds_write_b128 v13, v[48:51] offset:16384
    ds_write_b128 v13, v[52:55] offset:17408
    v_add_u32 v13, 131072, v3
    ds_write_b128 v13, v[56:59] offset:24576
    ds_write_b128 v13, v[60:63] offset:25600
    s_waitcnt lgkmcnt(0)
    v_and_b32 v14, 63, v0
    v_lshrrev_b32 v15, 6, v0
    v_lshrrev_b32 v16, 4, v14
    v_and_b32 v17, 15, v14
    v_lshrrev_b32 v18, 2, v17
    v_and_b32 v19, 3, v14
    v_bfe_u32 v20, v17, 1, 1
    v_and_b32 v21, 1, v17
    v_lshlrev_b32 v1, 4, v14
    v_lshlrev_b32 v2, 4, v0
    v_lshl_add_u32 v3, v15, 11, v1
    v_mov_b32 v4, 0x4444
    v_mov_b32 v24, 0xeeee
    v_cmp_ne_u32 vcc, 0, v20
    s_nop 1
    v_cndmask_b32 v4, v4, v24, vcc
    v_lshl_add_u32 v23, v15, 5, v17
    v_mul_u32_u24 v23, 40, v23
    v_lshl_add_u32 v23, v16, 3, v23
    v_add_u32 v5, 9216, v23
    v_lshl_add_u32 v23, v16, 3, v18
    v_mul_u32_u24 v23, 40, v23
    v_lshl_add_u32 v6, v19, 3, v23
    v_mul_u32_u24 v23, 1280, v15
    v_add_u32 v13, v23, v6
    v_and_b32 v22, 7, v17
    v_lshlrev_b32 v23, 9, v15
    v_lshl_add_u32 v23, v22, 5, v23
    v_lshl_add_u32 v23, v16, 3, v23
    v_lshrrev_b32 v24, 3, v17
    v_lshl_add_u32 v23, v24, 2, v23
    v_add_u32 v7, 19456, v23
    v_lshl_add_u32 v22, v18, 1, v21
    v_lshl_add_u32 v23, v16, 3, v22
    v_lshlrev_b32 v23, 4, v23
    v_mul_u32_u24 v24, 1152, v15
    v_add_u32 v24, v24, v23
    v_add_u32 v8, 19456, v24
    v_mul_u32_u24 v24, 1152, v20
    v_add_u32 v24, v24, v23
    v_add_u32 v9, 19456, v24
    s_lshr_b32 s62, s49, 3
    s_lshr_b32 s63, s49, 1
    s_and_b32 s63, s63, 3
    s_and_b32 s67, s49, 1
    s_lshl_b32 s69, s62, 6
    s_lshl_b32 s61, s63, 4
    s_add_u32 s69, s69, s61
    s_lshl_b32 s61, s67, 3
    s_add_u32 s69, s69, s61
    s_mul_i32 s27, s69, 12
    s_mul_i32 s61, s22, 3072
    s_add_u32 s27, s27, s61
    v_add_u32 v23, s69, v22
    v_mul_u32_u24 v23, 12, v23
    v_lshl_add_u32 v24, v16, 1, v20
    v_mul_u32_u24 v24, 9216, v24
    v_add_u32 v23, v23, v24
    s_mul_i32 s69, s22, 3072
    s_cmp_eq_u32 s22, 3
    s_cselect_b32 s69, 0x7fff0000, s69
    v_add_u32 v10, s69, v23
    s_lshl_b32 s69, s62, 4
    s_lshl_b32 s61, s63, 2
    s_add_u32 s69, s69, s61
    s_lshl_b32 s61, s67, 1
    s_add_u32 s69, s69, s61
    v_add_u32 v23, s69, v21
    v_lshlrev_b32 v23, 4, v23
    v_lshl_add_u32 v23, v16, 2, v23
    v_lshrrev_b32 v24, 1, v17
    v_lshl_add_u32 v23, v24, 10, v23
    s_mul_i32 s69, s22, 3072
    s_cmp_eq_u32 s22, 3
    s_cselect_b32 s69, 0x7fff0000, s69
    v_add_u32 v11, s69, v23
    v_mov_b32 v24, 0x7fff0000
    v_cmp_gt_u32 vcc, 6, v17
    s_nop 1
    v_cndmask_b32 v11, v24, v11, vcc
    v_lshlrev_b32 v23, 7, v17
    v_lshl_add_u32 v23, v15, 11, v23
    v_and_b32 v24, 1, v16
    v_mul_u32_u24 v24, 1048576, v24
    v_lshl_add_u32 v12, v24, 4, v23
    s_lshl_b32 s62, s49, 13
    s_add_u32 s56, s62, 20971520
    s_lshl_b32 s62, s49, 12
    s_add_u32 s57, s62, 54525952
    s_mul_i32 s62, s49, 9216
    s_add_u32 s65, s62, 71303168
    s_lshl_b32 s62, s49, 7
    s_add_u32 s64, s62, 73400320
    s_mov_b32 s50, 0
    s_mov_b32 s58, 0
    s_mov_b32 s66, 0
    s_mov_b32 s51, 72351744
    s_mov_b32 s52, 72360960
    s_mov_b32 s54, 0
    s_mov_b32 s76, 72379392
    s_mov_b32 s77, 589824
    s_lshl_b32 s70, s22, 10
    s_mov_b32 s72, 0x3e0293ee
    s_mov_b32 s73, 0x3e0293ee
    s_mov_b32 s98, 0x3f803f80
    s_mov_b32 s99, 0x3f803f80
    s_mov_b32 s100, 0x3f003f00
    s_mov_b32 s101, 0x3f003f00
    v_and_b32 v28, 63, v0
    v_and_b32 v29, 15, v28
    v_lshrrev_b32 v30, 2, v29
    v_and_b32 v31, 1, v29
    v_lshl_add_u32 v30, v30, 1, v31
    v_mul_u32_u24 v30, 1152, v30
    v_lshrrev_b32 v31, 4, v28
    v_lshl_add_u32 v30, v31, 5, v30
    v_bfe_u32 v31, v29, 1, 1
    v_lshl_add_u32 v30, v31, 4, v30
    s_cmp_eq_u32 s22, 3
    s_cselect_b32 s62, 0, s22
    s_lshl_b32 s62, s62, 7
    v_add_u32 v30, s62, v30
    buffer_load_dwordx4 v[16:19], v30, s[4:7], 0 offen
    buffer_load_dwordx4 v[20:23], v30, s[4:7], 0 offen offset:384
    buffer_load_dwordx4 v[24:27], v30, s[4:7], 0 offen offset:768
    v_and_b32 v32, 1, v29
    v_lshlrev_b32 v32, 4, v32
    v_mov_b32 v33, 0x3f80
    v_lshlrev_b32 v32, v32, v33
    v_bfe_u32 v33, v29, 1, 2
    v_cmp_eq_u32 vcc, 0, v33
    s_nop 1
    v_cndmask_b32 v36, 0, v32, vcc
    v_cmp_eq_u32 vcc, 1, v33
    s_nop 1
    v_cndmask_b32 v37, 0, v32, vcc
    v_cmp_eq_u32 vcc, 2, v33
    s_nop 1
    v_cndmask_b32 v38, 0, v32, vcc
    v_cmp_eq_u32 vcc, 3, v33
    s_nop 1
    v_cndmask_b32 v39, 0, v32, vcc
    v_lshlrev_b32 v33, 4, v29
    ds_write_b128 v33, v[36:39] offset:24064
    s_waitcnt vmcnt(0)
    s_cmp_eq_u32 s22, 3
    s_cbranch_scc1 rec_mem0_skip
    ds_write_b128 v2, v[16:19] offset:0
    ds_write_b128 v2, v[20:23] offset:3072
    ds_write_b128 v2, v[24:27] offset:6144
rec_mem0_skip:
    s_mov_b32 s88, 101
    v_mov_b32 v15, 192
    s_mov_b32 s90, 0
rec_wa:
    buffer_load_dword v14, v15, s[16:19], 0 offen sc1
    s_add_u32 s90, s90, 1
    s_cmp_gt_u32 s90, 65536
    s_cbranch_scc1 L_exit
    s_waitcnt vmcnt(0)
    v_readfirstlane_b32 s91, v14
    s_cmp_ge_u32 s91, 256
    s_cbranch_scc1 rec_wa_ok
    s_sleep 4
    s_branch rec_wa
rec_wa_ok:
    v_mov_b64 v[36:37], 0
    v_mov_b64 v[38:39], 0
    v_mov_b64 v[40:41], 0
    v_mov_b64 v[42:43], 0
    v_mov_b64 v[44:45], 0
    v_mov_b64 v[46:47], 0
    v_mov_b64 v[48:49], 0
    v_mov_b64 v[50:51], 0
    s_cmp_eq_u32 s22, 3
    s_cselect_b32 s70, 0, s70
    s_add_u32 s38, s50, 2
    s_min_u32 s38, s38, 64
    s_cmp_ge_u32 s58, s38
    s_cbranch_scc1 rec_kvoki
    s_mov_b32 s39, 0
    v_and_b32 v15, 16, v1
    v_lshlrev_b32 v15, 8, v15
    s_add_u32 s28, s64, 4096
rec_kvpolli:
    buffer_load_dword v14, v15, s[8:11], s28 offen sc1
    s_add_u32 s39, s39, 1
    s_cmp_gt_u32 s39, 32768
    s_cbranch_scc1 rec_timeout
    s_waitcnt vmcnt(0)
    v_readlane_b32 s29, v14, 0
    v_readlane_b32 s58, v14, 1
    s_min_u32 s58, s58, s29
    s_cmp_ge_u32 s58, s38
    s_cbranch_scc0 rec_kvpolli
rec_kvoki:
    buffer_load_dword v0, v12, s[8:11], s56 offen
    buffer_load_dwordx4 v[60:63], v3, s[8:11], s56 offen
    buffer_load_dwordx4 v[64:67], v3, s[8:11], s56 offen offset:1024
    s_waitcnt vmcnt(0)
    s_mov_b32 s37, 1
rec_step:
    s_cmp_eq_u32 s22, 1
    s_cbranch_scc1 rec_var1
    s_cmp_eq_u32 s22, 2
    s_cbranch_scc1 rec_var2
    s_cmp_eq_u32 s22, 3
    s_cbranch_scc1 rec_var3
    ds_read_b128 v[52:55], v3 offset:40960
    ds_read_b128 v[56:59], v3 offset:41984
    v_add_u32 v14, 65536, v3
    ds_read_b128 v[28:31], v14 offset:0
    ds_read_b128 v[32:35], v14 offset:1024
    s_cmp_eq_u32 s37, 1
    s_cbranch_scc1 rec_p0done0
    s_nop 7
    s_mov_b32 s61, 0
    s_add_u32 s63, s33, 3072
    s_add_u32 s69, s33, 6144
rec_p0poll0:
    buffer_load_dwordx4 v[16:19], v1, s[8:11], s33 offen sc1
    buffer_load_dwordx4 v[20:23], v1, s[8:11], s63 offen sc1
    buffer_load_dwordx4 v[24:27], v1, s[8:11], s69 offen sc1
    s_add_u32 s61, s61, 1
    s_cmp_gt_u32 s61, 32768
    s_cbranch_scc1 rec_timeout
    s_waitcnt vmcnt(2)
    v_max3_u32 v15, v16, v17, v18
    s_waitcnt vmcnt(1)
    v_max3_u32 v15, v15, v19, v20
    v_max3_u32 v15, v15, v21, v22
    s_waitcnt vmcnt(0)
    v_max3_u32 v15, v15, v23, v24
    v_max3_u32 v15, v15, v25, v26
    v_max_u32 v15, v15, v27
    v_cmp_eq_u32 vcc, -1, v15
    s_cbranch_vccnz rec_p0poll0
rec_p0done0:
    s_mov_b32 s37, 0
    ds_write_b128 v2, v[16:19] offset:0
    ds_write_b128 v2, v[20:23] offset:3072
    ds_write_b128 v2, v[24:27] offset:6144
    v_smfmac_f32_16x16x64_bf16 v[36:39], v[16:19], a[0:7], v4
    v_smfmac_f32_16x16x64_bf16 v[40:43], v[16:19], a[8:15], v4
    v_smfmac_f32_16x16x64_bf16 v[44:47], v[16:19], a[80:87], v4
    v_smfmac_f32_16x16x64_bf16 v[48:51], v[16:19], a[88:95], v4
    v_smfmac_f32_16x16x64_bf16 v[36:39], v[20:23], a[32:39], v4
    s_waitcnt lgkmcnt(5)
    v_smfmac_f32_16x16x64_bf16 v[40:43], v[20:23], v[52:59], v4
    ds_read_b128 v[52:55], v3 offset:24576
    ds_read_b128 v[56:59], v3 offset:25600
    v_smfmac_f32_16x16x64_bf16 v[44:47], v[20:23], a[128:135], v4
    v_smfmac_f32_16x16x64_bf16 v[48:51], v[20:23], a[136:143], v4
    s_waitcnt lgkmcnt(2)
    s_barrier
    ds_read_b128 v[16:19], v1 offset:1024
    ds_read_b128 v[20:23], v1 offset:2048
    v_smfmac_f32_16x16x64_bf16 v[36:39], v[24:27], a[56:63], v4
    v_smfmac_f32_16x16x64_bf16 v[40:43], v[24:27], v[28:35], v4
    ds_read_b128 v[28:31], v3 offset:32768
    ds_read_b128 v[32:35], v3 offset:33792
    v_smfmac_f32_16x16x64_bf16 v[44:47], v[24:27], a[176:183], v4
    v_smfmac_f32_16x16x64_bf16 v[48:51], v[24:27], a[184:191], v4
    ds_read_b128 v[24:27], v1 offset:4096
    s_waitcnt lgkmcnt(4)
    v_smfmac_f32_16x16x64_bf16 v[36:39], v[16:19], a[16:23], v4
    s_add_u32 s62, s56, 262144
    buffer_load_dword v0, v12, s[8:11], s62 offen
    v_smfmac_f32_16x16x64_bf16 v[40:43], v[16:19], v[52:59], v4
    ds_read_b128 v[52:55], v3 offset:49152
    ds_read_b128 v[56:59], v3 offset:50176
    v_smfmac_f32_16x16x64_bf16 v[44:47], v[16:19], a[96:103], v4
    v_smfmac_f32_16x16x64_bf16 v[48:51], v[16:19], a[104:111], v4
    ds_read_b128 v[16:19], v1 offset:5120
    s_waitcnt lgkmcnt(6)
    v_smfmac_f32_16x16x64_bf16 v[36:39], v[20:23], a[24:31], v4
    s_waitcnt lgkmcnt(4)
    v_smfmac_f32_16x16x64_bf16 v[40:43], v[20:23], v[28:35], v4
    ds_read_b128 v[28:31], v3 offset:57344
    ds_read_b128 v[32:35], v3 offset:58368
    v_smfmac_f32_16x16x64_bf16 v[44:47], v[20:23], a[112:119], v4
    v_smfmac_f32_16x16x64_bf16 v[48:51], v[20:23], a[120:127], v4
    ds_read_b128 v[20:23], v1 offset:7168
    s_waitcnt lgkmcnt(6)
    v_smfmac_f32_16x16x64_bf16 v[36:39], v[24:27], a[40:47], v4
    s_waitcnt lgkmcnt(4)
    v_smfmac_f32_16x16x64_bf16 v[40:43], v[24:27], v[52:59], v4
    ds_read_b128 v[52:55], v14 offset:8192
    ds_read_b128 v[56:59], v14 offset:9216
    v_smfmac_f32_16x16x64_bf16 v[44:47], v[24:27], a[144:151], v4
    v_smfmac_f32_16x16x64_bf16 v[48:51], v[24:27], a[152:159], v4
    ds_read_b128 v[24:27], v1 offset:8192
    s_waitcnt lgkmcnt(6)
    v_smfmac_f32_16x16x64_bf16 v[36:39], v[16:19], a[48:55], v4
    s_waitcnt lgkmcnt(4)
    v_smfmac_f32_16x16x64_bf16 v[40:43], v[16:19], v[28:35], v4
    ds_read_b128 v[28:31], v14 offset:16384
    ds_read_b128 v[32:35], v14 offset:17408
    v_smfmac_f32_16x16x64_bf16 v[44:47], v[16:19], a[160:167], v4
    v_smfmac_f32_16x16x64_bf16 v[48:51], v[16:19], a[168:175], v4
    ds_read_b128 v[16:19], v1 offset:0
    s_waitcnt lgkmcnt(6)
    v_smfmac_f32_16x16x64_bf16 v[36:39], v[20:23], a[64:71], v4
    s_waitcnt lgkmcnt(4)
    v_smfmac_f32_16x16x64_bf16 v[40:43], v[20:23], v[52:59], v4
    s_waitcnt lgkmcnt(3)
    v_smfmac_f32_16x16x64_bf16 v[36:39], v[24:27], a[72:79], v4
    v_mov_b64 v[52:53], 0
    s_waitcnt lgkmcnt(1)
    v_smfmac_f32_16x16x64_bf16 v[40:43], v[24:27], v[28:35], v4
    ds_read_b128 v[28:31], v14 offset:24576
    ds_read_b128 v[32:35], v14 offset:25600
    v_mov_b64 v[54:55], 0
    v_smfmac_f32_16x16x64_bf16 v[44:47], v[20:23], a[192:199], v4
    v_mov_b64 v[56:57], 0
    v_smfmac_f32_16x16x64_bf16 v[48:51], v[20:23], a[200:207], v4
    ds_read_b128 v[20:23], v1 offset:1024
    v_mov_b64 v[58:59], 0
    v_pk_add_f32 v[36:37], v[36:37], v[38:39]
    v_smfmac_f32_16x16x64_bf16 v[44:47], v[24:27], a[208:215], v4
    v_pk_add_f32 v[40:41], v[40:41], v[42:43]
    v_pk_mul_f32 v[36:37], v[36:37], s[72:73]
    v_smfmac_f32_16x16x64_bf16 v[48:51], v[24:27], a[216:223], v4
    ds_read_b128 v[24:27], v1 offset:2048
    v_pk_mul_f32 v[40:41], v[40:41], s[72:73]
    v_cvt_pk_bf16_f32 v38, v36, v37
    s_waitcnt lgkmcnt(4)
    v_smfmac_f32_16x16x64_bf16 v[52:55], v[16:19], a[224:231], v4
    v_cvt_pk_bf16_f32 v39, v36, v37
    v_cvt_pk_bf16_f32 v42, v40, v41
    ds_write_b64 v5, v[38:39]
    v_smfmac_f32_16x16x64_bf16 v[56:59], v[16:19], a[232:239], v4
    ds_read_b128 v[16:19], v1 offset:3072
    v_cvt_pk_bf16_f32 v43, v40, v41
    ds_write_b64 v5, v[42:43] offset:640
    s_waitcnt lgkmcnt(4)
    v_smfmac_f32_16x16x64_bf16 v[52:55], v[20:23], a[240:247], v4
    v_pk_add_f32 v[44:45], v[44:45], v[46:47]
    v_pk_add_f32 v[48:49], v[48:49], v[50:51]
    v_smfmac_f32_16x16x64_bf16 v[56:59], v[20:23], v[28:35], v4
    ds_read_b128 v[28:31], v14 offset:32768
    ds_read_b128 v[32:35], v14 offset:33792
    ds_read_b128 v[20:23], v1 offset:4096
    v_cvt_pk_bf16_f32 v46, v44, v45
    v_cvt_pk_bf16_f32 v47, v44, v45
    s_waitcnt lgkmcnt(6)
    v_smfmac_f32_16x16x64_bf16 v[52:55], v[24:27], a[248:255], v4
    v_cvt_pk_bf16_f32 v50, v48, v49
    ds_write_b64 v5, v[46:47] offset:5120
    v_smfmac_f32_16x16x64_bf16 v[56:59], v[24:27], v[72:79], v4
    ds_read_b128 v[24:27], v1 offset:5120
    v_cvt_pk_bf16_f32 v51, v48, v49
    ds_write_b64 v5, v[50:51] offset:5760
    s_waitcnt lgkmcnt(7)
    s_waitcnt lgkmcnt(4)
    v_smfmac_f32_16x16x64_bf16 v[52:55], v[16:19], v[28:35], v4
    ds_read_b128 v[28:31], v14 offset:40960
    ds_read_b128 v[32:35], v14 offset:41984
    ds_read_b64_tr_b16 v[68:69], v13 offset:9216
    ds_read_b64_tr_b16 v[70:71], v13 offset:9376
    v_smfmac_f32_16x16x64_bf16 v[56:59], v[16:19], v[80:87], v4
    ds_read_b128 v[16:19], v1 offset:6144
    s_waitcnt lgkmcnt(8)
    v_smfmac_f32_16x16x64_bf16 v[52:55], v[20:23], v[88:95], v4
    s_waitcnt lgkmcnt(3)
    v_smfmac_f32_16x16x64_bf16 v[56:59], v[20:23], v[28:35], v4
    ds_read_b128 v[28:31], v14 offset:49152
    ds_read_b128 v[32:35], v14 offset:50176
    ds_read_b128 v[20:23], v1 offset:7168
    ds_read_b64_tr_b16 v[44:45], v13 offset:14336
    ds_read_b64_tr_b16 v[46:47], v13 offset:14496
    v_smfmac_f32_16x16x64_bf16 v[52:55], v[24:27], v[96:103], v4
    s_waitcnt lgkmcnt(6)
    v_mfma_f32_16x16x32_bf16 v[36:39], v[60:63], v[68:71], 0
    v_mfma_f32_16x16x32_bf16 v[40:43], v[64:67], v[68:71], 0
    v_smfmac_f32_16x16x64_bf16 v[56:59], v[24:27], v[104:111], v4
    ds_read_b128 v[24:27], v1 offset:8192
    s_add_u32 s62, s56, 16777216
    buffer_load_dwordx4 v[60:63], v3, s[8:11], s62 offen
    v_subrev_u32 v15, 19456, v8
    v_lshrrev_b32 v15, 1, v15
    s_waitcnt lgkmcnt(6)
    s_waitcnt lgkmcnt(4)
    v_smfmac_f32_16x16x64_bf16 v[52:55], v[16:19], v[28:35], v4
    ds_read_b128 v[28:31], v14 offset:57344
    ds_read_b128 v[32:35], v14 offset:58368
    v_smfmac_f32_16x16x64_bf16 v[56:59], v[16:19], v[112:119], v4
    s_waitcnt lgkmcnt(3)
    v_mfma_f32_16x16x32_bf16 v[48:51], v[44:47], v[68:71], 0
    s_mov_b32 exec_lo, 0x33333333
    s_mov_b32 exec_hi, 0x33333333
    ds_write_b128 v8, v[36:39]
    ds_write_b128 v8, v[40:43] offset:512
    s_mov_b64 exec, -1
    v_smfmac_f32_16x16x64_bf16 v[52:55], v[20:23], v[120:127], v4
    buffer_load_dwordx4 v[64:67], v3, s[8:11], s62 offen offset:1024
    s_waitcnt lgkmcnt(2)
    v_smfmac_f32_16x16x64_bf16 v[56:59], v[20:23], v[28:35], v4
    v_add_u32 v14, 131072, v3
    ds_read_b128 v[28:31], v14 offset:0
    ds_read_b128 v[32:35], v14 offset:1024
    v_smfmac_f32_16x16x64_bf16 v[52:55], v[24:27], v[128:135], v4
    s_mov_b32 exec_lo, 0x33333333
    s_mov_b32 exec_hi, 0x33333333
    ds_write_b64 v15, v[48:49] offset:9216
    s_mov_b64 exec, -1
    s_waitcnt lgkmcnt(1)
    v_smfmac_f32_16x16x64_bf16 v[56:59], v[24:27], v[28:35], v4
    v_subrev_u32 v50, 19456, v8
    s_mov_b32 exec_lo, 0x33333333
    s_mov_b32 exec_hi, 0x33333333
    buffer_store_dwordx4 v[44:47], v50, s[8:11], s57 offen sc1
    s_mov_b64 exec, -1
    v_pk_add_f32 v[16:17], v[52:53], v[54:55]
    s_nop 1
    v_pk_add_f32 v[18:19], v[56:57], v[58:59]
    v_cvt_pk_bf16_f32 v52, v52, v53
    v_cvt_pk_bf16_f32 v24, v16, v17
    v_cvt_pk_bf16_f32 v25, v18, v19
    v_cvt_pk_bf16_f32 v53, v54, v55
    v_cvt_pk_bf16_f32 v54, v56, v57
    v_cvt_pk_bf16_f32 v55, v58, v59
    s_waitcnt lgkmcnt(0)
    s_branch rec_bk
rec_var1:
    ds_read_b128 v[52:55], v3 offset:24576
    ds_read_b128 v[56:59], v3 offset:25600
    ds_read_b128 v[28:31], v3 offset:49152
    ds_read_b128 v[32:35], v3 offset:50176
    s_cmp_eq_u32 s37, 1
    s_cbranch_scc1 rec_p0done1
    s_nop 7
    s_mov_b32 s61, 0
    s_add_u32 s63, s33, 3072
    s_add_u32 s69, s33, 6144
rec_p0poll1:
    buffer_load_dwordx4 v[16:19], v1, s[8:11], s33 offen sc1
    buffer_load_dwordx4 v[20:23], v1, s[8:11], s63 offen sc1
    buffer_load_dwordx4 v[24:27], v1, s[8:11], s69 offen sc1
    s_add_u32 s61, s61, 1
    s_cmp_gt_u32 s61, 32768
    s_cbranch_scc1 rec_timeout
    s_waitcnt vmcnt(2)
    v_max3_u32 v15, v16, v17, v18
    s_waitcnt vmcnt(1)
    v_max3_u32 v15, v15, v19, v20
    v_max3_u32 v15, v15, v21, v22
    s_waitcnt vmcnt(0)
    v_max3_u32 v15, v15, v23, v24
    v_max3_u32 v15, v15, v25, v26
    v_max_u32 v15, v15, v27
    v_cmp_eq_u32 vcc, -1, v15
    s_cbranch_vccnz rec_p0poll1
rec_p0done1:
    s_mov_b32 s37, 0
    ds_write_b128 v2, v[16:19] offset:0
    ds_write_b128 v2, v[20:23] offset:3072
    ds_write_b128 v2, v[24:27] offset:6144
    v_smfmac_f32_16x16x64_bf16 v[36:39], v[16:19], a[16:23], v4
    s_waitcnt lgkmcnt(5)
    v_smfmac_f32_16x16x64_bf16 v[40:43], v[16:19], v[52:59], v4
    v_add_u32 v14, 65536, v3
    ds_read_b128 v[52:55], v14 offset:8192
    ds_read_b128 v[56:59], v14 offset:9216
    v_smfmac_f32_16x16x64_bf16 v[44:47], v[16:19], a[96:103], v4
    v_smfmac_f32_16x16x64_bf16 v[48:51], v[16:19], a[104:111], v4
    v_smfmac_f32_16x16x64_bf16 v[36:39], v[20:23], a[40:47], v4
    s_waitcnt lgkmcnt(5)
    v_smfmac_f32_16x16x64_bf16 v[40:43], v[20:23], v[28:35], v4
    ds_read_b128 v[28:31], v3 offset:32768
    ds_read_b128 v[32:35], v3 offset:33792
    v_smfmac_f32_16x16x64_bf16 v[44:47], v[20:23], a[144:151], v4
    v_smfmac_f32_16x16x64_bf16 v[48:51], v[20:23], a[152:159], v4
    s_waitcnt lgkmcnt(4)
    s_barrier
    ds_read_b128 v[16:19], v1 offset:0
    ds_read_b128 v[20:23], v1 offset:2048
    v_smfmac_f32_16x16x64_bf16 v[36:39], v[24:27], a[64:71], v4
    s_waitcnt lgkmcnt(4)
    v_smfmac_f32_16x16x64_bf16 v[40:43], v[24:27], v[52:59], v4
    ds_read_b128 v[52:55], v3 offset:40960
    ds_read_b128 v[56:59], v3 offset:41984
    v_smfmac_f32_16x16x64_bf16 v[44:47], v[24:27], a[192:199], v4
    v_smfmac_f32_16x16x64_bf16 v[48:51], v[24:27], a[200:207], v4
    ds_read_b128 v[24:27], v1 offset:3072
    s_waitcnt lgkmcnt(4)
    v_smfmac_f32_16x16x64_bf16 v[36:39], v[16:19], a[0:7], v4
    v_smfmac_f32_16x16x64_bf16 v[40:43], v[16:19], a[8:15], v4
    v_smfmac_f32_16x16x64_bf16 v[44:47], v[16:19], a[80:87], v4
    v_smfmac_f32_16x16x64_bf16 v[48:51], v[16:19], a[88:95], v4
    ds_read_b128 v[16:19], v1 offset:5120
    s_waitcnt lgkmcnt(4)
    v_smfmac_f32_16x16x64_bf16 v[36:39], v[20:23], a[24:31], v4
    s_add_u32 s62, s56, 262144
    buffer_load_dword v0, v12, s[8:11], s62 offen
    v_smfmac_f32_16x16x64_bf16 v[40:43], v[20:23], v[28:35], v4
    ds_read_b128 v[28:31], v3 offset:57344
    ds_read_b128 v[32:35], v3 offset:58368
    v_smfmac_f32_16x16x64_bf16 v[44:47], v[20:23], a[112:119], v4
    v_smfmac_f32_16x16x64_bf16 v[48:51], v[20:23], a[120:127], v4
    ds_read_b128 v[20:23], v1 offset:6144
    s_waitcnt lgkmcnt(4)
    v_smfmac_f32_16x16x64_bf16 v[36:39], v[24:27], a[32:39], v4
    v_smfmac_f32_16x16x64_bf16 v[40:43], v[24:27], v[52:59], v4
    ds_read_b128 v[52:55], v14 offset:0
    ds_read_b128 v[56:59], v14 offset:1024
    v_smfmac_f32_16x16x64_bf16 v[44:47], v[24:27], a[128:135], v4
    v_smfmac_f32_16x16x64_bf16 v[48:51], v[24:27], a[136:143], v4
    ds_read_b128 v[24:27], v1 offset:8192
    s_waitcnt lgkmcnt(6)
    v_smfmac_f32_16x16x64_bf16 v[36:39], v[16:19], a[48:55], v4
    s_waitcnt lgkmcnt(4)
    v_smfmac_f32_16x16x64_bf16 v[40:43], v[16:19], v[28:35], v4
    ds_read_b128 v[28:31], v14 offset:16384
    ds_read_b128 v[32:35], v14 offset:17408
    v_smfmac_f32_16x16x64_bf16 v[44:47], v[16:19], a[160:167], v4
    v_smfmac_f32_16x16x64_bf16 v[48:51], v[16:19], a[168:175], v4
    ds_read_b128 v[16:19], v1 offset:0
    s_waitcnt lgkmcnt(6)
    v_smfmac_f32_16x16x64_bf16 v[36:39], v[20:23], a[56:63], v4
    s_waitcnt lgkmcnt(4)
    v_smfmac_f32_16x16x64_bf16 v[40:43], v[20:23], v[52:59], v4
    s_waitcnt lgkmcnt(3)
    v_smfmac_f32_16x16x64_bf16 v[36:39], v[24:27], a[72:79], v4
    v_mov_b64 v[52:53], 0
    s_waitcnt lgkmcnt(1)
    v_smfmac_f32_16x16x64_bf16 v[40:43], v[24:27], v[28:35], v4
    ds_read_b128 v[28:31], v14 offset:24576
    ds_read_b128 v[32:35], v14 offset:25600
    v_mov_b64 v[54:55], 0
    v_smfmac_f32_16x16x64_bf16 v[44:47], v[20:23], a[176:183], v4
    v_mov_b64 v[56:57], 0
    v_smfmac_f32_16x16x64_bf16 v[48:51], v[20:23], a[184:191], v4
    ds_read_b128 v[20:23], v1 offset:1024
    v_mov_b64 v[58:59], 0
    v_pk_add_f32 v[36:37], v[36:37], v[38:39]
    v_smfmac_f32_16x16x64_bf16 v[44:47], v[24:27], a[208:215], v4
    v_pk_add_f32 v[40:41], v[40:41], v[42:43]
    v_pk_mul_f32 v[36:37], v[36:37], s[72:73]
    v_smfmac_f32_16x16x64_bf16 v[48:51], v[24:27], a[216:223], v4
    ds_read_b128 v[24:27], v1 offset:2048
    v_pk_mul_f32 v[40:41], v[40:41], s[72:73]
    v_cvt_pk_bf16_f32 v38, v36, v37
    s_waitcnt lgkmcnt(4)
    v_smfmac_f32_16x16x64_bf16 v[52:55], v[16:19], a[224:231], v4
    v_cvt_pk_bf16_f32 v39, v36, v37
    v_cvt_pk_bf16_f32 v42, v40, v41
    ds_write_b64 v5, v[38:39]
    v_smfmac_f32_16x16x64_bf16 v[56:59], v[16:19], a[232:239], v4
    ds_read_b128 v[16:19], v1 offset:3072
    v_cvt_pk_bf16_f32 v43, v40, v41
    ds_write_b64 v5, v[42:43] offset:640
    s_waitcnt lgkmcnt(4)
    v_smfmac_f32_16x16x64_bf16 v[52:55], v[20:23], a[240:247], v4
    v_pk_add_f32 v[44:45], v[44:45], v[46:47]
    v_pk_add_f32 v[48:49], v[48:49], v[50:51]
    v_smfmac_f32_16x16x64_bf16 v[56:59], v[20:23], v[28:35], v4
    ds_read_b128 v[28:31], v14 offset:32768
    ds_read_b128 v[32:35], v14 offset:33792
    ds_read_b128 v[20:23], v1 offset:4096
    v_cvt_pk_bf16_f32 v46, v44, v45
    v_cvt_pk_bf16_f32 v47, v44, v45
    s_waitcnt lgkmcnt(6)
    v_smfmac_f32_16x16x64_bf16 v[52:55], v[24:27], a[248:255], v4
    v_cvt_pk_bf16_f32 v50, v48, v49
    ds_write_b64 v5, v[46:47] offset:5120
    v_smfmac_f32_16x16x64_bf16 v[56:59], v[24:27], v[72:79], v4
    ds_read_b128 v[24:27], v1 offset:5120
    v_cvt_pk_bf16_f32 v51, v48, v49
    ds_write_b64 v5, v[50:51] offset:5760
    s_waitcnt lgkmcnt(7)
    s_waitcnt lgkmcnt(4)
    v_smfmac_f32_16x16x64_bf16 v[52:55], v[16:19], v[28:35], v4
    ds_read_b128 v[28:31], v14 offset:40960
    ds_read_b128 v[32:35], v14 offset:41984
    ds_read_b64_tr_b16 v[68:69], v13 offset:9216
    ds_read_b64_tr_b16 v[70:71], v13 offset:9376
    v_smfmac_f32_16x16x64_bf16 v[56:59], v[16:19], v[80:87], v4
    ds_read_b128 v[16:19], v1 offset:6144
    s_waitcnt lgkmcnt(8)
    v_smfmac_f32_16x16x64_bf16 v[52:55], v[20:23], v[88:95], v4
    s_waitcnt lgkmcnt(3)
    v_smfmac_f32_16x16x64_bf16 v[56:59], v[20:23], v[28:35], v4
    ds_read_b128 v[28:31], v14 offset:49152
    ds_read_b128 v[32:35], v14 offset:50176
    ds_read_b128 v[20:23], v1 offset:7168
    ds_read_b64_tr_b16 v[44:45], v13 offset:14336
    ds_read_b64_tr_b16 v[46:47], v13 offset:14496
    v_smfmac_f32_16x16x64_bf16 v[52:55], v[24:27], v[96:103], v4
    s_waitcnt lgkmcnt(6)
    v_mfma_f32_16x16x32_bf16 v[36:39], v[60:63], v[68:71], 0
    v_mfma_f32_16x16x32_bf16 v[40:43], v[64:67], v[68:71], 0
    v_smfmac_f32_16x16x64_bf16 v[56:59], v[24:27], v[104:111], v4
    ds_read_b128 v[24:27], v1 offset:8192
    s_add_u32 s62, s56, 16777216
    buffer_load_dwordx4 v[60:63], v3, s[8:11], s62 offen
    v_subrev_u32 v15, 20608, v8
    v_lshrrev_b32 v15, 1, v15
    s_waitcnt lgkmcnt(6)
    s_waitcnt lgkmcnt(4)
    v_smfmac_f32_16x16x64_bf16 v[52:55], v[16:19], v[28:35], v4
    ds_read_b128 v[28:31], v14 offset:57344
    ds_read_b128 v[32:35], v14 offset:58368
    v_smfmac_f32_16x16x64_bf16 v[56:59], v[16:19], v[112:119], v4
    s_waitcnt lgkmcnt(3)
    v_mfma_f32_16x16x32_bf16 v[48:51], v[44:47], v[68:71], 0
    s_mov_b32 exec_lo, 0x33333333
    s_mov_b32 exec_hi, 0x33333333
    ds_write_b128 v8, v[36:39]
    ds_write_b128 v8, v[40:43] offset:512
    s_mov_b64 exec, -1
    v_smfmac_f32_16x16x64_bf16 v[52:55], v[20:23], v[120:127], v4
    buffer_load_dwordx4 v[64:67], v3, s[8:11], s62 offen offset:1024
    s_waitcnt lgkmcnt(2)
    v_smfmac_f32_16x16x64_bf16 v[56:59], v[20:23], v[28:35], v4
    v_add_u32 v14, 131072, v3
    ds_read_b128 v[28:31], v14 offset:0
    ds_read_b128 v[32:35], v14 offset:1024
    v_smfmac_f32_16x16x64_bf16 v[52:55], v[24:27], v[128:135], v4
    s_mov_b32 exec_lo, 0x33333333
    s_mov_b32 exec_hi, 0x33333333
    ds_write_b64 v15, v[48:49] offset:10496
    s_mov_b64 exec, -1
    s_waitcnt lgkmcnt(1)
    v_smfmac_f32_16x16x64_bf16 v[56:59], v[24:27], v[28:35], v4
    v_subrev_u32 v50, 20096, v8
    s_mov_b32 exec_lo, 0x33333333
    s_mov_b32 exec_hi, 0x33333333
    buffer_store_dwordx4 v[44:47], v50, s[8:11], s57 offen sc1
    s_mov_b64 exec, -1
    v_pk_add_f32 v[16:17], v[52:53], v[54:55]
    s_nop 1
    v_pk_add_f32 v[18:19], v[56:57], v[58:59]
    v_cvt_pk_bf16_f32 v52, v52, v53
    v_cvt_pk_bf16_f32 v24, v16, v17
    v_cvt_pk_bf16_f32 v25, v18, v19
    v_cvt_pk_bf16_f32 v53, v54, v55
    v_cvt_pk_bf16_f32 v54, v56, v57
    v_cvt_pk_bf16_f32 v55, v58, v59
    s_waitcnt lgkmcnt(0)
    s_branch rec_bk
rec_var2:
    ds_read_b128 v[52:55], v3 offset:32768
    ds_read_b128 v[56:59], v3 offset:33792
    ds_read_b128 v[28:31], v3 offset:57344
    ds_read_b128 v[32:35], v3 offset:58368
    s_cmp_eq_u32 s37, 1
    s_cbranch_scc1 rec_p0done2
    s_nop 7
    s_mov_b32 s61, 0
    s_add_u32 s63, s33, 3072
    s_add_u32 s69, s33, 6144
rec_p0poll2:
    buffer_load_dwordx4 v[16:19], v1, s[8:11], s33 offen sc1
    buffer_load_dwordx4 v[20:23], v1, s[8:11], s63 offen sc1
    buffer_load_dwordx4 v[24:27], v1, s[8:11], s69 offen sc1
    s_add_u32 s61, s61, 1
    s_cmp_gt_u32 s61, 32768
    s_cbranch_scc1 rec_timeout
    s_waitcnt vmcnt(2)
    v_max3_u32 v15, v16, v17, v18
    s_waitcnt vmcnt(1)
    v_max3_u32 v15, v15, v19, v20
    v_max3_u32 v15, v15, v21, v22
    s_waitcnt vmcnt(0)
    v_max3_u32 v15, v15, v23, v24
    v_max3_u32 v15, v15, v25, v26
    v_max_u32 v15, v15, v27
    v_cmp_eq_u32 vcc, -1, v15
    s_cbranch_vccnz rec_p0poll2
rec_p0done2:
    s_mov_b32 s37, 0
    ds_write_b128 v2, v[16:19] offset:0
    ds_write_b128 v2, v[20:23] offset:3072
    ds_write_b128 v2, v[24:27] offset:6144
    v_smfmac_f32_16x16x64_bf16 v[36:39], v[16:19], a[24:31], v4
    s_waitcnt lgkmcnt(5)
    v_smfmac_f32_16x16x64_bf16 v[40:43], v[16:19], v[52:59], v4
    v_add_u32 v14, 65536, v3
    ds_read_b128 v[52:55], v14 offset:16384
    ds_read_b128 v[56:59], v14 offset:17408
    v_smfmac_f32_16x16x64_bf16 v[44:47], v[16:19], a[112:119], v4
    v_smfmac_f32_16x16x64_bf16 v[48:51], v[16:19], a[120:127], v4
    v_smfmac_f32_16x16x64_bf16 v[36:39], v[20:23], a[48:55], v4
    s_waitcnt lgkmcnt(5)
    v_smfmac_f32_16x16x64_bf16 v[40:43], v[20:23], v[28:35], v4
    ds_read_b128 v[28:31], v3 offset:24576
    ds_read_b128 v[32:35], v3 offset:25600
    v_smfmac_f32_16x16x64_bf16 v[44:47], v[20:23], a[160:167], v4
    v_smfmac_f32_16x16x64_bf16 v[48:51], v[20:23], a[168:175], v4
    s_waitcnt lgkmcnt(4)
    s_barrier
    ds_read_b128 v[16:19], v1 offset:0
    ds_read_b128 v[20:23], v1 offset:1024
    v_smfmac_f32_16x16x64_bf16 v[36:39], v[24:27], a[72:79], v4
    s_waitcnt lgkmcnt(4)
    v_smfmac_f32_16x16x64_bf16 v[40:43], v[24:27], v[52:59], v4
    ds_read_b128 v[52:55], v3 offset:40960
    ds_read_b128 v[56:59], v3 offset:41984
    v_smfmac_f32_16x16x64_bf16 v[44:47], v[24:27], a[208:215], v4
    v_smfmac_f32_16x16x64_bf16 v[48:51], v[24:27], a[216:223], v4
    ds_read_b128 v[24:27], v1 offset:3072
    s_waitcnt lgkmcnt(4)
    v_smfmac_f32_16x16x64_bf16 v[36:39], v[16:19], a[0:7], v4
    v_smfmac_f32_16x16x64_bf16 v[40:43], v[16:19], a[8:15], v4
    v_smfmac_f32_16x16x64_bf16 v[44:47], v[16:19], a[80:87], v4
    v_smfmac_f32_16x16x64_bf16 v[48:51], v[16:19], a[88:95], v4
    ds_read_b128 v[16:19], v1 offset:4096
    s_waitcnt lgkmcnt(4)
    v_smfmac_f32_16x16x64_bf16 v[36:39], v[20:23], a[16:23], v4
    v_smfmac_f32_16x16x64_bf16 v[40:43], v[20:23], v[28:35], v4
    ds_read_b128 v[28:31], v3 offset:49152
    ds_read_b128 v[32:35], v3 offset:50176
    v_smfmac_f32_16x16x64_bf16 v[44:47], v[20:23], a[96:103], v4
    v_smfmac_f32_16x16x64_bf16 v[48:51], v[20:23], a[104:111], v4
    ds_read_b128 v[20:23], v1 offset:6144
    s_waitcnt lgkmcnt(4)
    v_smfmac_f32_16x16x64_bf16 v[36:39], v[24:27], a[32:39], v4
    s_add_u32 s62, s56, 262144
    buffer_load_dword v0, v12, s[8:11], s62 offen
    v_smfmac_f32_16x16x64_bf16 v[40:43], v[24:27], v[52:59], v4
    ds_read_b128 v[52:55], v14 offset:0
    ds_read_b128 v[56:59], v14 offset:1024
    v_smfmac_f32_16x16x64_bf16 v[44:47], v[24:27], a[128:135], v4
    v_smfmac_f32_16x16x64_bf16 v[48:51], v[24:27], a[136:143], v4
    ds_read_b128 v[24:27], v1 offset:7168
    s_waitcnt lgkmcnt(6)
    v_smfmac_f32_16x16x64_bf16 v[36:39], v[16:19], a[40:47], v4
    s_waitcnt lgkmcnt(4)
    v_smfmac_f32_16x16x64_bf16 v[40:43], v[16:19], v[28:35], v4
    ds_read_b128 v[28:31], v14 offset:8192
    ds_read_b128 v[32:35], v14 offset:9216
    v_smfmac_f32_16x16x64_bf16 v[44:47], v[16:19], a[144:151], v4
    v_smfmac_f32_16x16x64_bf16 v[48:51], v[16:19], a[152:159], v4
    ds_read_b128 v[16:19], v1 offset:0
    s_waitcnt lgkmcnt(6)
    v_smfmac_f32_16x16x64_bf16 v[36:39], v[20:23], a[56:63], v4
    s_waitcnt lgkmcnt(4)
    v_smfmac_f32_16x16x64_bf16 v[40:43], v[20:23], v[52:59], v4
    s_waitcnt lgkmcnt(3)
    v_smfmac_f32_16x16x64_bf16 v[36:39], v[24:27], a[64:71], v4
    v_mov_b64 v[52:53], 0
    s_waitcnt lgkmcnt(1)
    v_smfmac_f32_16x16x64_bf16 v[40:43], v[24:27], v[28:35], v4
    ds_read_b128 v[28:31], v14 offset:24576
    ds_read_b128 v[32:35], v14 offset:25600
    v_mov_b64 v[54:55], 0
    v_smfmac_f32_16x16x64_bf16 v[44:47], v[20:23], a[176:183], v4
    v_mov_b64 v[56:57], 0
    v_smfmac_f32_16x16x64_bf16 v[48:51], v[20:23], a[184:191], v4
    ds_read_b128 v[20:23], v1 offset:1024
    v_mov_b64 v[58:59], 0
    v_pk_add_f32 v[36:37], v[36:37], v[38:39]
    v_smfmac_f32_16x16x64_bf16 v[44:47], v[24:27], a[192:199], v4
    v_pk_add_f32 v[40:41], v[40:41], v[42:43]
    v_pk_mul_f32 v[36:37], v[36:37], s[72:73]
    v_smfmac_f32_16x16x64_bf16 v[48:51], v[24:27], a[200:207], v4
    ds_read_b128 v[24:27], v1 offset:2048
    v_pk_mul_f32 v[40:41], v[40:41], s[72:73]
    v_cvt_pk_bf16_f32 v38, v36, v37
    s_waitcnt lgkmcnt(4)
    v_smfmac_f32_16x16x64_bf16 v[52:55], v[16:19], a[224:231], v4
    v_cvt_pk_bf16_f32 v39, v36, v37
    v_cvt_pk_bf16_f32 v42, v40, v41
    ds_write_b64 v5, v[38:39]
    v_smfmac_f32_16x16x64_bf16 v[56:59], v[16:19], a[232:239], v4
    ds_read_b128 v[16:19], v1 offset:3072
    v_cvt_pk_bf16_f32 v43, v40, v41
    ds_write_b64 v5, v[42:43] offset:640
    s_waitcnt lgkmcnt(4)
    v_smfmac_f32_16x16x64_bf16 v[52:55], v[20:23], a[240:247], v4
    v_pk_add_f32 v[44:45], v[44:45], v[46:47]
    v_pk_add_f32 v[48:49], v[48:49], v[50:51]
    v_smfmac_f32_16x16x64_bf16 v[56:59], v[20:23], v[28:35], v4
    ds_read_b128 v[28:31], v14 offset:32768
    ds_read_b128 v[32:35], v14 offset:33792
    ds_read_b128 v[20:23], v1 offset:4096
    v_cvt_pk_bf16_f32 v46, v44, v45
    v_cvt_pk_bf16_f32 v47, v44, v45
    s_waitcnt lgkmcnt(6)
    v_smfmac_f32_16x16x64_bf16 v[52:55], v[24:27], a[248:255], v4
    v_cvt_pk_bf16_f32 v50, v48, v49
    ds_write_b64 v5, v[46:47] offset:5120
    v_smfmac_f32_16x16x64_bf16 v[56:59], v[24:27], v[72:79], v4
    ds_read_b128 v[24:27], v1 offset:5120
    v_cvt_pk_bf16_f32 v51, v48, v49
    ds_write_b64 v5, v[50:51] offset:5760
    s_waitcnt lgkmcnt(7)
    s_waitcnt lgkmcnt(4)
    v_smfmac_f32_16x16x64_bf16 v[52:55], v[16:19], v[28:35], v4
    ds_read_b128 v[28:31], v14 offset:40960
    ds_read_b128 v[32:35], v14 offset:41984
    ds_read_b64_tr_b16 v[68:69], v13 offset:9216
    ds_read_b64_tr_b16 v[70:71], v13 offset:9376
    v_smfmac_f32_16x16x64_bf16 v[56:59], v[16:19], v[80:87], v4
    ds_read_b128 v[16:19], v1 offset:6144
    s_waitcnt lgkmcnt(8)
    v_smfmac_f32_16x16x64_bf16 v[52:55], v[20:23], v[88:95], v4
    s_waitcnt lgkmcnt(3)
    v_smfmac_f32_16x16x64_bf16 v[56:59], v[20:23], v[28:35], v4
    ds_read_b128 v[28:31], v14 offset:49152
    ds_read_b128 v[32:35], v14 offset:50176
    ds_read_b128 v[20:23], v1 offset:7168
    ds_read_b64_tr_b16 v[44:45], v13 offset:14336
    ds_read_b64_tr_b16 v[46:47], v13 offset:14496
    v_smfmac_f32_16x16x64_bf16 v[52:55], v[24:27], v[96:103], v4
    s_waitcnt lgkmcnt(6)
    v_mfma_f32_16x16x32_bf16 v[36:39], v[60:63], v[68:71], 0
    v_mfma_f32_16x16x32_bf16 v[40:43], v[64:67], v[68:71], 0
    v_smfmac_f32_16x16x64_bf16 v[56:59], v[24:27], v[104:111], v4
    ds_read_b128 v[24:27], v1 offset:8192
    s_add_u32 s62, s56, 16777216
    buffer_load_dwordx4 v[60:63], v3, s[8:11], s62 offen
    v_subrev_u32 v15, 21760, v8
    v_lshrrev_b32 v15, 1, v15
    s_waitcnt lgkmcnt(6)
    s_waitcnt lgkmcnt(4)
    v_smfmac_f32_16x16x64_bf16 v[52:55], v[16:19], v[28:35], v4
    ds_read_b128 v[28:31], v14 offset:57344
    ds_read_b128 v[32:35], v14 offset:58368
    v_smfmac_f32_16x16x64_bf16 v[56:59], v[16:19], v[112:119], v4
    s_waitcnt lgkmcnt(3)
    v_mfma_f32_16x16x32_bf16 v[48:51], v[44:47], v[68:71], 0
    s_mov_b32 exec_lo, 0x33333333
    s_mov_b32 exec_hi, 0x33333333
    ds_write_b128 v8, v[36:39]
    ds_write_b128 v8, v[40:43] offset:512
    s_mov_b64 exec, -1
    v_smfmac_f32_16x16x64_bf16 v[52:55], v[20:23], v[120:127], v4
    buffer_load_dwordx4 v[64:67], v3, s[8:11], s62 offen offset:1024
    s_waitcnt lgkmcnt(2)
    v_smfmac_f32_16x16x64_bf16 v[56:59], v[20:23], v[28:35], v4
    v_add_u32 v14, 131072, v3
    ds_read_b128 v[28:31], v14 offset:0
    ds_read_b128 v[32:35], v14 offset:1024
    v_smfmac_f32_16x16x64_bf16 v[52:55], v[24:27], v[128:135], v4
    s_mov_b32 exec_lo, 0x33333333
    s_mov_b32 exec_hi, 0x33333333
    ds_write_b64 v15, v[48:49] offset:11776
    s_mov_b64 exec, -1
    s_waitcnt lgkmcnt(1)
    v_smfmac_f32_16x16x64_bf16 v[56:59], v[24:27], v[28:35], v4
    v_subrev_u32 v50, 20736, v8
    s_mov_b32 exec_lo, 0x33333333
    s_mov_b32 exec_hi, 0x33333333
    buffer_store_dwordx4 v[44:47], v50, s[8:11], s57 offen sc1
    s_mov_b64 exec, -1
    v_pk_add_f32 v[16:17], v[52:53], v[54:55]
    s_nop 1
    v_pk_add_f32 v[18:19], v[56:57], v[58:59]
    v_cvt_pk_bf16_f32 v52, v52, v53
    v_cvt_pk_bf16_f32 v24, v16, v17
    v_cvt_pk_bf16_f32 v25, v18, v19
    v_cvt_pk_bf16_f32 v53, v54, v55
    v_cvt_pk_bf16_f32 v54, v56, v57
    v_cvt_pk_bf16_f32 v55, v58, v59
    s_waitcnt lgkmcnt(0)
    s_branch rec_bk
rec_var3:
    ds_read_b128 v[52:55], v3 offset:40960
    ds_read_b128 v[56:59], v3 offset:41984
    v_add_u32 v14, 65536, v3
    ds_read_b128 v[28:31], v14 offset:0
    ds_read_b128 v[32:35], v14 offset:1024
    s_cmp_eq_u32 s37, 1
    s_cbranch_scc1 rec_p0done3
    s_nop 7
    s_mov_b32 s61, 0
    s_add_u32 s63, s33, 3072
    s_add_u32 s69, s33, 6144
rec_p0poll3:
    buffer_load_dwordx4 v[16:19], v1, s[8:11], s33 offen sc1
    buffer_load_dwordx4 v[20:23], v1, s[8:11], s63 offen sc1
    buffer_load_dwordx4 v[24:27], v1, s[8:11], s69 offen sc1
    s_add_u32 s61, s61, 1
    s_cmp_gt_u32 s61, 32768
    s_cbranch_scc1 rec_timeout
    s_waitcnt vmcnt(2)
    v_max3_u32 v15, v16, v17, v18
    s_waitcnt vmcnt(1)
    v_max3_u32 v15, v15, v19, v20
    v_max3_u32 v15, v15, v21, v22
    s_waitcnt vmcnt(0)
    v_max3_u32 v15, v15, v23, v24
    v_max3_u32 v15, v15, v25, v26
    v_max_u32 v15, v15, v27
    v_cmp_eq_u32 vcc, -1, v15
    s_cbranch_vccnz rec_p0poll3
rec_p0done3:
    s_mov_b32 s37, 0
    v_smfmac_f32_16x16x64_bf16 v[36:39], v[16:19], a[0:7], v4
    v_smfmac_f32_16x16x64_bf16 v[40:43], v[16:19], a[8:15], v4
    v_smfmac_f32_16x16x64_bf16 v[44:47], v[16:19], a[80:87], v4
    v_smfmac_f32_16x16x64_bf16 v[48:51], v[16:19], a[88:95], v4
    v_smfmac_f32_16x16x64_bf16 v[36:39], v[20:23], a[32:39], v4
    s_waitcnt lgkmcnt(2)
    v_smfmac_f32_16x16x64_bf16 v[40:43], v[20:23], v[52:59], v4
    ds_read_b128 v[52:55], v3 offset:24576
    ds_read_b128 v[56:59], v3 offset:25600
    v_smfmac_f32_16x16x64_bf16 v[44:47], v[20:23], a[128:135], v4
    v_smfmac_f32_16x16x64_bf16 v[48:51], v[20:23], a[136:143], v4
    s_barrier
    ds_read_b128 v[16:19], v1 offset:1024
    ds_read_b128 v[20:23], v1 offset:2048
    v_smfmac_f32_16x16x64_bf16 v[36:39], v[24:27], a[56:63], v4
    s_waitcnt lgkmcnt(4)
    v_smfmac_f32_16x16x64_bf16 v[40:43], v[24:27], v[28:35], v4
    ds_read_b128 v[28:31], v3 offset:32768
    ds_read_b128 v[32:35], v3 offset:33792
    v_mov_b32 v68, s50
    v_mov_b32 v69, 0
    s_add_u32 s62, s64, 12288
    buffer_store_dword v68, v69, s[8:11], s62 offen sc1
    v_smfmac_f32_16x16x64_bf16 v[44:47], v[24:27], a[176:183], v4
    v_smfmac_f32_16x16x64_bf16 v[48:51], v[24:27], a[184:191], v4
    ds_read_b128 v[24:27], v1 offset:4096
    s_waitcnt lgkmcnt(4)
    v_smfmac_f32_16x16x64_bf16 v[36:39], v[16:19], a[16:23], v4
    v_smfmac_f32_16x16x64_bf16 v[40:43], v[16:19], v[52:59], v4
    ds_read_b128 v[52:55], v3 offset:49152
    ds_read_b128 v[56:59], v3 offset:50176
    v_smfmac_f32_16x16x64_bf16 v[44:47], v[16:19], a[96:103], v4
    v_smfmac_f32_16x16x64_bf16 v[48:51], v[16:19], a[104:111], v4
    ds_read_b128 v[16:19], v1 offset:5120
    s_waitcnt lgkmcnt(6)
    v_smfmac_f32_16x16x64_bf16 v[36:39], v[20:23], a[24:31], v4
    s_waitcnt lgkmcnt(4)
    v_smfmac_f32_16x16x64_bf16 v[40:43], v[20:23], v[28:35], v4
    ds_read_b128 v[28:31], v3 offset:57344
    ds_read_b128 v[32:35], v3 offset:58368
    v_smfmac_f32_16x16x64_bf16 v[44:47], v[20:23], a[112:119], v4
    v_smfmac_f32_16x16x64_bf16 v[48:51], v[20:23], a[120:127], v4
    ds_read_b128 v[20:23], v1 offset:7168
    s_waitcnt lgkmcnt(6)
    v_smfmac_f32_16x16x64_bf16 v[36:39], v[24:27], a[40:47], v4
    s_waitcnt lgkmcnt(4)
    v_smfmac_f32_16x16x64_bf16 v[40:43], v[24:27], v[52:59], v4
    ds_read_b128 v[52:55], v14 offset:8192
    ds_read_b128 v[56:59], v14 offset:9216
    v_smfmac_f32_16x16x64_bf16 v[44:47], v[24:27], a[144:151], v4
    v_smfmac_f32_16x16x64_bf16 v[48:51], v[24:27], a[152:159], v4
    ds_read_b128 v[24:27], v1 offset:8192
    s_waitcnt lgkmcnt(6)
    v_smfmac_f32_16x16x64_bf16 v[36:39], v[16:19], a[48:55], v4
    s_add_u32 s62, s56, 262144
    buffer_load_dword v0, v12, s[8:11], s62 offen
    s_waitcnt lgkmcnt(4)
    v_smfmac_f32_16x16x64_bf16 v[40:43], v[16:19], v[28:35], v4
    ds_read_b128 v[28:31], v14 offset:16384
    ds_read_b128 v[32:35], v14 offset:17408
    v_smfmac_f32_16x16x64_bf16 v[44:47], v[16:19], a[160:167], v4
    v_smfmac_f32_16x16x64_bf16 v[48:51], v[16:19], a[168:175], v4
    ds_read_b128 v[16:19], v1 offset:0
    s_waitcnt lgkmcnt(6)
    v_smfmac_f32_16x16x64_bf16 v[36:39], v[20:23], a[64:71], v4
    s_waitcnt lgkmcnt(4)
    v_smfmac_f32_16x16x64_bf16 v[40:43], v[20:23], v[52:59], v4
    s_waitcnt lgkmcnt(3)
    v_smfmac_f32_16x16x64_bf16 v[36:39], v[24:27], a[72:79], v4
    v_mov_b64 v[52:53], 0
    s_waitcnt lgkmcnt(1)
    v_smfmac_f32_16x16x64_bf16 v[40:43], v[24:27], v[28:35], v4
    ds_read_b128 v[28:31], v14 offset:24576
    ds_read_b128 v[32:35], v14 offset:25600
    v_mov_b64 v[54:55], 0
    v_smfmac_f32_16x16x64_bf16 v[44:47], v[20:23], a[192:199], v4
    v_mov_b64 v[56:57], 0
    v_smfmac_f32_16x16x64_bf16 v[48:51], v[20:23], a[200:207], v4
    ds_read_b128 v[20:23], v1 offset:1024
    v_mov_b64 v[58:59], 0
    v_pk_add_f32 v[36:37], v[36:37], v[38:39]
    v_smfmac_f32_16x16x64_bf16 v[44:47], v[24:27], a[208:215], v4
    v_pk_add_f32 v[40:41], v[40:41], v[42:43]
    v_pk_mul_f32 v[36:37], v[36:37], s[72:73]
    v_smfmac_f32_16x16x64_bf16 v[48:51], v[24:27], a[216:223], v4
    ds_read_b128 v[24:27], v1 offset:2048
    v_pk_mul_f32 v[40:41], v[40:41], s[72:73]
    v_cvt_pk_bf16_f32 v38, v36, v37
    s_waitcnt lgkmcnt(4)
    v_smfmac_f32_16x16x64_bf16 v[52:55], v[16:19], a[224:231], v4
    v_cvt_pk_bf16_f32 v39, v36, v37
    v_cvt_pk_bf16_f32 v42, v40, v41
    ds_write_b64 v5, v[38:39]
    v_smfmac_f32_16x16x64_bf16 v[56:59], v[16:19], a[232:239], v4
    ds_read_b128 v[16:19], v1 offset:3072
    v_cvt_pk_bf16_f32 v43, v40, v41
    ds_write_b64 v5, v[42:43] offset:640
    s_waitcnt lgkmcnt(4)
    v_smfmac_f32_16x16x64_bf16 v[52:55], v[20:23], a[240:247], v4
    v_pk_add_f32 v[44:45], v[44:45], v[46:47]
    v_pk_add_f32 v[48:49], v[48:49], v[50:51]
    v_smfmac_f32_16x16x64_bf16 v[56:59], v[20:23], v[28:35], v4
    ds_read_b128 v[28:31], v14 offset:32768
    ds_read_b128 v[32:35], v14 offset:33792
    ds_read_b128 v[20:23], v1 offset:4096
    v_cvt_pk_bf16_f32 v46, v44, v45
    v_cvt_pk_bf16_f32 v47, v44, v45
    s_waitcnt lgkmcnt(6)
    v_smfmac_f32_16x16x64_bf16 v[52:55], v[24:27], a[248:255], v4
    v_cvt_pk_bf16_f32 v50, v48, v49
    ds_write_b64 v5, v[46:47] offset:5120
    v_smfmac_f32_16x16x64_bf16 v[56:59], v[24:27], v[72:79], v4
    ds_read_b128 v[24:27], v1 offset:5120
    v_cvt_pk_bf16_f32 v51, v48, v49
    ds_write_b64 v5, v[50:51] offset:5760
    s_waitcnt lgkmcnt(7)
    s_waitcnt lgkmcnt(4)
    v_smfmac_f32_16x16x64_bf16 v[52:55], v[16:19], v[28:35], v4
    ds_read_b128 v[28:31], v14 offset:40960
    ds_read_b128 v[32:35], v14 offset:41984
    ds_read_b64_tr_b16 v[68:69], v13 offset:9216
    ds_read_b64_tr_b16 v[70:71], v13 offset:9376
    v_smfmac_f32_16x16x64_bf16 v[56:59], v[16:19], v[80:87], v4
    ds_read_b128 v[16:19], v1 offset:6144
    s_waitcnt lgkmcnt(8)
    v_smfmac_f32_16x16x64_bf16 v[52:55], v[20:23], v[88:95], v4
    s_waitcnt lgkmcnt(3)
    v_smfmac_f32_16x16x64_bf16 v[56:59], v[20:23], v[28:35], v4
    ds_read_b128 v[28:31], v14 offset:49152
    ds_read_b128 v[32:35], v14 offset:50176
    ds_read_b128 v[20:23], v1 offset:7168
    ds_read_b64_tr_b16 v[44:45], v13 offset:14336
    ds_read_b64_tr_b16 v[46:47], v13 offset:14496
    v_smfmac_f32_16x16x64_bf16 v[52:55], v[24:27], v[96:103], v4
    s_waitcnt lgkmcnt(6)
    v_mfma_f32_16x16x32_bf16 v[36:39], v[60:63], v[68:71], 0
    v_mfma_f32_16x16x32_bf16 v[40:43], v[64:67], v[68:71], 0
    v_smfmac_f32_16x16x64_bf16 v[56:59], v[24:27], v[104:111], v4
    ds_read_b128 v[24:27], v1 offset:8192
    s_add_u32 s62, s56, 16777216
    buffer_load_dwordx4 v[60:63], v3, s[8:11], s62 offen
    v_subrev_u32 v15, 22912, v8
    v_lshrrev_b32 v15, 1, v15
    s_waitcnt lgkmcnt(6)
    s_waitcnt lgkmcnt(4)
    v_smfmac_f32_16x16x64_bf16 v[52:55], v[16:19], v[28:35], v4
    ds_read_b128 v[28:31], v14 offset:57344
    ds_read_b128 v[32:35], v14 offset:58368
    v_smfmac_f32_16x16x64_bf16 v[56:59], v[16:19], v[112:119], v4
    s_waitcnt lgkmcnt(3)
    v_mfma_f32_16x16x32_bf16 v[48:51], v[44:47], v[68:71], 0
    s_mov_b32 exec_lo, 0x33333333
    s_mov_b32 exec_hi, 0x33333333
    ds_write_b128 v8, v[36:39]
    ds_write_b128 v8, v[40:43] offset:512
    s_mov_b64 exec, -1
    v_smfmac_f32_16x16x64_bf16 v[52:55], v[20:23], v[120:127], v4
    buffer_load_dwordx4 v[64:67], v3, s[8:11], s62 offen offset:1024
    s_waitcnt lgkmcnt(2)
    v_smfmac_f32_16x16x64_bf16 v[56:59], v[20:23], v[28:35], v4
    v_add_u32 v14, 131072, v3
    ds_read_b128 v[28:31], v14 offset:0
    ds_read_b128 v[32:35], v14 offset:1024
    v_smfmac_f32_16x16x64_bf16 v[52:55], v[24:27], v[128:135], v4
    s_mov_b32 exec_lo, 0x33333333
    s_mov_b32 exec_hi, 0x33333333
    ds_write_b64 v15, v[48:49] offset:13056
    s_mov_b64 exec, -1
    s_waitcnt lgkmcnt(1)
    v_smfmac_f32_16x16x64_bf16 v[56:59], v[24:27], v[28:35], v4
    v_subrev_u32 v50, 21376, v8
    s_mov_b32 exec_lo, 0x33333333
    s_mov_b32 exec_hi, 0x33333333
    buffer_store_dwordx4 v[44:47], v50, s[8:11], s57 offen sc1
    s_mov_b64 exec, -1
    v_pk_add_f32 v[16:17], v[52:53], v[54:55]
    s_nop 1
    v_pk_add_f32 v[18:19], v[56:57], v[58:59]
    v_cvt_pk_bf16_f32 v52, v52, v53
    v_cvt_pk_bf16_f32 v24, v16, v17
    v_cvt_pk_bf16_f32 v25, v18, v19
    v_cvt_pk_bf16_f32 v53, v54, v55
    v_cvt_pk_bf16_f32 v54, v56, v57
    v_cvt_pk_bf16_f32 v55, v58, v59
    s_waitcnt lgkmcnt(0)
rec_bk:
    s_barrier
    s_cmp_eq_u32 s50, 63
    s_cbranch_scc1 rec_last
    ds_read_b128 v[36:39], v9
    ds_read_b128 v[16:19], v9 offset:2304
    ds_read_b128 v[40:43], v9 offset:512
    ds_read_b128 v[20:23], v9 offset:2816
    v_subrev_u32 v14, 19456, v8
    s_mul_i32 s62, s22, 1152
    v_subrev_u32 v14, s62, v14
    v_lshrrev_b32 v14, 1, v14
    v_and_b32 v15, 32, v1
    v_mad_u32_u24 v14, v15, 40, v14
    ds_read_b64 v[68:69], v14 offset:9216
    ds_read_b64 v[70:71], v14 offset:11776
    s_waitcnt lgkmcnt(4)
    v_pk_add_f32 v[36:37], v[36:37], v[16:17]
    v_pk_add_f32 v[38:39], v[38:39], v[18:19]
    s_waitcnt lgkmcnt(2)
    v_pk_add_f32 v[40:41], v[40:41], v[20:21]
    v_pk_add_f32 v[42:43], v[42:43], v[22:23]
    v_add_f32_dpp v36, v36, v36 quad_perm:[2,3,0,1] row_mask:0xf bank_mask:0xf
    v_add_f32_dpp v37, v37, v37 quad_perm:[2,3,0,1] row_mask:0xf bank_mask:0xf
    v_add_f32_dpp v38, v38, v38 quad_perm:[2,3,0,1] row_mask:0xf bank_mask:0xf
    v_add_f32_dpp v39, v39, v39 quad_perm:[2,3,0,1] row_mask:0xf bank_mask:0xf
    s_waitcnt lgkmcnt(0)
    v_pk_add_f32 v[68:69], v[68:69], v[70:71]
    v_add_f32_dpp v40, v40, v40 quad_perm:[2,3,0,1] row_mask:0xf bank_mask:0xf
    v_add_f32_dpp v41, v41, v41 quad_perm:[2,3,0,1] row_mask:0xf bank_mask:0xf
    v_add_f32_dpp v42, v42, v42 quad_perm:[2,3,0,1] row_mask:0xf bank_mask:0xf
    v_add_f32_dpp v43, v43, v43 quad_perm:[2,3,0,1] row_mask:0xf bank_mask:0xf
    v_add_f32_dpp v68, v68, v68 quad_perm:[2,3,0,1] row_mask:0xf bank_mask:0xf
    v_add_f32_dpp v69, v69, v69 quad_perm:[2,3,0,1] row_mask:0xf bank_mask:0xf
    v_max3_f32 v14, v36, v37, v38
    v_max3_f32 v14, v14, v39, v40
    v_max3_f32 v14, v14, v41, v42
    v_max3_f32 v14, v14, v43, v68
    v_max_f32 v14, v14, v69
    v_mov_b32 v15, v14
    s_add_u32 s63, s57, 8388608
    v_lshrrev_b32 v26, 1, v2
    buffer_store_dwordx2 v[24:25], v26, s[8:11], s63 offen sc1
    v_permlane32_swap_b32 v14, v15
    v_max_f32 v14, v14, v15
    v_mov_b32 v15, v14
    v_mov_b64 v[16:17], s[98:99]
    v_mov_b64 v[18:19], s[98:99]
    v_permlane16_swap_b32 v14, v15
    v_max_f32 v14, v14, v15
    v_mov_b64 v[20:21], s[100:101]
    v_pk_add_f32 v[68:69], v[68:69], v[14:15] op_sel_hi:[1,0] neg_lo:[0,1] neg_hi:[0,1]
    v_pk_add_f32 v[36:37], v[36:37], v[14:15] op_sel_hi:[1,0] neg_lo:[0,1] neg_hi:[0,1]
    v_pk_add_f32 v[38:39], v[38:39], v[14:15] op_sel_hi:[1,0] neg_lo:[0,1] neg_hi:[0,1]
    v_pk_add_f32 v[40:41], v[40:41], v[14:15] op_sel_hi:[1,0] neg_lo:[0,1] neg_hi:[0,1]
    v_pk_add_f32 v[42:43], v[42:43], v[14:15] op_sel_hi:[1,0] neg_lo:[0,1] neg_hi:[0,1]
    v_exp_f32 v68, v68
    v_exp_f32 v69, v69
    v_exp_f32 v36, v36
    v_exp_f32 v37, v37
    v_cvt_pk_bf16_f32 v48, v68, v69
    v_cvt_pk_bf16_f32 v49, v68, v69
    v_exp_f32 v38, v38
    v_exp_f32 v39, v39
    v_cvt_pk_bf16_f32 v44, v36, v37
    v_exp_f32 v40, v40
    v_exp_f32 v41, v41
    v_cvt_pk_bf16_f32 v45, v38, v39
    v_exp_f32 v42, v42
    v_exp_f32 v43, v43
    v_cvt_pk_bf16_f32 v46, v40, v41
    v_mfma_f32_16x16x16_bf16 v[68:71], v[48:49], v[20:21], 0
    v_cvt_pk_bf16_f32 v47, v42, v43
    s_waitcnt vmcnt(2)
    v_mfma_f32_16x16x16_bf16 v[36:39], v[48:49], v[52:53], 0
    v_mfma_f32_16x16x32_bf16 v[68:71], v[44:47], v[16:19], v[68:71]
    v_mfma_f32_16x16x16_bf16 v[40:43], v[48:49], v[54:55], 0
    v_mfma_f32_16x16x32_bf16 v[36:39], v[44:47], v[60:63], v[36:39]
    v_mfma_f32_16x16x32_bf16 v[40:43], v[44:47], v[64:67], v[40:43]
    v_mov_b64 v[44:45], 0
    v_mov_b64 v[46:47], 0
    v_mov_b64 v[48:49], 0
    v_mov_b64 v[50:51], 0
    v_mov_b64 v[52:53], 0
    v_mov_b64 v[54:55], 0
    v_mov_b64 v[56:57], 0
    v_mov_b64 v[58:59], 0
    v_mov_b64 v[60:61], 0
    v_mov_b64 v[62:63], 0
    v_mov_b64 v[64:65], 0
    v_mov_b64 v[66:67], 0
    v_rcp_f32 v68, v68
    v_rcp_f32 v69, v69
    v_and_b32 v14, 0xf0, v1
    v_lshrrev_b32 v14, 1, v14
    v_and_b32 v15, 0x300, v1
    v_or_b32 v15, v14, v15
    v_pk_mul_f32 v[36:37], v[36:37], v[68:69]
    v_pk_mul_f32 v[40:41], v[40:41], v[68:69]
    v_cvt_pk_bf16_f32 v70, v36, v37
    ds_write_b32 v7, v70
    v_cvt_pk_bf16_f32 v71, v40, v41
    ds_write_b32 v7, v71 offset:256
    v_mov_b64 v[36:37], 0
    v_mov_b64 v[38:39], 0
    v_mov_b64 v[40:41], 0
    v_mov_b64 v[42:43], 0
    v_mov_b64 v[68:69], 0
    v_mov_b64 v[70:71], 0
    s_waitcnt lgkmcnt(0)
    s_barrier
    ds_read_b64_tr_b16 v[16:17], v15 offset:19456
    ds_read_b64_tr_b16 v[18:19], v15 offset:19584
    ds_read_b64_tr_b16 v[20:21], v15 offset:20480
    ds_read_b64_tr_b16 v[22:23], v15 offset:20608
    v_add_u32 v14, 131072, v3
    ds_read_b128 v[28:31], v14 offset:8192
    ds_read_b128 v[32:35], v14 offset:9216
    v_lshrrev_b32 v15, 2, v2
    v_lshl_add_u32 v15, v15, 1, v15
    s_add_u32 s55, s65, s54
    s_waitcnt lgkmcnt(4)
    v_smfmac_f32_16x16x64_bf16 v[36:39], v[16:19], v[136:143], v4
    s_waitcnt lgkmcnt(2)
    v_smfmac_f32_16x16x64_bf16 v[36:39], v[20:23], v[144:151], v4
    v_smfmac_f32_16x16x64_bf16 v[40:43], v[16:19], v[152:159], v4
    v_smfmac_f32_16x16x64_bf16 v[40:43], v[20:23], v[160:167], v4
    v_pk_add_f32 v[36:37], v[36:37], v[38:39]
    s_waitcnt lgkmcnt(0)
    v_smfmac_f32_16x16x64_bf16 v[44:47], v[16:19], v[28:35], v4
    ds_read_b128 v[28:31], v14 offset:16384
    ds_read_b128 v[32:35], v14 offset:17408
    v_cvt_pk_bf16_f32 v36, v36, v37
    v_smfmac_f32_16x16x64_bf16 v[44:47], v[20:23], v[168:175], v4
    v_pk_add_f32 v[40:41], v[40:41], v[42:43]
    v_smfmac_f32_16x16x64_bf16 v[48:51], v[16:19], v[176:183], v4
    v_cvt_pk_bf16_f32 v37, v40, v41
    v_smfmac_f32_16x16x64_bf16 v[48:51], v[20:23], v[184:191], v4
    v_pk_add_f32 v[44:45], v[44:45], v[46:47]
    v_smfmac_f32_16x16x64_bf16 v[52:55], v[16:19], v[192:199], v4
    v_cvt_pk_bf16_f32 v38, v44, v45
    buffer_store_dwordx3 v[36:38], v15, s[8:11], s55 offen
    s_add_u32 s55, s55, 3072
    s_waitcnt lgkmcnt(0)
    v_smfmac_f32_16x16x64_bf16 v[52:55], v[20:23], v[28:35], v4
    ds_read_b128 v[28:31], v14 offset:24576
    ds_read_b128 v[32:35], v14 offset:25600
    v_pk_add_f32 v[48:49], v[48:49], v[50:51]
    v_smfmac_f32_16x16x64_bf16 v[56:59], v[16:19], v[200:207], v4
    v_cvt_pk_bf16_f32 v48, v48, v49
    v_smfmac_f32_16x16x64_bf16 v[56:59], v[20:23], v[208:215], v4
    v_pk_add_f32 v[52:53], v[52:53], v[54:55]
    v_smfmac_f32_16x16x64_bf16 v[60:63], v[16:19], v[216:223], v4
    v_cvt_pk_bf16_f32 v49, v52, v53
    v_smfmac_f32_16x16x64_bf16 v[60:63], v[20:23], v[224:231], v4
    v_pk_add_f32 v[56:57], v[56:57], v[58:59]
    s_waitcnt lgkmcnt(0)
    v_smfmac_f32_16x16x64_bf16 v[64:67], v[16:19], v[28:35], v4
    v_cvt_pk_bf16_f32 v50, v56, v57
    buffer_store_dwordx3 v[48:50], v15, s[8:11], s55 offen
    s_add_u32 s55, s55, 3072
    v_smfmac_f32_16x16x64_bf16 v[64:67], v[20:23], v[232:239], v4
    v_pk_add_f32 v[60:61], v[60:61], v[62:63]
    v_smfmac_f32_16x16x64_bf16 v[68:71], v[16:19], v[240:247], v4
    v_cvt_pk_bf16_f32 v60, v60, v61
    v_smfmac_f32_16x16x64_bf16 v[68:71], v[20:23], v[248:255], v4
    v_pk_add_f32 v[64:65], v[64:65], v[66:67]
    v_cvt_pk_bf16_f32 v61, v64, v65
    s_nop 5
    v_pk_add_f32 v[68:69], v[68:69], v[70:71]
    v_cvt_pk_bf16_f32 v62, v68, v69
    buffer_store_dwordx3 v[60:62], v15, s[8:11], s55 offen
    s_cmp_eq_u32 s22, 3
    s_cbranch_scc1 rec_w3tail
    s_add_u32 s62, s54, 71303168
    s_add_u32 s63, s62, 73728
    s_add_u32 s67, s62, 147456
    s_add_u32 s69, s62, 221184
    s_mov_b32 s61, 0
    v_and_b32 v14, 0xf0, v1
    ds_read_b128 v[24:27], v14 offset:24064
    v_mov_b32 v19, 0
    v_mov_b32 v23, 0
    v_mov_b32 v31, 0
    v_mov_b32 v35, 0
    s_cmp_eq_u32 s22, 0
    s_cbranch_scc1 rec_h1first
    s_nop 15
    s_nop 15
    s_cmp_eq_u32 s22, 1
    s_cbranch_scc1 rec_h1first
    s_nop 15
    s_nop 15
rec_h1first:
    buffer_load_dwordx3 v[16:18], v10, s[8:11], s62 offen sc1
    buffer_load_dwordx3 v[20:22], v10, s[8:11], s63 offen sc1
    buffer_load_dwordx3 v[28:30], v10, s[8:11], s67 offen sc1
    buffer_load_dwordx3 v[32:34], v10, s[8:11], s69 offen sc1
    s_add_u32 s78, s77, 71303168
    s_add_u32 s30, s78, 73728
    s_add_u32 s31, s78, 147456
    s_add_u32 s32, s78, 221184
    s_mov_b32 s34, s76
    s_mov_b32 s36, s57
    s_add_u32 s50, s50, 1
    s_add_u32 s56, s56, 262144
    s_add_u32 s57, s57, 131072
    s_mov_b32 s77, s54
    s_add_u32 s54, s54, 294912
    s_cmp_eq_u32 s54, 884736
    s_cselect_b32 s54, 0, s54
    s_mov_b32 s35, s52
    s_mov_b32 s76, s51
    s_mov_b32 s51, s52
    s_add_u32 s52, s52, 9216
    s_cmp_eq_u32 s52, 72388608
    s_cselect_b32 s52, 72351744, s52
    s_add_u32 s33, s51, s70
    s_add_u32 s38, s50, 2
    s_min_u32 s38, s38, 64
    s_cmp_ge_u32 s58, s38
    s_cbranch_scc1 rec_kvokw1
    s_mov_b32 s39, 0
    v_and_b32 v15, 16, v1
    v_lshlrev_b32 v15, 8, v15
    s_add_u32 s28, s64, 4096
rec_kvpollw1:
    buffer_load_dword v14, v15, s[8:11], s28 offen sc1
    s_add_u32 s39, s39, 1
    s_cmp_gt_u32 s39, 32768
    s_cbranch_scc1 rec_timeout
    s_waitcnt vmcnt(0)
    v_readlane_b32 s29, v14, 0
    v_readlane_b32 s58, v14, 1
    s_min_u32 s58, s58, s29
    s_cmp_ge_u32 s58, s38
    s_cbranch_scc0 rec_kvpollw1
rec_kvokw1:
    buffer_load_dwordx4 v[60:63], v3, s[8:11], s56 offen
    buffer_load_dwordx4 v[64:67], v3, s[8:11], s56 offen offset:1024
    v_mov_b32 v68, -1
    v_lshrrev_b32 v69, 5, v1
    v_mul_u32_u24 v69, 9216, v69
    v_and_b32 v70, 16, v1
    v_mul_u32_u24 v70, 92, v70
    v_lshrrev_b32 v70, 4, v70
    v_add_u32 v69, v69, v70
    s_add_u32 s30, s78, s27
    buffer_store_dword v68, v69, s[8:11], s30 offen
    buffer_store_dword v68, v11, s[8:11], s34 offen
    v_mov_b64 v[40:41], 0
    v_mov_b64 v[42:43], 0
    v_mov_b64 v[44:45], 0
    v_mov_b64 v[46:47], 0
    v_mov_b64 v[48:49], 0
    v_mov_b64 v[50:51], 0
    s_waitcnt lgkmcnt(0)
    s_waitcnt vmcnt(7)
    v_mfma_f32_16x16x32_bf16 v[36:39], v[16:19], v[24:27], 0
    s_waitcnt vmcnt(6)
    v_mfma_f32_16x16x32_bf16 v[36:39], v[20:23], v[24:27], v[36:39]
    s_waitcnt vmcnt(5)
    v_mfma_f32_16x16x32_bf16 v[36:39], v[28:31], v[24:27], v[36:39]
    s_waitcnt vmcnt(4)
    v_mfma_f32_16x16x32_bf16 v[36:39], v[32:35], v[24:27], v[36:39]
    s_nop 7
    v_pk_add_f32 v[36:37], v[36:37], v[38:39]
    v_cmp_u_f32 vcc, v36, v37
    v_cvt_pk_bf16_f32 v38, v36, v37
    s_cbranch_vccz rec_h1ok
rec_h1poll:
    buffer_load_dwordx3 v[16:18], v10, s[8:11], s62 offen sc1
    buffer_load_dwordx3 v[20:22], v10, s[8:11], s63 offen sc1
    buffer_load_dwordx3 v[28:30], v10, s[8:11], s67 offen sc1
    buffer_load_dwordx3 v[32:34], v10, s[8:11], s69 offen sc1
    s_add_u32 s61, s61, 1
    s_cmp_gt_u32 s61, 32768
    s_cbranch_scc1 rec_timeout
    s_waitcnt vmcnt(3)
    v_mfma_f32_16x16x32_bf16 v[36:39], v[16:19], v[24:27], 0
    s_waitcnt vmcnt(2)
    v_mfma_f32_16x16x32_bf16 v[36:39], v[20:23], v[24:27], v[36:39]
    s_waitcnt vmcnt(1)
    v_mfma_f32_16x16x32_bf16 v[36:39], v[28:31], v[24:27], v[36:39]
    s_waitcnt vmcnt(0)
    v_mfma_f32_16x16x32_bf16 v[36:39], v[32:35], v[24:27], v[36:39]
    s_nop 7
    v_pk_add_f32 v[36:37], v[36:37], v[38:39]
    v_cmp_u_f32 vcc, v36, v37
    v_cvt_pk_bf16_f32 v38, v36, v37
    s_cbranch_vccnz rec_h1poll
rec_h1ok:
    buffer_store_dword v38, v11, s[8:11], s35 offen
    v_mov_b64 v[36:37], 0
    v_mov_b64 v[38:39], 0
    s_branch rec_adv
rec_w3tail:
    s_add_u32 s78, s77, 71303168
    s_add_u32 s30, s78, 73728
    s_add_u32 s31, s78, 147456
    s_add_u32 s32, s78, 221184
    s_mov_b32 s34, s76
    s_mov_b32 s36, s57
    s_add_u32 s50, s50, 1
    s_add_u32 s56, s56, 262144
    s_add_u32 s57, s57, 131072
    s_mov_b32 s77, s54
    s_add_u32 s54, s54, 294912
    s_cmp_eq_u32 s54, 884736
    s_cselect_b32 s54, 0, s54
    s_mov_b32 s35, s52
    s_mov_b32 s76, s51
    s_mov_b32 s51, s52
    s_add_u32 s52, s52, 9216
    s_cmp_eq_u32 s52, 72388608
    s_cselect_b32 s52, 72351744, s52
    s_add_u32 s33, s51, s70
    s_add_u32 s38, s50, 2
    s_min_u32 s38, s38, 64
    s_cmp_ge_u32 s58, s38
    s_cbranch_scc1 rec_kvokw0
    s_mov_b32 s39, 0
    v_and_b32 v15, 16, v1
    v_lshlrev_b32 v15, 8, v15
    s_add_u32 s28, s64, 4096
rec_kvpollw0:
    buffer_load_dword v14, v15, s[8:11], s28 offen sc1
    s_add_u32 s39, s39, 1
    s_cmp_gt_u32 s39, 32768
    s_cbranch_scc1 rec_timeout
    s_waitcnt vmcnt(0)
    v_readlane_b32 s29, v14, 0
    v_readlane_b32 s58, v14, 1
    s_min_u32 s58, s58, s29
    s_cmp_ge_u32 s58, s38
    s_cbranch_scc0 rec_kvpollw0
rec_kvokw0:
    buffer_load_dwordx4 v[60:63], v3, s[8:11], s56 offen
    buffer_load_dwordx4 v[64:67], v3, s[8:11], s56 offen offset:1024
    v_mov_b64 v[36:37], 0
    v_mov_b64 v[38:39], 0
    v_mov_b64 v[40:41], 0
    v_mov_b64 v[42:43], 0
    v_mov_b64 v[44:45], 0
    v_mov_b64 v[46:47], 0
    v_mov_b64 v[48:49], 0
    v_mov_b64 v[50:51], 0
rec_adv:
    s_waitcnt lgkmcnt(0)
    s_barrier
    s_branch rec_step
rec_last:
    s_add_u32 s63, s57, 8388608
    v_lshrrev_b32 v26, 1, v2
    buffer_store_dwordx2 v[24:25], v26, s[8:11], s63 offen sc1
    s_branch rec_finish
rec_timeout:
    s_mov_b32 s66, 1
rec_finish:
    s_waitcnt vmcnt(0)
    s_barrier
    s_cmp_eq_u32 s22, 3
    s_cbranch_scc0 rec_exit
    s_add_u32 s63, s50, 1
    s_cmp_eq_u32 s66, 0
    s_cselect_b32 s63, s63, 0x7fffffff
    v_mov_b32 v16, s63
    v_mov_b32 v17, 0
    s_add_u32 s62, s64, 12288
    buffer_store_dword v16, v17, s[8:11], s62 offen sc1
    s_waitcnt vmcnt(0)
rec_exit:
    s_branch L_exit
L_kv_in:
    s_load_dwordx2 s[40:41], s[0:1], 24
    s_load_dwordx2 s[42:43], s[0:1], 32
    s_waitcnt lgkmcnt(0)
    s_mov_b32 s61, s79
    s_add_u32 s81, s80, 73404416
    s_add_u32 s82, s80, 73408512
    v_mov_b32 v1, 0
    v_mov_b32 v2, 0
    buffer_store_dword v1, v2, s[8:11], s81 offen sc1
    buffer_store_dword v1, v2, s[8:11], s82 offen sc1
    s_waitcnt vmcnt(0)
    s_barrier
    v_cmp_eq_u32 vcc, 0, v0
    s_and_saveexec_b64 s[20:21], vcc
    s_cbranch_execz kv_arr
    v_mov_b32 v1, 1
    v_mov_b32 v2, 192
    buffer_atomic_add v1, v2, s[16:19], 0 offen
kv_arr:
    s_mov_b64 exec, s[20:21]
    s_lshl_b32 s23, s61, 8
    v_and_b32 v1, 63, v0
    v_lshrrev_b32 v2, 6, v0
    v_lshrrev_b32 v3, 4, v1
    v_and_b32 v4, 15, v1
    v_lshl_add_u32 v5, v2, 2, v3
    v_lshlrev_b32 v5, 13, v5
    v_lshlrev_b32 v6, 2, v3
    v_xor_b32 v6, v4, v6
    v_lshl_add_u32 v5, v6, 4, v5
    v_add_u32 v5, s23, v5
    v_lshrrev_b32 v6, 1, v3
    v_and_b32 v7, 1, v3
    v_lshrrev_b32 v8, 2, v4
    v_and_b32 v9, 3, v1
    v_lshl_add_u32 v10, v6, 3, v8
    v_lshlrev_b32 v10, 8, v10
    v_lshlrev_b32 v11, 2, v2
    v_lshl_add_u32 v11, v7, 1, v11
    v_lshrrev_b32 v12, 1, v9
    v_add_u32 v11, v11, v12
    v_lshlrev_b32 v12, 2, v8
    v_xor_b32 v11, v11, v12
    v_lshl_add_u32 v10, v11, 4, v10
    v_and_b32 v12, 1, v9
    v_lshl_add_u32 v10, v12, 3, v10
    v_add_u32 v10, 73728, v10
    s_lshl_b32 s24, s22, 10
    s_mov_b32 s14, 4718592
    s_mov_b32 s15, 0x20000
    s_mov_b32 s12, s40
    s_and_b32 s13, s41, 0xffff
    s_add_u32 m0, s24, 73728
    s_mov_b32 s25, 0
    buffer_load_dwordx4 v5, s[12:15], s25 offen lds
    s_add_u32 m0, s24, 77824
    s_mov_b32 s25, 131072
    buffer_load_dwordx4 v5, s[12:15], s25 offen lds
    s_add_u32 m0, s24, 81920
    s_mov_b32 s25, 262144
    buffer_load_dwordx4 v5, s[12:15], s25 offen lds
    s_add_u32 m0, s24, 86016
    s_mov_b32 s25, 393216
    buffer_load_dwordx4 v5, s[12:15], s25 offen lds
    s_add_u32 m0, s24, 90112
    s_mov_b32 s25, 524288
    buffer_load_dwordx4 v5, s[12:15], s25 offen lds
    s_add_u32 m0, s24, 94208
    s_mov_b32 s25, 655360
    buffer_load_dwordx4 v5, s[12:15], s25 offen lds
    s_add_u32 m0, s24, 98304
    s_mov_b32 s25, 786432
    buffer_load_dwordx4 v5, s[12:15], s25 offen lds
    s_add_u32 m0, s24, 102400
    s_mov_b32 s25, 917504
    buffer_load_dwordx4 v5, s[12:15], s25 offen lds
    s_add_u32 m0, s24, 106496
    s_mov_b32 s25, 1048576
    buffer_load_dwordx4 v5, s[12:15], s25 offen lds
    s_add_u32 m0, s24, 110592
    s_mov_b32 s25, 1179648
    buffer_load_dwordx4 v5, s[12:15], s25 offen lds
    s_add_u32 m0, s24, 114688
    s_mov_b32 s25, 1310720
    buffer_load_dwordx4 v5, s[12:15], s25 offen lds
    s_add_u32 m0, s24, 118784
    s_mov_b32 s25, 1441792
    buffer_load_dwordx4 v5, s[12:15], s25 offen lds
    s_waitcnt vmcnt(8)
    s_barrier
    s_add_u32 m0, s24, 122880
    s_mov_b32 s25, 1572864
    buffer_load_dwordx4 v5, s[12:15], s25 offen lds
    s_add_u32 m0, s24, 126976
    s_mov_b32 s25, 1703936
    buffer_load_dwordx4 v5, s[12:15], s25 offen lds
    s_add_u32 m0, s24, 131072
    s_mov_b32 s25, 1835008
    buffer_load_dwordx4 v5, s[12:15], s25 offen lds
    s_add_u32 m0, s24, 135168
    s_mov_b32 s25, 1966080
    buffer_load_dwordx4 v5, s[12:15], s25 offen lds
    ds_read_b64_tr_b16 a[0:1], v10 offset:0
    ds_read_b64_tr_b16 a[2:3], v10 offset:1024
    ds_read_b64_tr_b16 a[4:5], v10 offset:4096
    ds_read_b64_tr_b16 a[6:7], v10 offset:5120
    ds_read_b64_tr_b16 a[8:9], v10 offset:8192
    ds_read_b64_tr_b16 a[10:11], v10 offset:9216
    ds_read_b64_tr_b16 a[12:13], v10 offset:12288
    ds_read_b64_tr_b16 a[14:15], v10 offset:13312
    s_waitcnt lgkmcnt(0)
    s_waitcnt vmcnt(8)
    s_barrier
    s_add_u32 m0, s24, 73728
    s_mov_b32 s25, 2097152
    buffer_load_dwordx4 v5, s[12:15], s25 offen lds
    s_add_u32 m0, s24, 77824
    s_mov_b32 s25, 2228224
    buffer_load_dwordx4 v5, s[12:15], s25 offen lds
    s_add_u32 m0, s24, 81920
    s_mov_b32 s25, 2359296
    buffer_load_dwordx4 v5, s[12:15], s25 offen lds
    s_add_u32 m0, s24, 86016
    s_mov_b32 s25, 2490368
    buffer_load_dwordx4 v5, s[12:15], s25 offen lds
    ds_read_b64_tr_b16 a[16:17], v10 offset:16384
    ds_read_b64_tr_b16 a[18:19], v10 offset:17408
    ds_read_b64_tr_b16 a[20:21], v10 offset:20480
    ds_read_b64_tr_b16 a[22:23], v10 offset:21504
    ds_read_b64_tr_b16 a[24:25], v10 offset:24576
    ds_read_b64_tr_b16 a[26:27], v10 offset:25600
    ds_read_b64_tr_b16 a[28:29], v10 offset:28672
    ds_read_b64_tr_b16 a[30:31], v10 offset:29696
    s_waitcnt lgkmcnt(0)
    s_waitcnt vmcnt(8)
    s_barrier
    s_add_u32 m0, s24, 90112
    s_mov_b32 s25, 2621440
    buffer_load_dwordx4 v5, s[12:15], s25 offen lds
    s_add_u32 m0, s24, 94208
    s_mov_b32 s25, 2752512
    buffer_load_dwordx4 v5, s[12:15], s25 offen lds
    s_add_u32 m0, s24, 98304
    s_mov_b32 s25, 2883584
    buffer_load_dwordx4 v5, s[12:15], s25 offen lds
    s_add_u32 m0, s24, 102400
    s_mov_b32 s25, 3014656
    buffer_load_dwordx4 v5, s[12:15], s25 offen lds
    ds_read_b64_tr_b16 a[32:33], v10 offset:32768
    ds_read_b64_tr_b16 a[34:35], v10 offset:33792
    ds_read_b64_tr_b16 a[36:37], v10 offset:36864
    ds_read_b64_tr_b16 a[38:39], v10 offset:37888
    ds_read_b64_tr_b16 a[40:41], v10 offset:40960
    ds_read_b64_tr_b16 a[42:43], v10 offset:41984
    ds_read_b64_tr_b16 a[44:45], v10 offset:45056
    ds_read_b64_tr_b16 a[46:47], v10 offset:46080
    s_waitcnt lgkmcnt(0)
    s_waitcnt vmcnt(8)
    s_barrier
    s_add_u32 m0, s24, 106496
    s_mov_b32 s25, 3145728
    buffer_load_dwordx4 v5, s[12:15], s25 offen lds
    s_add_u32 m0, s24, 110592
    s_mov_b32 s25, 3276800
    buffer_load_dwordx4 v5, s[12:15], s25 offen lds
    s_add_u32 m0, s24, 114688
    s_mov_b32 s25, 3407872
    buffer_load_dwordx4 v5, s[12:15], s25 offen lds
    s_add_u32 m0, s24, 118784
    s_mov_b32 s25, 3538944
    buffer_load_dwordx4 v5, s[12:15], s25 offen lds
    ds_read_b64_tr_b16 a[48:49], v10 offset:49152
    ds_read_b64_tr_b16 a[50:51], v10 offset:50176
    ds_read_b64_tr_b16 a[52:53], v10 offset:53248
    ds_read_b64_tr_b16 a[54:55], v10 offset:54272
    ds_read_b64_tr_b16 a[56:57], v10 offset:57344
    ds_read_b64_tr_b16 a[58:59], v10 offset:58368
    ds_read_b64_tr_b16 a[60:61], v10 offset:61440
    ds_read_b64_tr_b16 a[62:63], v10 offset:62464
    s_waitcnt lgkmcnt(0)
    s_waitcnt vmcnt(8)
    s_barrier
    s_add_u32 m0, s24, 122880
    s_mov_b32 s25, 3670016
    buffer_load_dwordx4 v5, s[12:15], s25 offen lds
    s_add_u32 m0, s24, 126976
    s_mov_b32 s25, 3801088
    buffer_load_dwordx4 v5, s[12:15], s25 offen lds
    s_add_u32 m0, s24, 131072
    s_mov_b32 s25, 3932160
    buffer_load_dwordx4 v5, s[12:15], s25 offen lds
    s_add_u32 m0, s24, 135168
    s_mov_b32 s25, 4063232
    buffer_load_dwordx4 v5, s[12:15], s25 offen lds
    ds_read_b64_tr_b16 a[64:65], v10 offset:0
    ds_read_b64_tr_b16 a[66:67], v10 offset:1024
    ds_read_b64_tr_b16 a[68:69], v10 offset:4096
    ds_read_b64_tr_b16 a[70:71], v10 offset:5120
    ds_read_b64_tr_b16 a[72:73], v10 offset:8192
    ds_read_b64_tr_b16 a[74:75], v10 offset:9216
    ds_read_b64_tr_b16 a[76:77], v10 offset:12288
    ds_read_b64_tr_b16 a[78:79], v10 offset:13312
    s_waitcnt lgkmcnt(0)
    s_waitcnt vmcnt(8)
    s_barrier
    s_add_u32 m0, s24, 73728
    s_mov_b32 s25, 4194304
    buffer_load_dwordx4 v5, s[12:15], s25 offen lds
    s_add_u32 m0, s24, 77824
    s_mov_b32 s25, 4325376
    buffer_load_dwordx4 v5, s[12:15], s25 offen lds
    s_add_u32 m0, s24, 81920
    s_mov_b32 s25, 4456448
    buffer_load_dwordx4 v5, s[12:15], s25 offen lds
    s_add_u32 m0, s24, 86016
    s_mov_b32 s25, 4587520
    buffer_load_dwordx4 v5, s[12:15], s25 offen lds
    ds_read_b64_tr_b16 a[80:81], v10 offset:16384
    ds_read_b64_tr_b16 a[82:83], v10 offset:17408
    ds_read_b64_tr_b16 a[84:85], v10 offset:20480
    ds_read_b64_tr_b16 a[86:87], v10 offset:21504
    ds_read_b64_tr_b16 a[88:89], v10 offset:24576
    ds_read_b64_tr_b16 a[90:91], v10 offset:25600
    ds_read_b64_tr_b16 a[92:93], v10 offset:28672
    ds_read_b64_tr_b16 a[94:95], v10 offset:29696
    s_waitcnt lgkmcnt(0)
    s_waitcnt vmcnt(8)
    s_barrier
    s_mov_b32 s12, s42
    s_and_b32 s13, s43, 0xffff
    s_add_u32 m0, s24, 90112
    s_mov_b32 s25, 0
    buffer_load_dwordx4 v5, s[12:15], s25 offen lds
    s_add_u32 m0, s24, 94208
    s_mov_b32 s25, 131072
    buffer_load_dwordx4 v5, s[12:15], s25 offen lds
    s_add_u32 m0, s24, 98304
    s_mov_b32 s25, 262144
    buffer_load_dwordx4 v5, s[12:15], s25 offen lds
    s_add_u32 m0, s24, 102400
    s_mov_b32 s25, 393216
    buffer_load_dwordx4 v5, s[12:15], s25 offen lds
    ds_read_b64_tr_b16 a[96:97], v10 offset:32768
    ds_read_b64_tr_b16 a[98:99], v10 offset:33792
    ds_read_b64_tr_b16 a[100:101], v10 offset:36864
    ds_read_b64_tr_b16 a[102:103], v10 offset:37888
    ds_read_b64_tr_b16 a[104:105], v10 offset:40960
    ds_read_b64_tr_b16 a[106:107], v10 offset:41984
    ds_read_b64_tr_b16 a[108:109], v10 offset:45056
    ds_read_b64_tr_b16 a[110:111], v10 offset:46080
    s_waitcnt lgkmcnt(0)
    s_waitcnt vmcnt(8)
    s_barrier
    s_add_u32 m0, s24, 106496
    s_mov_b32 s25, 524288
    buffer_load_dwordx4 v5, s[12:15], s25 offen lds
    s_add_u32 m0, s24, 110592
    s_mov_b32 s25, 655360
    buffer_load_dwordx4 v5, s[12:15], s25 offen lds
    s_add_u32 m0, s24, 114688
    s_mov_b32 s25, 786432
    buffer_load_dwordx4 v5, s[12:15], s25 offen lds
    s_add_u32 m0, s24, 118784
    s_mov_b32 s25, 917504
    buffer_load_dwordx4 v5, s[12:15], s25 offen lds
    ds_read_b64_tr_b16 a[112:113], v10 offset:49152
    ds_read_b64_tr_b16 a[114:115], v10 offset:50176
    ds_read_b64_tr_b16 a[116:117], v10 offset:53248
    ds_read_b64_tr_b16 a[118:119], v10 offset:54272
    ds_read_b64_tr_b16 a[120:121], v10 offset:57344
    ds_read_b64_tr_b16 a[122:123], v10 offset:58368
    ds_read_b64_tr_b16 a[124:125], v10 offset:61440
    ds_read_b64_tr_b16 a[126:127], v10 offset:62464
    s_waitcnt lgkmcnt(0)
    s_waitcnt vmcnt(8)
    s_barrier
    s_add_u32 m0, s24, 122880
    s_mov_b32 s25, 1048576
    buffer_load_dwordx4 v5, s[12:15], s25 offen lds
    s_add_u32 m0, s24, 126976
    s_mov_b32 s25, 1179648
    buffer_load_dwordx4 v5, s[12:15], s25 offen lds
    s_add_u32 m0, s24, 131072
    s_mov_b32 s25, 1310720
    buffer_load_dwordx4 v5, s[12:15], s25 offen lds
    s_add_u32 m0, s24, 135168
    s_mov_b32 s25, 1441792
    buffer_load_dwordx4 v5, s[12:15], s25 offen lds
    ds_read_b64_tr_b16 a[128:129], v10 offset:0
    ds_read_b64_tr_b16 a[130:131], v10 offset:1024
    ds_read_b64_tr_b16 a[132:133], v10 offset:4096
    ds_read_b64_tr_b16 a[134:135], v10 offset:5120
    ds_read_b64_tr_b16 a[136:137], v10 offset:8192
    ds_read_b64_tr_b16 a[138:139], v10 offset:9216
    ds_read_b64_tr_b16 a[140:141], v10 offset:12288
    ds_read_b64_tr_b16 a[142:143], v10 offset:13312
    s_waitcnt lgkmcnt(0)
    s_waitcnt vmcnt(8)
    s_barrier
    s_add_u32 m0, s24, 73728
    s_mov_b32 s25, 1572864
    buffer_load_dwordx4 v5, s[12:15], s25 offen lds
    s_add_u32 m0, s24, 77824
    s_mov_b32 s25, 1703936
    buffer_load_dwordx4 v5, s[12:15], s25 offen lds
    s_add_u32 m0, s24, 81920
    s_mov_b32 s25, 1835008
    buffer_load_dwordx4 v5, s[12:15], s25 offen lds
    s_add_u32 m0, s24, 86016
    s_mov_b32 s25, 1966080
    buffer_load_dwordx4 v5, s[12:15], s25 offen lds
    ds_read_b64_tr_b16 a[144:145], v10 offset:16384
    ds_read_b64_tr_b16 a[146:147], v10 offset:17408
    ds_read_b64_tr_b16 a[148:149], v10 offset:20480
    ds_read_b64_tr_b16 a[150:151], v10 offset:21504
    ds_read_b64_tr_b16 a[152:153], v10 offset:24576
    ds_read_b64_tr_b16 a[154:155], v10 offset:25600
    ds_read_b64_tr_b16 a[156:157], v10 offset:28672
    ds_read_b64_tr_b16 a[158:159], v10 offset:29696
    s_waitcnt lgkmcnt(0)
    s_waitcnt vmcnt(8)
    s_barrier
    s_add_u32 m0, s24, 90112
    s_mov_b32 s25, 2097152
    buffer_load_dwordx4 v5, s[12:15], s25 offen lds
    s_add_u32 m0, s24, 94208
    s_mov_b32 s25, 2228224
    buffer_load_dwordx4 v5, s[12:15], s25 offen lds
    s_add_u32 m0, s24, 98304
    s_mov_b32 s25, 2359296
    buffer_load_dwordx4 v5, s[12:15], s25 offen lds
    s_add_u32 m0, s24, 102400
    s_mov_b32 s25, 2490368
    buffer_load_dwordx4 v5, s[12:15], s25 offen lds
    ds_read_b64_tr_b16 a[160:161], v10 offset:32768
    ds_read_b64_tr_b16 a[162:163], v10 offset:33792
    ds_read_b64_tr_b16 a[164:165], v10 offset:36864
    ds_read_b64_tr_b16 a[166:167], v10 offset:37888
    ds_read_b64_tr_b16 a[168:169], v10 offset:40960
    ds_read_b64_tr_b16 a[170:171], v10 offset:41984
    ds_read_b64_tr_b16 a[172:173], v10 offset:45056
    ds_read_b64_tr_b16 a[174:175], v10 offset:46080
    s_waitcnt lgkmcnt(0)
    s_waitcnt vmcnt(8)
    s_barrier
    s_add_u32 m0, s24, 106496
    s_mov_b32 s25, 2621440
    buffer_load_dwordx4 v5, s[12:15], s25 offen lds
    s_add_u32 m0, s24, 110592
    s_mov_b32 s25, 2752512
    buffer_load_dwordx4 v5, s[12:15], s25 offen lds
    s_add_u32 m0, s24, 114688
    s_mov_b32 s25, 2883584
    buffer_load_dwordx4 v5, s[12:15], s25 offen lds
    s_add_u32 m0, s24, 118784
    s_mov_b32 s25, 3014656
    buffer_load_dwordx4 v5, s[12:15], s25 offen lds
    ds_read_b64_tr_b16 a[176:177], v10 offset:49152
    ds_read_b64_tr_b16 a[178:179], v10 offset:50176
    ds_read_b64_tr_b16 a[180:181], v10 offset:53248
    ds_read_b64_tr_b16 a[182:183], v10 offset:54272
    ds_read_b64_tr_b16 a[184:185], v10 offset:57344
    ds_read_b64_tr_b16 a[186:187], v10 offset:58368
    ds_read_b64_tr_b16 a[188:189], v10 offset:61440
    ds_read_b64_tr_b16 a[190:191], v10 offset:62464
    s_waitcnt lgkmcnt(0)
    s_waitcnt vmcnt(8)
    s_barrier
    s_add_u32 m0, s24, 122880
    s_mov_b32 s25, 3145728
    buffer_load_dwordx4 v5, s[12:15], s25 offen lds
    s_add_u32 m0, s24, 126976
    s_mov_b32 s25, 3276800
    buffer_load_dwordx4 v5, s[12:15], s25 offen lds
    s_add_u32 m0, s24, 131072
    s_mov_b32 s25, 3407872
    buffer_load_dwordx4 v5, s[12:15], s25 offen lds
    s_add_u32 m0, s24, 135168
    s_mov_b32 s25, 3538944
    buffer_load_dwordx4 v5, s[12:15], s25 offen lds
    ds_read_b64_tr_b16 a[192:193], v10 offset:0
    ds_read_b64_tr_b16 a[194:195], v10 offset:1024
    ds_read_b64_tr_b16 a[196:197], v10 offset:4096
    ds_read_b64_tr_b16 a[198:199], v10 offset:5120
    ds_read_b64_tr_b16 a[200:201], v10 offset:8192
    ds_read_b64_tr_b16 a[202:203], v10 offset:9216
    ds_read_b64_tr_b16 a[204:205], v10 offset:12288
    ds_read_b64_tr_b16 a[206:207], v10 offset:13312
    s_waitcnt lgkmcnt(0)
    s_waitcnt vmcnt(8)
    s_barrier
    s_add_u32 m0, s24, 73728
    s_mov_b32 s25, 3670016
    buffer_load_dwordx4 v5, s[12:15], s25 offen lds
    s_add_u32 m0, s24, 77824
    s_mov_b32 s25, 3801088
    buffer_load_dwordx4 v5, s[12:15], s25 offen lds
    s_add_u32 m0, s24, 81920
    s_mov_b32 s25, 3932160
    buffer_load_dwordx4 v5, s[12:15], s25 offen lds
    s_add_u32 m0, s24, 86016
    s_mov_b32 s25, 4063232
    buffer_load_dwordx4 v5, s[12:15], s25 offen lds
    ds_read_b64_tr_b16 a[208:209], v10 offset:16384
    ds_read_b64_tr_b16 a[210:211], v10 offset:17408
    ds_read_b64_tr_b16 a[212:213], v10 offset:20480
    ds_read_b64_tr_b16 a[214:215], v10 offset:21504
    ds_read_b64_tr_b16 a[216:217], v10 offset:24576
    ds_read_b64_tr_b16 a[218:219], v10 offset:25600
    ds_read_b64_tr_b16 a[220:221], v10 offset:28672
    ds_read_b64_tr_b16 a[222:223], v10 offset:29696
    s_waitcnt lgkmcnt(0)
    s_waitcnt vmcnt(8)
    s_barrier
    s_add_u32 m0, s24, 90112
    s_mov_b32 s25, 4194304
    buffer_load_dwordx4 v5, s[12:15], s25 offen lds
    s_add_u32 m0, s24, 94208
    s_mov_b32 s25, 4325376
    buffer_load_dwordx4 v5, s[12:15], s25 offen lds
    s_add_u32 m0, s24, 98304
    s_mov_b32 s25, 4456448
    buffer_load_dwordx4 v5, s[12:15], s25 offen lds
    s_add_u32 m0, s24, 102400
    s_mov_b32 s25, 4587520
    buffer_load_dwordx4 v5, s[12:15], s25 offen lds
    ds_read_b64_tr_b16 a[224:225], v10 offset:32768
    ds_read_b64_tr_b16 a[226:227], v10 offset:33792
    ds_read_b64_tr_b16 a[228:229], v10 offset:36864
    ds_read_b64_tr_b16 a[230:231], v10 offset:37888
    ds_read_b64_tr_b16 a[232:233], v10 offset:40960
    ds_read_b64_tr_b16 a[234:235], v10 offset:41984
    ds_read_b64_tr_b16 a[236:237], v10 offset:45056
    ds_read_b64_tr_b16 a[238:239], v10 offset:46080
    s_waitcnt lgkmcnt(0)
    s_waitcnt vmcnt(8)
    s_barrier
    ds_read_b64_tr_b16 a[240:241], v10 offset:49152
    ds_read_b64_tr_b16 a[242:243], v10 offset:50176
    ds_read_b64_tr_b16 a[244:245], v10 offset:53248
    ds_read_b64_tr_b16 a[246:247], v10 offset:54272
    ds_read_b64_tr_b16 a[248:249], v10 offset:57344
    ds_read_b64_tr_b16 a[250:251], v10 offset:58368
    ds_read_b64_tr_b16 a[252:253], v10 offset:61440
    ds_read_b64_tr_b16 a[254:255], v10 offset:62464
    s_waitcnt lgkmcnt(0)
    s_waitcnt vmcnt(4)
    s_barrier
    ds_read_b64_tr_b16 v[80:81], v10 offset:0
    ds_read_b64_tr_b16 v[82:83], v10 offset:1024
    ds_read_b64_tr_b16 v[84:85], v10 offset:4096
    ds_read_b64_tr_b16 v[86:87], v10 offset:5120
    ds_read_b64_tr_b16 v[88:89], v10 offset:8192
    ds_read_b64_tr_b16 v[90:91], v10 offset:9216
    ds_read_b64_tr_b16 v[92:93], v10 offset:12288
    ds_read_b64_tr_b16 v[94:95], v10 offset:13312
    s_waitcnt lgkmcnt(0)
    s_waitcnt vmcnt(0)
    s_barrier
    ds_read_b64_tr_b16 v[96:97], v10 offset:16384
    ds_read_b64_tr_b16 v[98:99], v10 offset:17408
    ds_read_b64_tr_b16 v[100:101], v10 offset:20480
    ds_read_b64_tr_b16 v[102:103], v10 offset:21504
    ds_read_b64_tr_b16 v[104:105], v10 offset:24576
    ds_read_b64_tr_b16 v[106:107], v10 offset:25600
    ds_read_b64_tr_b16 v[108:109], v10 offset:28672
    ds_read_b64_tr_b16 v[110:111], v10 offset:29696
    s_waitcnt lgkmcnt(0)
    v_lshlrev_b32 v12, 4, v1
    v_mul_u32_u24 v13, 9216, v2
    v_add_u32 v13, v13, v12
    v_add_u32 v14, 36864, v12
    v_and_b32 v15, 31, v1
    v_lshrrev_b32 v15, 4, v15
    v_lshlrev_b32 v15, 10, v15
    v_lshrrev_b32 v6, 5, v1
    v_lshl_add_u32 v6, v6, 4, v4
    v_lshl_add_u32 v15, v6, 4, v15
    v_lshl_add_u32 v15, v2, 11, v15
    s_mul_i32 s26, s22, 9216
    s_lshl_b32 s27, s61, 13
    s_mov_b32 s29, 0
    s_mov_b32 s30, 0
    s_lshl_b32 s31, s61, 7
    s_add_u32 s31, s31, 73400320
    s_mov_b32 s33, 0x3e0293ee
    v_mov_b32 v71, 192
    s_mov_b32 s90, 0
kv_wa:
    buffer_load_dword v70, v71, s[16:19], 0 offen sc1
    s_add_u32 s90, s90, 1
    s_cmp_gt_u32 s90, 65536
    s_cbranch_scc1 L_exit
    s_waitcnt vmcnt(0)
    v_readfirstlane_b32 s91, v70
    s_cmp_ge_u32 s91, 256
    s_cbranch_scc1 kv_wa_ok
    s_sleep 4
    s_branch kv_wa
kv_wa_ok:
    s_mov_b32 s39, 73416704
    s_mov_b32 s91, 1
    v_and_b32 v70, 63, v0
    v_min_u32 v70, 63, v70
    v_mul_u32_u24 v70, 128, v70
    s_mov_b32 s90, 0
kv_pl_ln:
    buffer_load_dword v71, v70, s[8:11], s39 offen sc1
    s_add_u32 s90, s90, 1
    s_cmp_gt_u32 s90, 65536
    s_cbranch_scc1 kv_timeout
    s_waitcnt vmcnt(0)
    v_cmp_gt_u32 vcc, s91, v71
    s_cbranch_vccz kv_pl_ok_ln
    s_sleep 2
    s_branch kv_pl_ln
kv_pl_ok_ln:
    s_mov_b32 s34, s33
    s_mov_b32 s35, s33
    s_add_u32 m0, s26, 0
    s_add_u32 s32, s29, 0
    buffer_load_dwordx4 v13, s[8:11], s32 offen offset:0 sc1 lds
    buffer_load_dwordx4 v13, s[8:11], s32 offen offset:1024 sc1 lds
    buffer_load_dwordx4 v13, s[8:11], s32 offen offset:2048 sc1 lds
    buffer_load_dwordx4 v13, s[8:11], s32 offen offset:3072 sc1 lds
    s_add_u32 m0, s26, 4096
    s_add_u32 s32, s29, 4096
    buffer_load_dwordx4 v13, s[8:11], s32 offen offset:0 sc1 lds
    buffer_load_dwordx4 v13, s[8:11], s32 offen offset:1024 sc1 lds
    buffer_load_dwordx4 v13, s[8:11], s32 offen offset:2048 sc1 lds
    buffer_load_dwordx4 v13, s[8:11], s32 offen offset:3072 sc1 lds
    s_add_u32 m0, s26, 8192
    s_add_u32 s32, s29, 8192
    buffer_load_dwordx4 v13, s[8:11], s32 offen offset:0 sc1 lds
    s_add_u32 s29, s29, 36864
    s_waitcnt vmcnt(0)
    s_barrier
    s_add_u32 s36, s30, 1
    s_cmp_lt_u32 s36, 64
    s_cbranch_scc0 kv_nd_p
    s_add_u32 m0, s26, 36864
    s_add_u32 s32, s29, 0
    buffer_load_dwordx4 v13, s[8:11], s32 offen offset:0 sc1 lds
    buffer_load_dwordx4 v13, s[8:11], s32 offen offset:1024 sc1 lds
    buffer_load_dwordx4 v13, s[8:11], s32 offen offset:2048 sc1 lds
    buffer_load_dwordx4 v13, s[8:11], s32 offen offset:3072 sc1 lds
    s_add_u32 m0, s26, 40960
    s_add_u32 s32, s29, 4096
    buffer_load_dwordx4 v13, s[8:11], s32 offen offset:0 sc1 lds
    buffer_load_dwordx4 v13, s[8:11], s32 offen offset:1024 sc1 lds
    buffer_load_dwordx4 v13, s[8:11], s32 offen offset:2048 sc1 lds
    buffer_load_dwordx4 v13, s[8:11], s32 offen offset:3072 sc1 lds
    s_add_u32 m0, s26, 45056
    s_add_u32 s32, s29, 8192
    buffer_load_dwordx4 v13, s[8:11], s32 offen offset:0 sc1 lds
    s_add_u32 s29, s29, 36864
kv_nd_p:
    ds_read_b128 v[16:19], v12 offset:0
    ds_read_b128 v[20:23], v12 offset:1024
    ds_read_b128 v[24:27], v12 offset:2048
    ds_read_b128 v[28:31], v12 offset:3072
    s_waitcnt lgkmcnt(3)
    v_mfma_f32_32x32x16_bf16 v[32:47], a[0:3], v[16:19], 0
    ds_read_b128 v[16:19], v12 offset:4096
    s_waitcnt lgkmcnt(3)
    v_mfma_f32_32x32x16_bf16 v[32:47], a[4:7], v[20:23], v[32:47]
    ds_read_b128 v[20:23], v12 offset:5120
    s_waitcnt lgkmcnt(3)
    v_mfma_f32_32x32x16_bf16 v[32:47], a[8:11], v[24:27], v[32:47]
    ds_read_b128 v[24:27], v12 offset:6144
    s_waitcnt lgkmcnt(3)
    v_mfma_f32_32x32x16_bf16 v[32:47], a[12:15], v[28:31], v[32:47]
    ds_read_b128 v[28:31], v12 offset:7168
    s_waitcnt lgkmcnt(3)
    v_mfma_f32_32x32x16_bf16 v[32:47], a[16:19], v[16:19], v[32:47]
    ds_read_b128 v[16:19], v12 offset:8192
    s_waitcnt lgkmcnt(3)
    v_mfma_f32_32x32x16_bf16 v[32:47], a[20:23], v[20:23], v[32:47]
    ds_read_b128 v[20:23], v12 offset:9216
    s_waitcnt lgkmcnt(3)
    v_mfma_f32_32x32x16_bf16 v[32:47], a[24:27], v[24:27], v[32:47]
    ds_read_b128 v[24:27], v12 offset:10240
    s_waitcnt lgkmcnt(3)
    v_mfma_f32_32x32x16_bf16 v[32:47], a[28:31], v[28:31], v[32:47]
    ds_read_b128 v[28:31], v12 offset:11264
    s_waitcnt lgkmcnt(3)
    v_mfma_f32_32x32x16_bf16 v[32:47], a[32:35], v[16:19], v[32:47]
    ds_read_b128 v[16:19], v12 offset:12288
    s_waitcnt lgkmcnt(3)
    v_mfma_f32_32x32x16_bf16 v[32:47], a[36:39], v[20:23], v[32:47]
    ds_read_b128 v[20:23], v12 offset:13312
    s_waitcnt lgkmcnt(3)
    v_mfma_f32_32x32x16_bf16 v[32:47], a[40:43], v[24:27], v[32:47]
    ds_read_b128 v[24:27], v12 offset:14336
    s_waitcnt lgkmcnt(3)
    v_mfma_f32_32x32x16_bf16 v[32:47], a[44:47], v[28:31], v[32:47]
    ds_read_b128 v[28:31], v12 offset:15360
    s_waitcnt lgkmcnt(3)
    v_mfma_f32_32x32x16_bf16 v[32:47], a[48:51], v[16:19], v[32:47]
    ds_read_b128 v[16:19], v12 offset:16384
    s_waitcnt lgkmcnt(3)
    v_mfma_f32_32x32x16_bf16 v[32:47], a[52:55], v[20:23], v[32:47]
    ds_read_b128 v[20:23], v12 offset:17408
    s_waitcnt lgkmcnt(3)
    v_mfma_f32_32x32x16_bf16 v[32:47], a[56:59], v[24:27], v[32:47]
    ds_read_b128 v[24:27], v12 offset:18432
    s_waitcnt lgkmcnt(3)
    v_mfma_f32_32x32x16_bf16 v[32:47], a[60:63], v[28:31], v[32:47]
    ds_read_b128 v[28:31], v12 offset:19456
    s_waitcnt lgkmcnt(3)
    v_mfma_f32_32x32x16_bf16 v[32:47], a[64:67], v[16:19], v[32:47]
    ds_read_b128 v[16:19], v12 offset:20480
    s_waitcnt lgkmcnt(3)
    v_mfma_f32_32x32x16_bf16 v[32:47], a[68:71], v[20:23], v[32:47]
    ds_read_b128 v[20:23], v12 offset:21504
    s_waitcnt lgkmcnt(3)
    v_mfma_f32_32x32x16_bf16 v[32:47], a[72:75], v[24:27], v[32:47]
    ds_read_b128 v[24:27], v12 offset:22528
    s_waitcnt lgkmcnt(3)
    v_mfma_f32_32x32x16_bf16 v[32:47], a[76:79], v[28:31], v[32:47]
    ds_read_b128 v[28:31], v12 offset:23552
    s_waitcnt lgkmcnt(3)
    v_mfma_f32_32x32x16_bf16 v[32:47], a[80:83], v[16:19], v[32:47]
    ds_read_b128 v[16:19], v12 offset:24576
    s_waitcnt lgkmcnt(3)
    v_mfma_f32_32x32x16_bf16 v[32:47], a[84:87], v[20:23], v[32:47]
    ds_read_b128 v[20:23], v12 offset:25600
    s_waitcnt lgkmcnt(3)
    v_mfma_f32_32x32x16_bf16 v[32:47], a[88:91], v[24:27], v[32:47]
    ds_read_b128 v[24:27], v12 offset:26624
    s_waitcnt lgkmcnt(3)
    v_mfma_f32_32x32x16_bf16 v[32:47], a[92:95], v[28:31], v[32:47]
    ds_read_b128 v[28:31], v12 offset:27648
    s_waitcnt lgkmcnt(3)
    v_mfma_f32_32x32x16_bf16 v[32:47], a[96:99], v[16:19], v[32:47]
    ds_read_b128 v[16:19], v12 offset:28672
    s_waitcnt lgkmcnt(3)
    v_mfma_f32_32x32x16_bf16 v[32:47], a[100:103], v[20:23], v[32:47]
    ds_read_b128 v[20:23], v12 offset:29696
    s_waitcnt lgkmcnt(3)
    v_mfma_f32_32x32x16_bf16 v[32:47], a[104:107], v[24:27], v[32:47]
    ds_read_b128 v[24:27], v12 offset:30720
    s_waitcnt lgkmcnt(3)
    v_mfma_f32_32x32x16_bf16 v[32:47], a[108:111], v[28:31], v[32:47]
    ds_read_b128 v[28:31], v12 offset:31744
    s_waitcnt lgkmcnt(3)
    v_mfma_f32_32x32x16_bf16 v[32:47], a[112:115], v[16:19], v[32:47]
    ds_read_b128 v[16:19], v12 offset:32768
    s_waitcnt lgkmcnt(3)
    v_mfma_f32_32x32x16_bf16 v[32:47], a[116:119], v[20:23], v[32:47]
    ds_read_b128 v[20:23], v12 offset:33792
    s_waitcnt lgkmcnt(3)
    v_mfma_f32_32x32x16_bf16 v[32:47], a[120:123], v[24:27], v[32:47]
    ds_read_b128 v[24:27], v12 offset:34816
    s_waitcnt lgkmcnt(3)
    v_mfma_f32_32x32x16_bf16 v[32:47], a[124:127], v[28:31], v[32:47]
    ds_read_b128 v[28:31], v12 offset:35840
    s_waitcnt lgkmcnt(3)
    v_mfma_f32_32x32x16_bf16 v[32:47], a[128:131], v[16:19], v[32:47]
    ds_read_b128 v[16:19], v12 offset:0
    s_waitcnt lgkmcnt(3)
    v_mfma_f32_32x32x16_bf16 v[32:47], a[132:135], v[20:23], v[32:47]
    ds_read_b128 v[20:23], v12 offset:1024
    s_waitcnt lgkmcnt(3)
    v_mfma_f32_32x32x16_bf16 v[32:47], a[136:139], v[24:27], v[32:47]
    ds_read_b128 v[24:27], v12 offset:2048
    s_waitcnt lgkmcnt(3)
    v_mfma_f32_32x32x16_bf16 v[32:47], a[140:143], v[28:31], v[32:47]
    ds_read_b128 v[28:31], v12 offset:3072
    s_waitcnt lgkmcnt(3)
    v_mfma_f32_32x32x16_bf16 v[48:63], v[16:19], a[144:147], 0
    ds_read_b128 v[16:19], v12 offset:4096
    s_waitcnt lgkmcnt(3)
    v_mfma_f32_32x32x16_bf16 v[48:63], v[20:23], a[148:151], v[48:63]
    ds_read_b128 v[20:23], v12 offset:5120
    s_waitcnt lgkmcnt(3)
    v_mfma_f32_32x32x16_bf16 v[48:63], v[24:27], a[152:155], v[48:63]
    v_cvt_pk_bf16_f32 v64, v32, v33
    v_cvt_pk_bf16_f32 v65, v34, v35
    ds_read_b128 v[24:27], v12 offset:6144
    s_waitcnt lgkmcnt(3)
    v_mfma_f32_32x32x16_bf16 v[48:63], v[28:31], a[156:159], v[48:63]
    v_cvt_pk_bf16_f32 v66, v36, v37
    v_cvt_pk_bf16_f32 v67, v38, v39
    ds_read_b128 v[28:31], v12 offset:7168
    s_waitcnt lgkmcnt(3)
    v_mfma_f32_32x32x16_bf16 v[48:63], v[16:19], a[160:163], v[48:63]
    v_cvt_pk_bf16_f32 v68, v40, v41
    v_cvt_pk_bf16_f32 v69, v42, v43
    ds_read_b128 v[16:19], v12 offset:8192
    s_waitcnt lgkmcnt(3)
    v_mfma_f32_32x32x16_bf16 v[48:63], v[20:23], a[164:167], v[48:63]
    v_cvt_pk_bf16_f32 v70, v44, v45
    v_cvt_pk_bf16_f32 v71, v46, v47
    ds_read_b128 v[20:23], v12 offset:9216
    s_waitcnt lgkmcnt(3)
    v_mfma_f32_32x32x16_bf16 v[48:63], v[24:27], a[168:171], v[48:63]
    s_nop 1
    v_permlane32_swap_b32 v64, v66
    ds_read_b128 v[24:27], v12 offset:10240
    s_waitcnt lgkmcnt(3)
    v_mfma_f32_32x32x16_bf16 v[48:63], v[28:31], a[172:175], v[48:63]
    v_permlane32_swap_b32 v65, v67
    v_permlane32_swap_b32 v68, v70
    ds_read_b128 v[28:31], v12 offset:11264
    s_waitcnt lgkmcnt(3)
    v_mfma_f32_32x32x16_bf16 v[48:63], v[16:19], a[176:179], v[48:63]
    v_permlane32_swap_b32 v69, v71
    s_add_u32 s28, s27, 20971520
    ds_read_b128 v[16:19], v12 offset:12288
    s_waitcnt lgkmcnt(3)
    v_mfma_f32_32x32x16_bf16 v[48:63], v[20:23], a[180:183], v[48:63]
    buffer_store_dwordx4 v[64:67], v15, s[8:11], s28 offen sc1
    buffer_store_dwordx4 v[68:71], v15, s[8:11], s28 offen offset:512 sc1
    ds_read_b128 v[20:23], v12 offset:13312
    s_waitcnt lgkmcnt(3)
    v_mfma_f32_32x32x16_bf16 v[48:63], v[24:27], a[184:187], v[48:63]
    ds_read_b128 v[24:27], v12 offset:14336
    s_waitcnt lgkmcnt(3)
    v_mfma_f32_32x32x16_bf16 v[48:63], v[28:31], a[188:191], v[48:63]
    ds_read_b128 v[28:31], v12 offset:15360
    s_waitcnt lgkmcnt(3)
    v_mfma_f32_32x32x16_bf16 v[48:63], v[16:19], a[192:195], v[48:63]
    ds_read_b128 v[16:19], v12 offset:16384
    s_waitcnt lgkmcnt(3)
    v_mfma_f32_32x32x16_bf16 v[48:63], v[20:23], a[196:199], v[48:63]
    ds_read_b128 v[20:23], v12 offset:17408
    s_waitcnt lgkmcnt(3)
    v_mfma_f32_32x32x16_bf16 v[48:63], v[24:27], a[200:203], v[48:63]
    ds_read_b128 v[24:27], v12 offset:18432
    s_waitcnt lgkmcnt(3)
    v_mfma_f32_32x32x16_bf16 v[48:63], v[28:31], a[204:207], v[48:63]
    ds_read_b128 v[28:31], v12 offset:19456
    s_waitcnt lgkmcnt(3)
    v_mfma_f32_32x32x16_bf16 v[48:63], v[16:19], a[208:211], v[48:63]
    ds_read_b128 v[16:19], v12 offset:20480
    s_waitcnt lgkmcnt(3)
    v_mfma_f32_32x32x16_bf16 v[48:63], v[20:23], a[212:215], v[48:63]
    ds_read_b128 v[20:23], v12 offset:21504
    s_waitcnt lgkmcnt(3)
    v_mfma_f32_32x32x16_bf16 v[48:63], v[24:27], a[216:219], v[48:63]
    ds_read_b128 v[24:27], v12 offset:22528
    s_waitcnt lgkmcnt(3)
    v_mfma_f32_32x32x16_bf16 v[48:63], v[28:31], a[220:223], v[48:63]
    ds_read_b128 v[28:31], v12 offset:23552
    s_waitcnt lgkmcnt(3)
    v_mfma_f32_32x32x16_bf16 v[48:63], v[16:19], a[224:227], v[48:63]
    ds_read_b128 v[16:19], v12 offset:24576
    s_waitcnt lgkmcnt(3)
    v_mfma_f32_32x32x16_bf16 v[48:63], v[20:23], a[228:231], v[48:63]
    ds_read_b128 v[20:23], v12 offset:25600
    s_waitcnt lgkmcnt(3)
    v_mfma_f32_32x32x16_bf16 v[48:63], v[24:27], a[232:235], v[48:63]
    ds_read_b128 v[24:27], v12 offset:26624
    s_waitcnt lgkmcnt(3)
    v_mfma_f32_32x32x16_bf16 v[48:63], v[28:31], a[236:239], v[48:63]
    ds_read_b128 v[28:31], v12 offset:27648
    s_waitcnt lgkmcnt(3)
    v_mfma_f32_32x32x16_bf16 v[48:63], v[16:19], a[240:243], v[48:63]
    ds_read_b128 v[16:19], v12 offset:28672
    s_waitcnt lgkmcnt(3)
    v_mfma_f32_32x32x16_bf16 v[48:63], v[20:23], a[244:247], v[48:63]
    ds_read_b128 v[20:23], v12 offset:29696
    s_waitcnt lgkmcnt(3)
    v_mfma_f32_32x32x16_bf16 v[48:63], v[24:27], a[248:251], v[48:63]
    ds_read_b128 v[24:27], v12 offset:30720
    s_waitcnt lgkmcnt(3)
    v_mfma_f32_32x32x16_bf16 v[48:63], v[28:31], a[252:255], v[48:63]
    ds_read_b128 v[28:31], v12 offset:31744
    s_waitcnt lgkmcnt(3)
    v_mfma_f32_32x32x16_bf16 v[48:63], v[16:19], v[80:83], v[48:63]
    ds_read_b128 v[16:19], v12 offset:32768
    s_waitcnt lgkmcnt(3)
    v_mfma_f32_32x32x16_bf16 v[48:63], v[20:23], v[84:87], v[48:63]
    ds_read_b128 v[20:23], v12 offset:33792
    s_waitcnt lgkmcnt(3)
    v_mfma_f32_32x32x16_bf16 v[48:63], v[24:27], v[88:91], v[48:63]
    ds_read_b128 v[24:27], v12 offset:34816
    s_waitcnt lgkmcnt(3)
    v_mfma_f32_32x32x16_bf16 v[48:63], v[28:31], v[92:95], v[48:63]
    ds_read_b128 v[28:31], v12 offset:35840
    s_waitcnt lgkmcnt(3)
    v_mfma_f32_32x32x16_bf16 v[48:63], v[16:19], v[96:99], v[48:63]
    s_waitcnt lgkmcnt(2)
    v_mfma_f32_32x32x16_bf16 v[48:63], v[20:23], v[100:103], v[48:63]
    s_waitcnt lgkmcnt(1)
    v_mfma_f32_32x32x16_bf16 v[48:63], v[24:27], v[104:107], v[48:63]
    s_waitcnt lgkmcnt(0)
    v_mfma_f32_32x32x16_bf16 v[48:63], v[28:31], v[108:111], v[48:63]
    s_nop 11
    v_cvt_pk_bf16_f32 v64, v48, v49
    v_cvt_pk_bf16_f32 v65, v50, v51
    v_cvt_pk_bf16_f32 v66, v56, v57
    v_cvt_pk_bf16_f32 v67, v58, v59
    v_cvt_pk_bf16_f32 v68, v52, v53
    v_cvt_pk_bf16_f32 v69, v54, v55
    v_cvt_pk_bf16_f32 v70, v60, v61
    v_cvt_pk_bf16_f32 v71, v62, v63
    s_add_u32 s28, s27, 37748736
    buffer_store_dwordx4 v[64:67], v15, s[8:11], s28 offen sc1
    buffer_store_dwordx4 v[68:71], v15, s[8:11], s28 offen offset:512 sc1
    s_add_u32 s27, s27, 262144
    s_add_u32 s30, s30, 1
kv_loop:
    s_waitcnt vmcnt(4)
    s_barrier
    s_sub_u32 s36, s30, 1
    s_cmp_eq_u32 s22, 0
    s_cbranch_scc0 kv_np_a
    v_mov_b32 v72, s36
    v_mov_b32 v73, 0
    s_mov_b64 exec, 1
    s_add_u32 s37, s31, 4096
    buffer_store_dword v72, v73, s[8:11], s37 offen sc1
    s_add_u32 s37, s31, 8192
    buffer_store_dword v72, v73, s[8:11], s37 offen sc1
    s_mov_b64 exec, -1
kv_np_a:
    s_add_u32 s36, s30, 1
    s_cmp_lt_u32 s36, 64
    s_cbranch_scc0 kv_nd_a
    s_add_u32 m0, s26, 0
    s_add_u32 s32, s29, 0
    buffer_load_dwordx4 v13, s[8:11], s32 offen offset:0 sc1 lds
    buffer_load_dwordx4 v13, s[8:11], s32 offen offset:1024 sc1 lds
    buffer_load_dwordx4 v13, s[8:11], s32 offen offset:2048 sc1 lds
    buffer_load_dwordx4 v13, s[8:11], s32 offen offset:3072 sc1 lds
    s_add_u32 m0, s26, 4096
    s_add_u32 s32, s29, 4096
    buffer_load_dwordx4 v13, s[8:11], s32 offen offset:0 sc1 lds
    buffer_load_dwordx4 v13, s[8:11], s32 offen offset:1024 sc1 lds
    buffer_load_dwordx4 v13, s[8:11], s32 offen offset:2048 sc1 lds
    buffer_load_dwordx4 v13, s[8:11], s32 offen offset:3072 sc1 lds
    s_add_u32 m0, s26, 8192
    s_add_u32 s32, s29, 8192
    buffer_load_dwordx4 v13, s[8:11], s32 offen offset:0 sc1 lds
    s_add_u32 s29, s29, 36864
kv_nd_a:
    ds_read_b128 v[16:19], v14 offset:0
    ds_read_b128 v[20:23], v14 offset:1024
    ds_read_b128 v[24:27], v14 offset:2048
    ds_read_b128 v[28:31], v14 offset:3072
    s_waitcnt lgkmcnt(3)
    v_mfma_f32_32x32x16_bf16 v[32:47], a[0:3], v[16:19], 0
    ds_read_b128 v[16:19], v14 offset:4096
    s_waitcnt lgkmcnt(3)
    v_mfma_f32_32x32x16_bf16 v[32:47], a[4:7], v[20:23], v[32:47]
    ds_read_b128 v[20:23], v14 offset:5120
    s_waitcnt lgkmcnt(3)
    v_mfma_f32_32x32x16_bf16 v[32:47], a[8:11], v[24:27], v[32:47]
    ds_read_b128 v[24:27], v14 offset:6144
    s_waitcnt lgkmcnt(3)
    v_mfma_f32_32x32x16_bf16 v[32:47], a[12:15], v[28:31], v[32:47]
    ds_read_b128 v[28:31], v14 offset:7168
    s_waitcnt lgkmcnt(3)
    v_mfma_f32_32x32x16_bf16 v[32:47], a[16:19], v[16:19], v[32:47]
    ds_read_b128 v[16:19], v14 offset:8192
    s_waitcnt lgkmcnt(3)
    v_mfma_f32_32x32x16_bf16 v[32:47], a[20:23], v[20:23], v[32:47]
    ds_read_b128 v[20:23], v14 offset:9216
    s_waitcnt lgkmcnt(3)
    v_mfma_f32_32x32x16_bf16 v[32:47], a[24:27], v[24:27], v[32:47]
    ds_read_b128 v[24:27], v14 offset:10240
    s_waitcnt lgkmcnt(3)
    v_mfma_f32_32x32x16_bf16 v[32:47], a[28:31], v[28:31], v[32:47]
    ds_read_b128 v[28:31], v14 offset:11264
    s_waitcnt lgkmcnt(3)
    v_mfma_f32_32x32x16_bf16 v[32:47], a[32:35], v[16:19], v[32:47]
    ds_read_b128 v[16:19], v14 offset:12288
    s_waitcnt lgkmcnt(3)
    v_mfma_f32_32x32x16_bf16 v[32:47], a[36:39], v[20:23], v[32:47]
    ds_read_b128 v[20:23], v14 offset:13312
    s_waitcnt lgkmcnt(3)
    v_mfma_f32_32x32x16_bf16 v[32:47], a[40:43], v[24:27], v[32:47]
    ds_read_b128 v[24:27], v14 offset:14336
    s_waitcnt lgkmcnt(3)
    v_mfma_f32_32x32x16_bf16 v[32:47], a[44:47], v[28:31], v[32:47]
    ds_read_b128 v[28:31], v14 offset:15360
    s_waitcnt lgkmcnt(3)
    v_mfma_f32_32x32x16_bf16 v[32:47], a[48:51], v[16:19], v[32:47]
    ds_read_b128 v[16:19], v14 offset:16384
    s_waitcnt lgkmcnt(3)
    v_mfma_f32_32x32x16_bf16 v[32:47], a[52:55], v[20:23], v[32:47]
    ds_read_b128 v[20:23], v14 offset:17408
    s_waitcnt lgkmcnt(3)
    v_mfma_f32_32x32x16_bf16 v[32:47], a[56:59], v[24:27], v[32:47]
    ds_read_b128 v[24:27], v14 offset:18432
    s_waitcnt lgkmcnt(3)
    v_mfma_f32_32x32x16_bf16 v[32:47], a[60:63], v[28:31], v[32:47]
    ds_read_b128 v[28:31], v14 offset:19456
    s_waitcnt lgkmcnt(3)
    v_mfma_f32_32x32x16_bf16 v[32:47], a[64:67], v[16:19], v[32:47]
    ds_read_b128 v[16:19], v14 offset:20480
    s_waitcnt lgkmcnt(3)
    v_mfma_f32_32x32x16_bf16 v[32:47], a[68:71], v[20:23], v[32:47]
    ds_read_b128 v[20:23], v14 offset:21504
    s_waitcnt lgkmcnt(3)
    v_mfma_f32_32x32x16_bf16 v[32:47], a[72:75], v[24:27], v[32:47]
    ds_read_b128 v[24:27], v14 offset:22528
    s_waitcnt lgkmcnt(3)
    v_mfma_f32_32x32x16_bf16 v[32:47], a[76:79], v[28:31], v[32:47]
    ds_read_b128 v[28:31], v14 offset:23552
    s_waitcnt lgkmcnt(3)
    v_mfma_f32_32x32x16_bf16 v[32:47], a[80:83], v[16:19], v[32:47]
    ds_read_b128 v[16:19], v14 offset:24576
    s_waitcnt lgkmcnt(3)
    v_mfma_f32_32x32x16_bf16 v[32:47], a[84:87], v[20:23], v[32:47]
    ds_read_b128 v[20:23], v14 offset:25600
    s_waitcnt lgkmcnt(3)
    v_mfma_f32_32x32x16_bf16 v[32:47], a[88:91], v[24:27], v[32:47]
    ds_read_b128 v[24:27], v14 offset:26624
    s_waitcnt lgkmcnt(3)
    v_mfma_f32_32x32x16_bf16 v[32:47], a[92:95], v[28:31], v[32:47]
    ds_read_b128 v[28:31], v14 offset:27648
    s_waitcnt lgkmcnt(3)
    v_mfma_f32_32x32x16_bf16 v[32:47], a[96:99], v[16:19], v[32:47]
    ds_read_b128 v[16:19], v14 offset:28672
    s_waitcnt lgkmcnt(3)
    v_mfma_f32_32x32x16_bf16 v[32:47], a[100:103], v[20:23], v[32:47]
    ds_read_b128 v[20:23], v14 offset:29696
    s_waitcnt lgkmcnt(3)
    v_mfma_f32_32x32x16_bf16 v[32:47], a[104:107], v[24:27], v[32:47]
    ds_read_b128 v[24:27], v14 offset:30720
    s_waitcnt lgkmcnt(3)
    v_mfma_f32_32x32x16_bf16 v[32:47], a[108:111], v[28:31], v[32:47]
    ds_read_b128 v[28:31], v14 offset:31744
    s_waitcnt lgkmcnt(3)
    v_mfma_f32_32x32x16_bf16 v[32:47], a[112:115], v[16:19], v[32:47]
    ds_read_b128 v[16:19], v14 offset:32768
    s_waitcnt lgkmcnt(3)
    v_mfma_f32_32x32x16_bf16 v[32:47], a[116:119], v[20:23], v[32:47]
    ds_read_b128 v[20:23], v14 offset:33792
    s_waitcnt lgkmcnt(3)
    v_mfma_f32_32x32x16_bf16 v[32:47], a[120:123], v[24:27], v[32:47]
    ds_read_b128 v[24:27], v14 offset:34816
    s_waitcnt lgkmcnt(3)
    v_mfma_f32_32x32x16_bf16 v[32:47], a[124:127], v[28:31], v[32:47]
    ds_read_b128 v[28:31], v14 offset:35840
    s_waitcnt lgkmcnt(3)
    v_mfma_f32_32x32x16_bf16 v[32:47], a[128:131], v[16:19], v[32:47]
    ds_read_b128 v[16:19], v14 offset:0
    s_waitcnt lgkmcnt(3)
    v_mfma_f32_32x32x16_bf16 v[32:47], a[132:135], v[20:23], v[32:47]
    ds_read_b128 v[20:23], v14 offset:1024
    s_waitcnt lgkmcnt(3)
    v_mfma_f32_32x32x16_bf16 v[32:47], a[136:139], v[24:27], v[32:47]
    ds_read_b128 v[24:27], v14 offset:2048
    s_waitcnt lgkmcnt(3)
    v_mfma_f32_32x32x16_bf16 v[32:47], a[140:143], v[28:31], v[32:47]
    ds_read_b128 v[28:31], v14 offset:3072
    s_waitcnt lgkmcnt(3)
    v_mfma_f32_32x32x16_bf16 v[48:63], v[16:19], a[144:147], 0
    ds_read_b128 v[16:19], v14 offset:4096
    s_waitcnt lgkmcnt(3)
    v_mfma_f32_32x32x16_bf16 v[48:63], v[20:23], a[148:151], v[48:63]
    ds_read_b128 v[20:23], v14 offset:5120
    s_waitcnt lgkmcnt(3)
    v_mfma_f32_32x32x16_bf16 v[48:63], v[24:27], a[152:155], v[48:63]
    v_cvt_pk_bf16_f32 v64, v32, v33
    v_cvt_pk_bf16_f32 v65, v34, v35
    ds_read_b128 v[24:27], v14 offset:6144
    s_waitcnt lgkmcnt(3)
    v_mfma_f32_32x32x16_bf16 v[48:63], v[28:31], a[156:159], v[48:63]
    v_cvt_pk_bf16_f32 v66, v36, v37
    v_cvt_pk_bf16_f32 v67, v38, v39
    ds_read_b128 v[28:31], v14 offset:7168
    s_waitcnt lgkmcnt(3)
    v_mfma_f32_32x32x16_bf16 v[48:63], v[16:19], a[160:163], v[48:63]
    v_cvt_pk_bf16_f32 v68, v40, v41
    v_cvt_pk_bf16_f32 v69, v42, v43
    ds_read_b128 v[16:19], v14 offset:8192
    s_waitcnt lgkmcnt(3)
    v_mfma_f32_32x32x16_bf16 v[48:63], v[20:23], a[164:167], v[48:63]
    v_cvt_pk_bf16_f32 v70, v44, v45
    v_cvt_pk_bf16_f32 v71, v46, v47
    ds_read_b128 v[20:23], v14 offset:9216
    s_waitcnt lgkmcnt(3)
    v_mfma_f32_32x32x16_bf16 v[48:63], v[24:27], a[168:171], v[48:63]
    s_nop 1
    v_permlane32_swap_b32 v64, v66
    ds_read_b128 v[24:27], v14 offset:10240
    s_waitcnt lgkmcnt(3)
    v_mfma_f32_32x32x16_bf16 v[48:63], v[28:31], a[172:175], v[48:63]
    v_permlane32_swap_b32 v65, v67
    v_permlane32_swap_b32 v68, v70
    ds_read_b128 v[28:31], v14 offset:11264
    s_waitcnt lgkmcnt(3)
    v_mfma_f32_32x32x16_bf16 v[48:63], v[16:19], a[176:179], v[48:63]
    v_permlane32_swap_b32 v69, v71
    s_add_u32 s28, s27, 20971520
    ds_read_b128 v[16:19], v14 offset:12288
    s_waitcnt lgkmcnt(3)
    v_mfma_f32_32x32x16_bf16 v[48:63], v[20:23], a[180:183], v[48:63]
    buffer_store_dwordx4 v[64:67], v15, s[8:11], s28 offen sc1
    buffer_store_dwordx4 v[68:71], v15, s[8:11], s28 offen offset:512 sc1
    ds_read_b128 v[20:23], v14 offset:13312
    s_waitcnt lgkmcnt(3)
    v_mfma_f32_32x32x16_bf16 v[48:63], v[24:27], a[184:187], v[48:63]
    ds_read_b128 v[24:27], v14 offset:14336
    s_waitcnt lgkmcnt(3)
    v_mfma_f32_32x32x16_bf16 v[48:63], v[28:31], a[188:191], v[48:63]
    ds_read_b128 v[28:31], v14 offset:15360
    s_waitcnt lgkmcnt(3)
    v_mfma_f32_32x32x16_bf16 v[48:63], v[16:19], a[192:195], v[48:63]
    ds_read_b128 v[16:19], v14 offset:16384
    s_waitcnt lgkmcnt(3)
    v_mfma_f32_32x32x16_bf16 v[48:63], v[20:23], a[196:199], v[48:63]
    ds_read_b128 v[20:23], v14 offset:17408
    s_waitcnt lgkmcnt(3)
    v_mfma_f32_32x32x16_bf16 v[48:63], v[24:27], a[200:203], v[48:63]
    ds_read_b128 v[24:27], v14 offset:18432
    s_waitcnt lgkmcnt(3)
    v_mfma_f32_32x32x16_bf16 v[48:63], v[28:31], a[204:207], v[48:63]
    ds_read_b128 v[28:31], v14 offset:19456
    s_waitcnt lgkmcnt(3)
    v_mfma_f32_32x32x16_bf16 v[48:63], v[16:19], a[208:211], v[48:63]
    ds_read_b128 v[16:19], v14 offset:20480
    s_waitcnt lgkmcnt(3)
    v_mfma_f32_32x32x16_bf16 v[48:63], v[20:23], a[212:215], v[48:63]
    ds_read_b128 v[20:23], v14 offset:21504
    s_waitcnt lgkmcnt(3)
    v_mfma_f32_32x32x16_bf16 v[48:63], v[24:27], a[216:219], v[48:63]
    ds_read_b128 v[24:27], v14 offset:22528
    s_waitcnt lgkmcnt(3)
    v_mfma_f32_32x32x16_bf16 v[48:63], v[28:31], a[220:223], v[48:63]
    ds_read_b128 v[28:31], v14 offset:23552
    s_waitcnt lgkmcnt(3)
    v_mfma_f32_32x32x16_bf16 v[48:63], v[16:19], a[224:227], v[48:63]
    ds_read_b128 v[16:19], v14 offset:24576
    s_waitcnt lgkmcnt(3)
    v_mfma_f32_32x32x16_bf16 v[48:63], v[20:23], a[228:231], v[48:63]
    ds_read_b128 v[20:23], v14 offset:25600
    s_waitcnt lgkmcnt(3)
    v_mfma_f32_32x32x16_bf16 v[48:63], v[24:27], a[232:235], v[48:63]
    ds_read_b128 v[24:27], v14 offset:26624
    s_waitcnt lgkmcnt(3)
    v_mfma_f32_32x32x16_bf16 v[48:63], v[28:31], a[236:239], v[48:63]
    ds_read_b128 v[28:31], v14 offset:27648
    s_waitcnt lgkmcnt(3)
    v_mfma_f32_32x32x16_bf16 v[48:63], v[16:19], a[240:243], v[48:63]
    ds_read_b128 v[16:19], v14 offset:28672
    s_waitcnt lgkmcnt(3)
    v_mfma_f32_32x32x16_bf16 v[48:63], v[20:23], a[244:247], v[48:63]
    ds_read_b128 v[20:23], v14 offset:29696
    s_waitcnt lgkmcnt(3)
    v_mfma_f32_32x32x16_bf16 v[48:63], v[24:27], a[248:251], v[48:63]
    ds_read_b128 v[24:27], v14 offset:30720
    s_waitcnt lgkmcnt(3)
    v_mfma_f32_32x32x16_bf16 v[48:63], v[28:31], a[252:255], v[48:63]
    ds_read_b128 v[28:31], v14 offset:31744
    s_waitcnt lgkmcnt(3)
    v_mfma_f32_32x32x16_bf16 v[48:63], v[16:19], v[80:83], v[48:63]
    ds_read_b128 v[16:19], v14 offset:32768
    s_waitcnt lgkmcnt(3)
    v_mfma_f32_32x32x16_bf16 v[48:63], v[20:23], v[84:87], v[48:63]
    ds_read_b128 v[20:23], v14 offset:33792
    s_waitcnt lgkmcnt(3)
    v_mfma_f32_32x32x16_bf16 v[48:63], v[24:27], v[88:91], v[48:63]
    ds_read_b128 v[24:27], v14 offset:34816
    s_waitcnt lgkmcnt(3)
    v_mfma_f32_32x32x16_bf16 v[48:63], v[28:31], v[92:95], v[48:63]
    ds_read_b128 v[28:31], v14 offset:35840
    s_waitcnt lgkmcnt(3)
    v_mfma_f32_32x32x16_bf16 v[48:63], v[16:19], v[96:99], v[48:63]
    s_waitcnt lgkmcnt(2)
    v_mfma_f32_32x32x16_bf16 v[48:63], v[20:23], v[100:103], v[48:63]
    s_waitcnt lgkmcnt(1)
    v_mfma_f32_32x32x16_bf16 v[48:63], v[24:27], v[104:107], v[48:63]
    s_waitcnt lgkmcnt(0)
    v_mfma_f32_32x32x16_bf16 v[48:63], v[28:31], v[108:111], v[48:63]
    s_nop 11
    v_cvt_pk_bf16_f32 v64, v48, v49
    v_cvt_pk_bf16_f32 v65, v50, v51
    v_cvt_pk_bf16_f32 v66, v56, v57
    v_cvt_pk_bf16_f32 v67, v58, v59
    v_cvt_pk_bf16_f32 v68, v52, v53
    v_cvt_pk_bf16_f32 v69, v54, v55
    v_cvt_pk_bf16_f32 v70, v60, v61
    v_cvt_pk_bf16_f32 v71, v62, v63
    s_add_u32 s28, s27, 37748736
    buffer_store_dwordx4 v[64:67], v15, s[8:11], s28 offen sc1
    buffer_store_dwordx4 v[68:71], v15, s[8:11], s28 offen offset:512 sc1
    s_add_u32 s27, s27, 262144
    s_add_u32 s30, s30, 1
    s_cmp_ge_u32 s30, 64
    s_cbranch_scc1 kv_done
    s_waitcnt vmcnt(4)
    s_barrier
    s_sub_u32 s36, s30, 1
    s_cmp_eq_u32 s22, 0
    s_cbranch_scc0 kv_np_b
    v_mov_b32 v72, s36
    v_mov_b32 v73, 0
    s_mov_b64 exec, 1
    s_add_u32 s37, s31, 4096
    buffer_store_dword v72, v73, s[8:11], s37 offen sc1
    s_add_u32 s37, s31, 8192
    buffer_store_dword v72, v73, s[8:11], s37 offen sc1
    s_mov_b64 exec, -1
kv_np_b:
    s_add_u32 s36, s30, 1
    s_cmp_lt_u32 s36, 64
    s_cbranch_scc0 kv_nd_b
    s_add_u32 m0, s26, 36864
    s_add_u32 s32, s29, 0
    buffer_load_dwordx4 v13, s[8:11], s32 offen offset:0 sc1 lds
    buffer_load_dwordx4 v13, s[8:11], s32 offen offset:1024 sc1 lds
    buffer_load_dwordx4 v13, s[8:11], s32 offen offset:2048 sc1 lds
    buffer_load_dwordx4 v13, s[8:11], s32 offen offset:3072 sc1 lds
    s_add_u32 m0, s26, 40960
    s_add_u32 s32, s29, 4096
    buffer_load_dwordx4 v13, s[8:11], s32 offen offset:0 sc1 lds
    buffer_load_dwordx4 v13, s[8:11], s32 offen offset:1024 sc1 lds
    buffer_load_dwordx4 v13, s[8:11], s32 offen offset:2048 sc1 lds
    buffer_load_dwordx4 v13, s[8:11], s32 offen offset:3072 sc1 lds
    s_add_u32 m0, s26, 45056
    s_add_u32 s32, s29, 8192
    buffer_load_dwordx4 v13, s[8:11], s32 offen offset:0 sc1 lds
    s_add_u32 s29, s29, 36864
kv_nd_b:
    ds_read_b128 v[16:19], v12 offset:0
    ds_read_b128 v[20:23], v12 offset:1024
    ds_read_b128 v[24:27], v12 offset:2048
    ds_read_b128 v[28:31], v12 offset:3072
    s_waitcnt lgkmcnt(3)
    v_mfma_f32_32x32x16_bf16 v[32:47], a[0:3], v[16:19], 0
    ds_read_b128 v[16:19], v12 offset:4096
    s_waitcnt lgkmcnt(3)
    v_mfma_f32_32x32x16_bf16 v[32:47], a[4:7], v[20:23], v[32:47]
    ds_read_b128 v[20:23], v12 offset:5120
    s_waitcnt lgkmcnt(3)
    v_mfma_f32_32x32x16_bf16 v[32:47], a[8:11], v[24:27], v[32:47]
    ds_read_b128 v[24:27], v12 offset:6144
    s_waitcnt lgkmcnt(3)
    v_mfma_f32_32x32x16_bf16 v[32:47], a[12:15], v[28:31], v[32:47]
    ds_read_b128 v[28:31], v12 offset:7168
    s_waitcnt lgkmcnt(3)
    v_mfma_f32_32x32x16_bf16 v[32:47], a[16:19], v[16:19], v[32:47]
    ds_read_b128 v[16:19], v12 offset:8192
    s_waitcnt lgkmcnt(3)
    v_mfma_f32_32x32x16_bf16 v[32:47], a[20:23], v[20:23], v[32:47]
    ds_read_b128 v[20:23], v12 offset:9216
    s_waitcnt lgkmcnt(3)
    v_mfma_f32_32x32x16_bf16 v[32:47], a[24:27], v[24:27], v[32:47]
    ds_read_b128 v[24:27], v12 offset:10240
    s_waitcnt lgkmcnt(3)
    v_mfma_f32_32x32x16_bf16 v[32:47], a[28:31], v[28:31], v[32:47]
    ds_read_b128 v[28:31], v12 offset:11264
    s_waitcnt lgkmcnt(3)
    v_mfma_f32_32x32x16_bf16 v[32:47], a[32:35], v[16:19], v[32:47]
    ds_read_b128 v[16:19], v12 offset:12288
    s_waitcnt lgkmcnt(3)
    v_mfma_f32_32x32x16_bf16 v[32:47], a[36:39], v[20:23], v[32:47]
    ds_read_b128 v[20:23], v12 offset:13312
    s_waitcnt lgkmcnt(3)
    v_mfma_f32_32x32x16_bf16 v[32:47], a[40:43], v[24:27], v[32:47]
    ds_read_b128 v[24:27], v12 offset:14336
    s_waitcnt lgkmcnt(3)
    v_mfma_f32_32x32x16_bf16 v[32:47], a[44:47], v[28:31], v[32:47]
    ds_read_b128 v[28:31], v12 offset:15360
    s_waitcnt lgkmcnt(3)
    v_mfma_f32_32x32x16_bf16 v[32:47], a[48:51], v[16:19], v[32:47]
    ds_read_b128 v[16:19], v12 offset:16384
    s_waitcnt lgkmcnt(3)
    v_mfma_f32_32x32x16_bf16 v[32:47], a[52:55], v[20:23], v[32:47]
    ds_read_b128 v[20:23], v12 offset:17408
    s_waitcnt lgkmcnt(3)
    v_mfma_f32_32x32x16_bf16 v[32:47], a[56:59], v[24:27], v[32:47]
    ds_read_b128 v[24:27], v12 offset:18432
    s_waitcnt lgkmcnt(3)
    v_mfma_f32_32x32x16_bf16 v[32:47], a[60:63], v[28:31], v[32:47]
    ds_read_b128 v[28:31], v12 offset:19456
    s_waitcnt lgkmcnt(3)
    v_mfma_f32_32x32x16_bf16 v[32:47], a[64:67], v[16:19], v[32:47]
    ds_read_b128 v[16:19], v12 offset:20480
    s_waitcnt lgkmcnt(3)
    v_mfma_f32_32x32x16_bf16 v[32:47], a[68:71], v[20:23], v[32:47]
    ds_read_b128 v[20:23], v12 offset:21504
    s_waitcnt lgkmcnt(3)
    v_mfma_f32_32x32x16_bf16 v[32:47], a[72:75], v[24:27], v[32:47]
    ds_read_b128 v[24:27], v12 offset:22528
    s_waitcnt lgkmcnt(3)
    v_mfma_f32_32x32x16_bf16 v[32:47], a[76:79], v[28:31], v[32:47]
    ds_read_b128 v[28:31], v12 offset:23552
    s_waitcnt lgkmcnt(3)
    v_mfma_f32_32x32x16_bf16 v[32:47], a[80:83], v[16:19], v[32:47]
    ds_read_b128 v[16:19], v12 offset:24576
    s_waitcnt lgkmcnt(3)
    v_mfma_f32_32x32x16_bf16 v[32:47], a[84:87], v[20:23], v[32:47]
    ds_read_b128 v[20:23], v12 offset:25600
    s_waitcnt lgkmcnt(3)
    v_mfma_f32_32x32x16_bf16 v[32:47], a[88:91], v[24:27], v[32:47]
    ds_read_b128 v[24:27], v12 offset:26624
    s_waitcnt lgkmcnt(3)
    v_mfma_f32_32x32x16_bf16 v[32:47], a[92:95], v[28:31], v[32:47]
    ds_read_b128 v[28:31], v12 offset:27648
    s_waitcnt lgkmcnt(3)
    v_mfma_f32_32x32x16_bf16 v[32:47], a[96:99], v[16:19], v[32:47]
    ds_read_b128 v[16:19], v12 offset:28672
    s_waitcnt lgkmcnt(3)
    v_mfma_f32_32x32x16_bf16 v[32:47], a[100:103], v[20:23], v[32:47]
    ds_read_b128 v[20:23], v12 offset:29696
    s_waitcnt lgkmcnt(3)
    v_mfma_f32_32x32x16_bf16 v[32:47], a[104:107], v[24:27], v[32:47]
    ds_read_b128 v[24:27], v12 offset:30720
    s_waitcnt lgkmcnt(3)
    v_mfma_f32_32x32x16_bf16 v[32:47], a[108:111], v[28:31], v[32:47]
    ds_read_b128 v[28:31], v12 offset:31744
    s_waitcnt lgkmcnt(3)
    v_mfma_f32_32x32x16_bf16 v[32:47], a[112:115], v[16:19], v[32:47]
    ds_read_b128 v[16:19], v12 offset:32768
    s_waitcnt lgkmcnt(3)
    v_mfma_f32_32x32x16_bf16 v[32:47], a[116:119], v[20:23], v[32:47]
    ds_read_b128 v[20:23], v12 offset:33792
    s_waitcnt lgkmcnt(3)
    v_mfma_f32_32x32x16_bf16 v[32:47], a[120:123], v[24:27], v[32:47]
    ds_read_b128 v[24:27], v12 offset:34816
    s_waitcnt lgkmcnt(3)
    v_mfma_f32_32x32x16_bf16 v[32:47], a[124:127], v[28:31], v[32:47]
    ds_read_b128 v[28:31], v12 offset:35840
    s_waitcnt lgkmcnt(3)
    v_mfma_f32_32x32x16_bf16 v[32:47], a[128:131], v[16:19], v[32:47]
    ds_read_b128 v[16:19], v12 offset:0
    s_waitcnt lgkmcnt(3)
    v_mfma_f32_32x32x16_bf16 v[32:47], a[132:135], v[20:23], v[32:47]
    ds_read_b128 v[20:23], v12 offset:1024
    s_waitcnt lgkmcnt(3)
    v_mfma_f32_32x32x16_bf16 v[32:47], a[136:139], v[24:27], v[32:47]
    ds_read_b128 v[24:27], v12 offset:2048
    s_waitcnt lgkmcnt(3)
    v_mfma_f32_32x32x16_bf16 v[32:47], a[140:143], v[28:31], v[32:47]
    ds_read_b128 v[28:31], v12 offset:3072
    s_waitcnt lgkmcnt(3)
    v_mfma_f32_32x32x16_bf16 v[48:63], v[16:19], a[144:147], 0
    ds_read_b128 v[16:19], v12 offset:4096
    s_waitcnt lgkmcnt(3)
    v_mfma_f32_32x32x16_bf16 v[48:63], v[20:23], a[148:151], v[48:63]
    ds_read_b128 v[20:23], v12 offset:5120
    s_waitcnt lgkmcnt(3)
    v_mfma_f32_32x32x16_bf16 v[48:63], v[24:27], a[152:155], v[48:63]
    v_cvt_pk_bf16_f32 v64, v32, v33
    v_cvt_pk_bf16_f32 v65, v34, v35
    ds_read_b128 v[24:27], v12 offset:6144
    s_waitcnt lgkmcnt(3)
    v_mfma_f32_32x32x16_bf16 v[48:63], v[28:31], a[156:159], v[48:63]
    v_cvt_pk_bf16_f32 v66, v36, v37
    v_cvt_pk_bf16_f32 v67, v38, v39
    ds_read_b128 v[28:31], v12 offset:7168
    s_waitcnt lgkmcnt(3)
    v_mfma_f32_32x32x16_bf16 v[48:63], v[16:19], a[160:163], v[48:63]
    v_cvt_pk_bf16_f32 v68, v40, v41
    v_cvt_pk_bf16_f32 v69, v42, v43
    ds_read_b128 v[16:19], v12 offset:8192
    s_waitcnt lgkmcnt(3)
    v_mfma_f32_32x32x16_bf16 v[48:63], v[20:23], a[164:167], v[48:63]
    v_cvt_pk_bf16_f32 v70, v44, v45
    v_cvt_pk_bf16_f32 v71, v46, v47
    ds_read_b128 v[20:23], v12 offset:9216
    s_waitcnt lgkmcnt(3)
    v_mfma_f32_32x32x16_bf16 v[48:63], v[24:27], a[168:171], v[48:63]
    s_nop 1
    v_permlane32_swap_b32 v64, v66
    ds_read_b128 v[24:27], v12 offset:10240
    s_waitcnt lgkmcnt(3)
    v_mfma_f32_32x32x16_bf16 v[48:63], v[28:31], a[172:175], v[48:63]
    v_permlane32_swap_b32 v65, v67
    v_permlane32_swap_b32 v68, v70
    ds_read_b128 v[28:31], v12 offset:11264
    s_waitcnt lgkmcnt(3)
    v_mfma_f32_32x32x16_bf16 v[48:63], v[16:19], a[176:179], v[48:63]
    v_permlane32_swap_b32 v69, v71
    s_add_u32 s28, s27, 20971520
    ds_read_b128 v[16:19], v12 offset:12288
    s_waitcnt lgkmcnt(3)
    v_mfma_f32_32x32x16_bf16 v[48:63], v[20:23], a[180:183], v[48:63]
    buffer_store_dwordx4 v[64:67], v15, s[8:11], s28 offen sc1
    buffer_store_dwordx4 v[68:71], v15, s[8:11], s28 offen offset:512 sc1
    ds_read_b128 v[20:23], v12 offset:13312
    s_waitcnt lgkmcnt(3)
    v_mfma_f32_32x32x16_bf16 v[48:63], v[24:27], a[184:187], v[48:63]
    ds_read_b128 v[24:27], v12 offset:14336
    s_waitcnt lgkmcnt(3)
    v_mfma_f32_32x32x16_bf16 v[48:63], v[28:31], a[188:191], v[48:63]
    ds_read_b128 v[28:31], v12 offset:15360
    s_waitcnt lgkmcnt(3)
    v_mfma_f32_32x32x16_bf16 v[48:63], v[16:19], a[192:195], v[48:63]
    ds_read_b128 v[16:19], v12 offset:16384
    s_waitcnt lgkmcnt(3)
    v_mfma_f32_32x32x16_bf16 v[48:63], v[20:23], a[196:199], v[48:63]
    ds_read_b128 v[20:23], v12 offset:17408
    s_waitcnt lgkmcnt(3)
    v_mfma_f32_32x32x16_bf16 v[48:63], v[24:27], a[200:203], v[48:63]
    ds_read_b128 v[24:27], v12 offset:18432
    s_waitcnt lgkmcnt(3)
    v_mfma_f32_32x32x16_bf16 v[48:63], v[28:31], a[204:207], v[48:63]
    ds_read_b128 v[28:31], v12 offset:19456
    s_waitcnt lgkmcnt(3)
    v_mfma_f32_32x32x16_bf16 v[48:63], v[16:19], a[208:211], v[48:63]
    ds_read_b128 v[16:19], v12 offset:20480
    s_waitcnt lgkmcnt(3)
    v_mfma_f32_32x32x16_bf16 v[48:63], v[20:23], a[212:215], v[48:63]
    ds_read_b128 v[20:23], v12 offset:21504
    s_waitcnt lgkmcnt(3)
    v_mfma_f32_32x32x16_bf16 v[48:63], v[24:27], a[216:219], v[48:63]
    ds_read_b128 v[24:27], v12 offset:22528
    s_waitcnt lgkmcnt(3)
    v_mfma_f32_32x32x16_bf16 v[48:63], v[28:31], a[220:223], v[48:63]
    ds_read_b128 v[28:31], v12 offset:23552
    s_waitcnt lgkmcnt(3)
    v_mfma_f32_32x32x16_bf16 v[48:63], v[16:19], a[224:227], v[48:63]
    ds_read_b128 v[16:19], v12 offset:24576
    s_waitcnt lgkmcnt(3)
    v_mfma_f32_32x32x16_bf16 v[48:63], v[20:23], a[228:231], v[48:63]
    ds_read_b128 v[20:23], v12 offset:25600
    s_waitcnt lgkmcnt(3)
    v_mfma_f32_32x32x16_bf16 v[48:63], v[24:27], a[232:235], v[48:63]
    ds_read_b128 v[24:27], v12 offset:26624
    s_waitcnt lgkmcnt(3)
    v_mfma_f32_32x32x16_bf16 v[48:63], v[28:31], a[236:239], v[48:63]
    ds_read_b128 v[28:31], v12 offset:27648
    s_waitcnt lgkmcnt(3)
    v_mfma_f32_32x32x16_bf16 v[48:63], v[16:19], a[240:243], v[48:63]
    ds_read_b128 v[16:19], v12 offset:28672
    s_waitcnt lgkmcnt(3)
    v_mfma_f32_32x32x16_bf16 v[48:63], v[20:23], a[244:247], v[48:63]
    ds_read_b128 v[20:23], v12 offset:29696
    s_waitcnt lgkmcnt(3)
    v_mfma_f32_32x32x16_bf16 v[48:63], v[24:27], a[248:251], v[48:63]
    ds_read_b128 v[24:27], v12 offset:30720
    s_waitcnt lgkmcnt(3)
    v_mfma_f32_32x32x16_bf16 v[48:63], v[28:31], a[252:255], v[48:63]
    ds_read_b128 v[28:31], v12 offset:31744
    s_waitcnt lgkmcnt(3)
    v_mfma_f32_32x32x16_bf16 v[48:63], v[16:19], v[80:83], v[48:63]
    ds_read_b128 v[16:19], v12 offset:32768
    s_waitcnt lgkmcnt(3)
    v_mfma_f32_32x32x16_bf16 v[48:63], v[20:23], v[84:87], v[48:63]
    ds_read_b128 v[20:23], v12 offset:33792
    s_waitcnt lgkmcnt(3)
    v_mfma_f32_32x32x16_bf16 v[48:63], v[24:27], v[88:91], v[48:63]
    ds_read_b128 v[24:27], v12 offset:34816
    s_waitcnt lgkmcnt(3)
    v_mfma_f32_32x32x16_bf16 v[48:63], v[28:31], v[92:95], v[48:63]
    ds_read_b128 v[28:31], v12 offset:35840
    s_waitcnt lgkmcnt(3)
    v_mfma_f32_32x32x16_bf16 v[48:63], v[16:19], v[96:99], v[48:63]
    s_waitcnt lgkmcnt(2)
    v_mfma_f32_32x32x16_bf16 v[48:63], v[20:23], v[100:103], v[48:63]
    s_waitcnt lgkmcnt(1)
    v_mfma_f32_32x32x16_bf16 v[48:63], v[24:27], v[104:107], v[48:63]
    s_waitcnt lgkmcnt(0)
    v_mfma_f32_32x32x16_bf16 v[48:63], v[28:31], v[108:111], v[48:63]
    s_nop 11
    v_cvt_pk_bf16_f32 v64, v48, v49
    v_cvt_pk_bf16_f32 v65, v50, v51
    v_cvt_pk_bf16_f32 v66, v56, v57
    v_cvt_pk_bf16_f32 v67, v58, v59
    v_cvt_pk_bf16_f32 v68, v52, v53
    v_cvt_pk_bf16_f32 v69, v54, v55
    v_cvt_pk_bf16_f32 v70, v60, v61
    v_cvt_pk_bf16_f32 v71, v62, v63
    s_add_u32 s28, s27, 37748736
    buffer_store_dwordx4 v[64:67], v15, s[8:11], s28 offen sc1
    buffer_store_dwordx4 v[68:71], v15, s[8:11], s28 offen offset:512 sc1
    s_add_u32 s27, s27, 262144
    s_add_u32 s30, s30, 1
    s_cmp_lt_u32 s30, 64
    s_cbranch_scc1 kv_loop
kv_done:
    s_waitcnt vmcnt(0)
    s_barrier
    s_mov_b32 s36, 64
    s_cmp_eq_u32 s22, 0
    s_cbranch_scc0 kv_np_end
    v_mov_b32 v72, s36
    v_mov_b32 v73, 0
    s_mov_b64 exec, 1
    s_add_u32 s37, s31, 4096
    buffer_store_dword v72, v73, s[8:11], s37 offen sc1
    s_add_u32 s37, s31, 8192
    buffer_store_dword v72, v73, s[8:11], s37 offen sc1
    s_mov_b64 exec, -1
kv_np_end:
kv_timeout:
    s_branch L_exit
L_att_in:
    s_load_dwordx2 s[4:5], s[0:1], 0
    s_load_dwordx2 s[12:13], s[0:1], 40
    s_load_dwordx2 s[36:37], s[0:1], 16
    s_waitcnt lgkmcnt(0)
    s_and_b32 s5, s5, 0xffff
    s_mov_b32 s6, 2359296
    s_mov_b32 s7, 0x20000
    s_and_b32 s13, s13, 0xffff
    s_mov_b32 s14, 4718592
    s_mov_b32 s15, 0x20000
    s_lshl_b32 s83, s82, 5
    s_add_u32 s83, s83, s79
    s_lshl_b32 s84, s83, 7
    s_add_u32 s81, s84, 73424896
    s_lshl_b32 s86, s82, 8
    s_lshl_b32 s87, s79, 2
    s_add_u32 s86, s86, s87
    s_add_u32 s86, s86, 73441280
    s_add_u32 s87, s86, 128
    v_mov_b32 v1, 0
    v_mov_b32 v2, 0
    buffer_store_dword v1, v2, s[8:11], s81 offen sc1
    buffer_store_dword v1, v2, s[8:11], s86 offen sc1
    buffer_store_dword v1, v2, s[8:11], s87 offen sc1
    s_cmp_ge_u32 s83, 64
    s_cbranch_scc1 L_att_noln
    s_add_u32 s85, s84, 73416704
    v_mov_b32 v1, 0
    v_mov_b32 v2, 0
    buffer_store_dword v1, v2, s[8:11], s85 offen sc1
    s_waitcnt vmcnt(0)
    s_barrier
    v_cmp_eq_u32 vcc, 0, v0
    s_and_saveexec_b64 s[20:21], vcc
    s_cbranch_execz att_arr
    v_mov_b32 v1, 1
    v_mov_b32 v2, 192
    buffer_atomic_add v1, v2, s[16:19], 0 offen
att_arr:
    s_mov_b64 exec, s[20:21]
    v_and_b32 v1, 63, v0
    v_lshrrev_b32 v2, 6, v0
    v_and_b32 v3, 31, v1
    v_lshrrev_b32 v4, 5, v1
    v_mul_u32_u24 v5, 1152, v3
    v_lshlrev_b32 v6, 4, v4
    v_add_u32 v5, v5, v6
    v_mul_u32_u24 v6, 288, v2
    v_add_u32 v5, v5, v6
    v_lshlrev_b32 v9, 4, v1
    v_mul_u32_u24 v10, 9216, v2
    v_add_u32 v9, v9, v10
    v_lshrrev_b32 v6, 4, v3
    v_lshlrev_b32 v6, 10, v6
    v_lshl_add_u32 v6, v4, 8, v6
    v_and_b32 v7, 15, v3
    v_lshl_add_u32 v6, v7, 4, v6
    s_nop 0
    v_readfirstlane_b32 s22, v2
    s_mul_i32 s49, s83, 36864
    s_add_u32 s51, s49, 0
    buffer_load_dwordx4 v[16:19], v5, s[4:7], s49 offen offset:0
    buffer_load_dwordx4 v[20:23], v5, s[4:7], s49 offen offset:32
    buffer_load_dwordx4 v[24:27], v5, s[4:7], s49 offen offset:64
    buffer_load_dwordx4 v[28:31], v5, s[4:7], s49 offen offset:96
    buffer_load_dwordx4 v[32:35], v5, s[4:7], s49 offen offset:128
    buffer_load_dwordx4 v[36:39], v5, s[4:7], s49 offen offset:160
    buffer_load_dwordx4 v[40:43], v5, s[4:7], s49 offen offset:192
    buffer_load_dwordx4 v[44:47], v5, s[4:7], s49 offen offset:224
    buffer_load_dwordx4 v[48:51], v5, s[4:7], s49 offen offset:256
    s_waitcnt vmcnt(0)
    v_lshlrev_b32 v64, 16, v16
    v_and_b32 v65, 0xffff0000, v16
    v_lshlrev_b32 v66, 16, v17
    v_and_b32 v67, 0xffff0000, v17
    v_lshlrev_b32 v68, 16, v18
    v_and_b32 v69, 0xffff0000, v18
    v_lshlrev_b32 v70, 16, v19
    v_and_b32 v71, 0xffff0000, v19
    v_lshlrev_b32 v72, 16, v20
    v_and_b32 v73, 0xffff0000, v20
    v_lshlrev_b32 v74, 16, v21
    v_and_b32 v75, 0xffff0000, v21
    v_lshlrev_b32 v76, 16, v22
    v_and_b32 v77, 0xffff0000, v22
    v_lshlrev_b32 v78, 16, v23
    v_and_b32 v79, 0xffff0000, v23
    v_lshlrev_b32 v80, 16, v24
    v_and_b32 v81, 0xffff0000, v24
    v_lshlrev_b32 v82, 16, v25
    v_and_b32 v83, 0xffff0000, v25
    v_lshlrev_b32 v84, 16, v26
    v_and_b32 v85, 0xffff0000, v26
    v_lshlrev_b32 v86, 16, v27
    v_and_b32 v87, 0xffff0000, v27
    v_lshlrev_b32 v88, 16, v28
    v_and_b32 v89, 0xffff0000, v28
    v_lshlrev_b32 v90, 16, v29
    v_and_b32 v91, 0xffff0000, v29
    v_lshlrev_b32 v92, 16, v30
    v_and_b32 v93, 0xffff0000, v30
    v_lshlrev_b32 v94, 16, v31
    v_and_b32 v95, 0xffff0000, v31
    v_lshlrev_b32 v96, 16, v32
    v_and_b32 v97, 0xffff0000, v32
    v_lshlrev_b32 v98, 16, v33
    v_and_b32 v99, 0xffff0000, v33
    v_lshlrev_b32 v100, 16, v34
    v_and_b32 v101, 0xffff0000, v34
    v_lshlrev_b32 v102, 16, v35
    v_and_b32 v103, 0xffff0000, v35
    v_lshlrev_b32 v104, 16, v36
    v_and_b32 v105, 0xffff0000, v36
    v_lshlrev_b32 v106, 16, v37
    v_and_b32 v107, 0xffff0000, v37
    v_lshlrev_b32 v108, 16, v38
    v_and_b32 v109, 0xffff0000, v38
    v_lshlrev_b32 v110, 16, v39
    v_and_b32 v111, 0xffff0000, v39
    v_lshlrev_b32 v112, 16, v40
    v_and_b32 v113, 0xffff0000, v40
    v_lshlrev_b32 v114, 16, v41
    v_and_b32 v115, 0xffff0000, v41
    v_lshlrev_b32 v116, 16, v42
    v_and_b32 v117, 0xffff0000, v42
    v_lshlrev_b32 v118, 16, v43
    v_and_b32 v119, 0xffff0000, v43
    v_lshlrev_b32 v120, 16, v44
    v_and_b32 v121, 0xffff0000, v44
    v_lshlrev_b32 v122, 16, v45
    v_and_b32 v123, 0xffff0000, v45
    v_lshlrev_b32 v124, 16, v46
    v_and_b32 v125, 0xffff0000, v46
    v_lshlrev_b32 v126, 16, v47
    v_and_b32 v127, 0xffff0000, v47
    v_lshlrev_b32 v128, 16, v48
    v_and_b32 v129, 0xffff0000, v48
    v_lshlrev_b32 v130, 16, v49
    v_and_b32 v131, 0xffff0000, v49
    v_lshlrev_b32 v132, 16, v50
    v_and_b32 v133, 0xffff0000, v50
    v_lshlrev_b32 v134, 16, v51
    v_and_b32 v135, 0xffff0000, v51
    v_add_f32 v7, v64, v65
    v_add_f32 v7, v7, v66
    v_add_f32 v7, v7, v67
    v_add_f32 v7, v7, v68
    v_add_f32 v7, v7, v69
    v_add_f32 v7, v7, v70
    v_add_f32 v7, v7, v71
    v_add_f32 v7, v7, v72
    v_add_f32 v7, v7, v73
    v_add_f32 v7, v7, v74
    v_add_f32 v7, v7, v75
    v_add_f32 v7, v7, v76
    v_add_f32 v7, v7, v77
    v_add_f32 v7, v7, v78
    v_add_f32 v7, v7, v79
    v_add_f32 v7, v7, v80
    v_add_f32 v7, v7, v81
    v_add_f32 v7, v7, v82
    v_add_f32 v7, v7, v83
    v_add_f32 v7, v7, v84
    v_add_f32 v7, v7, v85
    v_add_f32 v7, v7, v86
    v_add_f32 v7, v7, v87
    v_add_f32 v7, v7, v88
    v_add_f32 v7, v7, v89
    v_add_f32 v7, v7, v90
    v_add_f32 v7, v7, v91
    v_add_f32 v7, v7, v92
    v_add_f32 v7, v7, v93
    v_add_f32 v7, v7, v94
    v_add_f32 v7, v7, v95
    v_add_f32 v7, v7, v96
    v_add_f32 v7, v7, v97
    v_add_f32 v7, v7, v98
    v_add_f32 v7, v7, v99
    v_add_f32 v7, v7, v100
    v_add_f32 v7, v7, v101
    v_add_f32 v7, v7, v102
    v_add_f32 v7, v7, v103
    v_add_f32 v7, v7, v104
    v_add_f32 v7, v7, v105
    v_add_f32 v7, v7, v106
    v_add_f32 v7, v7, v107
    v_add_f32 v7, v7, v108
    v_add_f32 v7, v7, v109
    v_add_f32 v7, v7, v110
    v_add_f32 v7, v7, v111
    v_add_f32 v7, v7, v112
    v_add_f32 v7, v7, v113
    v_add_f32 v7, v7, v114
    v_add_f32 v7, v7, v115
    v_add_f32 v7, v7, v116
    v_add_f32 v7, v7, v117
    v_add_f32 v7, v7, v118
    v_add_f32 v7, v7, v119
    v_add_f32 v7, v7, v120
    v_add_f32 v7, v7, v121
    v_add_f32 v7, v7, v122
    v_add_f32 v7, v7, v123
    v_add_f32 v7, v7, v124
    v_add_f32 v7, v7, v125
    v_add_f32 v7, v7, v126
    v_add_f32 v7, v7, v127
    v_add_f32 v7, v7, v128
    v_add_f32 v7, v7, v129
    v_add_f32 v7, v7, v130
    v_add_f32 v7, v7, v131
    v_add_f32 v7, v7, v132
    v_add_f32 v7, v7, v133
    v_add_f32 v7, v7, v134
    v_add_f32 v7, v7, v135
    v_mov_b32 v8, v7
    s_nop 1
    v_permlane32_swap_b32 v7, v8
    v_add_f32 v7, v7, v8
    v_lshlrev_b32 v11, 2, v3
    v_lshl_add_u32 v12, v2, 7, v11
    ds_write_b32 v12, v7 offset:0
    s_waitcnt lgkmcnt(0)
    s_barrier
    ds_read_b32 v12, v11 offset:0
    ds_read_b32 v13, v11 offset:128
    ds_read_b32 v14, v11 offset:256
    ds_read_b32 v15, v11 offset:384
    s_waitcnt lgkmcnt(0)
    v_add_f32 v12, v12, v13
    v_add_f32 v14, v14, v15
    v_add_f32 v7, v12, v14
    v_mul_f32 v7, 0x3ae38e39, v7
    v_sub_f32 v64, v64, v7
    v_sub_f32 v65, v65, v7
    v_sub_f32 v66, v66, v7
    v_sub_f32 v67, v67, v7
    v_sub_f32 v68, v68, v7
    v_sub_f32 v69, v69, v7
    v_sub_f32 v70, v70, v7
    v_sub_f32 v71, v71, v7
    v_sub_f32 v72, v72, v7
    v_sub_f32 v73, v73, v7
    v_sub_f32 v74, v74, v7
    v_sub_f32 v75, v75, v7
    v_sub_f32 v76, v76, v7
    v_sub_f32 v77, v77, v7
    v_sub_f32 v78, v78, v7
    v_sub_f32 v79, v79, v7
    v_sub_f32 v80, v80, v7
    v_sub_f32 v81, v81, v7
    v_sub_f32 v82, v82, v7
    v_sub_f32 v83, v83, v7
    v_sub_f32 v84, v84, v7
    v_sub_f32 v85, v85, v7
    v_sub_f32 v86, v86, v7
    v_sub_f32 v87, v87, v7
    v_sub_f32 v88, v88, v7
    v_sub_f32 v89, v89, v7
    v_sub_f32 v90, v90, v7
    v_sub_f32 v91, v91, v7
    v_sub_f32 v92, v92, v7
    v_sub_f32 v93, v93, v7
    v_sub_f32 v94, v94, v7
    v_sub_f32 v95, v95, v7
    v_sub_f32 v96, v96, v7
    v_sub_f32 v97, v97, v7
    v_sub_f32 v98, v98, v7
    v_sub_f32 v99, v99, v7
    v_sub_f32 v100, v100, v7
    v_sub_f32 v101, v101, v7
    v_sub_f32 v102, v102, v7
    v_sub_f32 v103, v103, v7
    v_sub_f32 v104, v104, v7
    v_sub_f32 v105, v105, v7
    v_sub_f32 v106, v106, v7
    v_sub_f32 v107, v107, v7
    v_sub_f32 v108, v108, v7
    v_sub_f32 v109, v109, v7
    v_sub_f32 v110, v110, v7
    v_sub_f32 v111, v111, v7
    v_sub_f32 v112, v112, v7
    v_sub_f32 v113, v113, v7
    v_sub_f32 v114, v114, v7
    v_sub_f32 v115, v115, v7
    v_sub_f32 v116, v116, v7
    v_sub_f32 v117, v117, v7
    v_sub_f32 v118, v118, v7
    v_sub_f32 v119, v119, v7
    v_sub_f32 v120, v120, v7
    v_sub_f32 v121, v121, v7
    v_sub_f32 v122, v122, v7
    v_sub_f32 v123, v123, v7
    v_sub_f32 v124, v124, v7
    v_sub_f32 v125, v125, v7
    v_sub_f32 v126, v126, v7
    v_sub_f32 v127, v127, v7
    v_sub_f32 v128, v128, v7
    v_sub_f32 v129, v129, v7
    v_sub_f32 v130, v130, v7
    v_sub_f32 v131, v131, v7
    v_sub_f32 v132, v132, v7
    v_sub_f32 v133, v133, v7
    v_sub_f32 v134, v134, v7
    v_sub_f32 v135, v135, v7
    v_mul_f32 v52, v64, v64
    v_fmac_f32 v52, v65, v65
    v_fmac_f32 v52, v66, v66
    v_fmac_f32 v52, v67, v67
    v_fmac_f32 v52, v68, v68
    v_fmac_f32 v52, v69, v69
    v_fmac_f32 v52, v70, v70
    v_fmac_f32 v52, v71, v71
    v_fmac_f32 v52, v72, v72
    v_fmac_f32 v52, v73, v73
    v_fmac_f32 v52, v74, v74
    v_fmac_f32 v52, v75, v75
    v_fmac_f32 v52, v76, v76
    v_fmac_f32 v52, v77, v77
    v_fmac_f32 v52, v78, v78
    v_fmac_f32 v52, v79, v79
    v_fmac_f32 v52, v80, v80
    v_fmac_f32 v52, v81, v81
    v_fmac_f32 v52, v82, v82
    v_fmac_f32 v52, v83, v83
    v_fmac_f32 v52, v84, v84
    v_fmac_f32 v52, v85, v85
    v_fmac_f32 v52, v86, v86
    v_fmac_f32 v52, v87, v87
    v_fmac_f32 v52, v88, v88
    v_fmac_f32 v52, v89, v89
    v_fmac_f32 v52, v90, v90
    v_fmac_f32 v52, v91, v91
    v_fmac_f32 v52, v92, v92
    v_fmac_f32 v52, v93, v93
    v_fmac_f32 v52, v94, v94
    v_fmac_f32 v52, v95, v95
    v_fmac_f32 v52, v96, v96
    v_fmac_f32 v52, v97, v97
    v_fmac_f32 v52, v98, v98
    v_fmac_f32 v52, v99, v99
    v_fmac_f32 v52, v100, v100
    v_fmac_f32 v52, v101, v101
    v_fmac_f32 v52, v102, v102
    v_fmac_f32 v52, v103, v103
    v_fmac_f32 v52, v104, v104
    v_fmac_f32 v52, v105, v105
    v_fmac_f32 v52, v106, v106
    v_fmac_f32 v52, v107, v107
    v_fmac_f32 v52, v108, v108
    v_fmac_f32 v52, v109, v109
    v_fmac_f32 v52, v110, v110
    v_fmac_f32 v52, v111, v111
    v_fmac_f32 v52, v112, v112
    v_fmac_f32 v52, v113, v113
    v_fmac_f32 v52, v114, v114
    v_fmac_f32 v52, v115, v115
    v_fmac_f32 v52, v116, v116
    v_fmac_f32 v52, v117, v117
    v_fmac_f32 v52, v118, v118
    v_fmac_f32 v52, v119, v119
    v_fmac_f32 v52, v120, v120
    v_fmac_f32 v52, v121, v121
    v_fmac_f32 v52, v122, v122
    v_fmac_f32 v52, v123, v123
    v_fmac_f32 v52, v124, v124
    v_fmac_f32 v52, v125, v125
    v_fmac_f32 v52, v126, v126
    v_fmac_f32 v52, v127, v127
    v_fmac_f32 v52, v128, v128
    v_fmac_f32 v52, v129, v129
    v_fmac_f32 v52, v130, v130
    v_fmac_f32 v52, v131, v131
    v_fmac_f32 v52, v132, v132
    v_fmac_f32 v52, v133, v133
    v_fmac_f32 v52, v134, v134
    v_fmac_f32 v52, v135, v135
    v_mov_b32 v8, v52
    s_nop 1
    v_permlane32_swap_b32 v52, v8
    v_add_f32 v52, v52, v8
    v_lshlrev_b32 v11, 2, v3
    v_lshl_add_u32 v12, v2, 7, v11
    ds_write_b32 v12, v52 offset:512
    s_waitcnt lgkmcnt(0)
    s_barrier
    ds_read_b32 v12, v11 offset:512
    ds_read_b32 v13, v11 offset:640
    ds_read_b32 v14, v11 offset:768
    ds_read_b32 v15, v11 offset:896
    s_waitcnt lgkmcnt(0)
    v_add_f32 v12, v12, v13
    v_add_f32 v14, v14, v15
    v_add_f32 v52, v12, v14
    v_mov_b32 v8, 0x3727c5ac
    v_fmac_f32 v8, 0x3ae38e39, v52
    v_rsq_f32 v8, v8
    s_nop 0
    v_pk_mul_f32 v[64:65], v[64:65], v[8:9] op_sel_hi:[1,0]
    v_pk_mul_f32 v[66:67], v[66:67], v[8:9] op_sel_hi:[1,0]
    v_pk_mul_f32 v[68:69], v[68:69], v[8:9] op_sel_hi:[1,0]
    v_pk_mul_f32 v[70:71], v[70:71], v[8:9] op_sel_hi:[1,0]
    v_pk_mul_f32 v[72:73], v[72:73], v[8:9] op_sel_hi:[1,0]
    v_pk_mul_f32 v[74:75], v[74:75], v[8:9] op_sel_hi:[1,0]
    v_pk_mul_f32 v[76:77], v[76:77], v[8:9] op_sel_hi:[1,0]
    v_pk_mul_f32 v[78:79], v[78:79], v[8:9] op_sel_hi:[1,0]
    v_pk_mul_f32 v[80:81], v[80:81], v[8:9] op_sel_hi:[1,0]
    v_pk_mul_f32 v[82:83], v[82:83], v[8:9] op_sel_hi:[1,0]
    v_pk_mul_f32 v[84:85], v[84:85], v[8:9] op_sel_hi:[1,0]
    v_pk_mul_f32 v[86:87], v[86:87], v[8:9] op_sel_hi:[1,0]
    v_pk_mul_f32 v[88:89], v[88:89], v[8:9] op_sel_hi:[1,0]
    v_pk_mul_f32 v[90:91], v[90:91], v[8:9] op_sel_hi:[1,0]
    v_pk_mul_f32 v[92:93], v[92:93], v[8:9] op_sel_hi:[1,0]
    v_pk_mul_f32 v[94:95], v[94:95], v[8:9] op_sel_hi:[1,0]
    v_pk_mul_f32 v[96:97], v[96:97], v[8:9] op_sel_hi:[1,0]
    v_pk_mul_f32 v[98:99], v[98:99], v[8:9] op_sel_hi:[1,0]
    v_pk_mul_f32 v[100:101], v[100:101], v[8:9] op_sel_hi:[1,0]
    v_pk_mul_f32 v[102:103], v[102:103], v[8:9] op_sel_hi:[1,0]
    v_pk_mul_f32 v[104:105], v[104:105], v[8:9] op_sel_hi:[1,0]
    v_pk_mul_f32 v[106:107], v[106:107], v[8:9] op_sel_hi:[1,0]
    v_pk_mul_f32 v[108:109], v[108:109], v[8:9] op_sel_hi:[1,0]
    v_pk_mul_f32 v[110:111], v[110:111], v[8:9] op_sel_hi:[1,0]
    v_pk_mul_f32 v[112:113], v[112:113], v[8:9] op_sel_hi:[1,0]
    v_pk_mul_f32 v[114:115], v[114:115], v[8:9] op_sel_hi:[1,0]
    v_pk_mul_f32 v[116:117], v[116:117], v[8:9] op_sel_hi:[1,0]
    v_pk_mul_f32 v[118:119], v[118:119], v[8:9] op_sel_hi:[1,0]
    v_pk_mul_f32 v[120:121], v[120:121], v[8:9] op_sel_hi:[1,0]
    v_pk_mul_f32 v[122:123], v[122:123], v[8:9] op_sel_hi:[1,0]
    v_pk_mul_f32 v[124:125], v[124:125], v[8:9] op_sel_hi:[1,0]
    v_pk_mul_f32 v[126:127], v[126:127], v[8:9] op_sel_hi:[1,0]
    v_pk_mul_f32 v[128:129], v[128:129], v[8:9] op_sel_hi:[1,0]
    v_pk_mul_f32 v[130:131], v[130:131], v[8:9] op_sel_hi:[1,0]
    v_pk_mul_f32 v[132:133], v[132:133], v[8:9] op_sel_hi:[1,0]
    v_pk_mul_f32 v[134:135], v[134:135], v[8:9] op_sel_hi:[1,0]
    v_cvt_pk_bf16_f32 v16, v64, v65
    v_cvt_pk_bf16_f32 v17, v66, v67
    v_cvt_pk_bf16_f32 v18, v68, v69
    v_cvt_pk_bf16_f32 v19, v70, v71
    v_cvt_pk_bf16_f32 v20, v72, v73
    v_cvt_pk_bf16_f32 v21, v74, v75
    v_cvt_pk_bf16_f32 v22, v76, v77
    v_cvt_pk_bf16_f32 v23, v78, v79
    v_cvt_pk_bf16_f32 v24, v80, v81
    v_cvt_pk_bf16_f32 v25, v82, v83
    v_cvt_pk_bf16_f32 v26, v84, v85
    v_cvt_pk_bf16_f32 v27, v86, v87
    v_cvt_pk_bf16_f32 v28, v88, v89
    v_cvt_pk_bf16_f32 v29, v90, v91
    v_cvt_pk_bf16_f32 v30, v92, v93
    v_cvt_pk_bf16_f32 v31, v94, v95
    v_cvt_pk_bf16_f32 v32, v96, v97
    v_cvt_pk_bf16_f32 v33, v98, v99
    v_cvt_pk_bf16_f32 v34, v100, v101
    v_cvt_pk_bf16_f32 v35, v102, v103
    v_cvt_pk_bf16_f32 v36, v104, v105
    v_cvt_pk_bf16_f32 v37, v106, v107
    v_cvt_pk_bf16_f32 v38, v108, v109
    v_cvt_pk_bf16_f32 v39, v110, v111
    v_cvt_pk_bf16_f32 v40, v112, v113
    v_cvt_pk_bf16_f32 v41, v114, v115
    v_cvt_pk_bf16_f32 v42, v116, v117
    v_cvt_pk_bf16_f32 v43, v118, v119
    v_cvt_pk_bf16_f32 v44, v120, v121
    v_cvt_pk_bf16_f32 v45, v122, v123
    v_cvt_pk_bf16_f32 v46, v124, v125
    v_cvt_pk_bf16_f32 v47, v126, v127
    v_cvt_pk_bf16_f32 v48, v128, v129
    v_cvt_pk_bf16_f32 v49, v130, v131
    v_cvt_pk_bf16_f32 v50, v132, v133
    v_cvt_pk_bf16_f32 v51, v134, v135
    s_mov_b32 s21, s51
    buffer_store_dwordx4 v[16:19], v9, s[8:11], s21 offen offset:0 sc1
    buffer_store_dwordx4 v[20:23], v9, s[8:11], s21 offen offset:1024 sc1
    buffer_store_dwordx4 v[24:27], v9, s[8:11], s21 offen offset:2048 sc1
    buffer_store_dwordx4 v[28:31], v9, s[8:11], s21 offen offset:3072 sc1
    s_add_u32 s21, s21, 4096
    buffer_store_dwordx4 v[32:35], v9, s[8:11], s21 offen offset:0 sc1
    buffer_store_dwordx4 v[36:39], v9, s[8:11], s21 offen offset:1024 sc1
    buffer_store_dwordx4 v[40:43], v9, s[8:11], s21 offen offset:2048 sc1
    buffer_store_dwordx4 v[44:47], v9, s[8:11], s21 offen offset:3072 sc1
    s_add_u32 s21, s21, 4096
    buffer_store_dwordx4 v[48:51], v9, s[8:11], s21 offen offset:0 sc1
    s_lshl_b32 s46, s83, 7
    s_add_u32 s46, s46, 73416704
    s_mov_b32 s47, 1
    s_waitcnt vmcnt(0)
    s_barrier
    s_cmp_eq_u32 s22, 0
    s_cbranch_scc0 ln1_np_l1
    v_mov_b32 v250, s47
    v_mov_b32 v251, 0
    s_mov_b64 exec, 1
    buffer_store_dword v250, v251, s[8:11], s46 offen sc1
    s_mov_b64 exec, -1
ln1_np_l1:
    s_branch L_att_go
L_att_noln:
    s_waitcnt vmcnt(0)
    s_barrier
    v_cmp_eq_u32 vcc, 0, v0
    s_and_saveexec_b64 s[20:21], vcc
    s_cbranch_execz att2_arr
    v_mov_b32 v1, 1
    v_mov_b32 v2, 192
    buffer_atomic_add v1, v2, s[16:19], 0 offen
att2_arr:
    s_mov_b64 exec, s[20:21]
L_att_go:
    v_lshrrev_b32 v2, 6, v0
    s_nop 0
    v_readfirstlane_b32 s22, v2
    s_mul_i32 s40, s79, 147456
    v_and_b32 v1, 63, v0
    v_lshrrev_b32 v2, 6, v0
    v_lshlrev_b32 v3, 4, v1
    v_mul_u32_u24 v4, 9216, v2
    v_add_u32 v4, v4, v3
    v_lshrrev_b32 v5, 4, v1
    v_bfe_u32 v6, v1, 2, 2
    v_and_b32 v7, 3, v1
    v_lshl_add_u32 v8, v5, 2, v6
    v_mul_u32_u24 v8, 1152, v8
    v_mul_u32_u24 v9, 288, v2
    v_add_u32 v8, v8, v9
    v_lshl_add_u32 v9, v7, 4, v8
    v_lshl_add_u32 v10, v7, 3, v8
    v_add_u32 v9, 81920, v9
    v_add_u32 v10, 81920, v10
    v_add_u32 v11, 36864, v9
    v_add_u32 v12, 36864, v10
    s_mul_i32 s24, s22, 9216
    s_add_u32 m0, s24, 81920
    s_add_u32 s25, s40, 0
    buffer_load_dwordx4 v4, s[12:15], s25 offen offset:0 lds
    buffer_load_dwordx4 v4, s[12:15], s25 offen offset:1024 lds
    buffer_load_dwordx4 v4, s[12:15], s25 offen offset:2048 lds
    buffer_load_dwordx4 v4, s[12:15], s25 offen offset:3072 lds
    s_add_u32 m0, s24, 86016
    s_add_u32 s25, s40, 4096
    buffer_load_dwordx4 v4, s[12:15], s25 offen offset:0 lds
    buffer_load_dwordx4 v4, s[12:15], s25 offen offset:1024 lds
    buffer_load_dwordx4 v4, s[12:15], s25 offen offset:2048 lds
    buffer_load_dwordx4 v4, s[12:15], s25 offen offset:3072 lds
    s_add_u32 m0, s24, 90112
    s_add_u32 s25, s40, 8192
    buffer_load_dwordx4 v4, s[12:15], s25 offen offset:0 lds
    s_add_u32 m0, s24, 118784
    s_add_u32 s25, s40, 36864
    buffer_load_dwordx4 v4, s[12:15], s25 offen offset:0 lds
    buffer_load_dwordx4 v4, s[12:15], s25 offen offset:1024 lds
    buffer_load_dwordx4 v4, s[12:15], s25 offen offset:2048 lds
    buffer_load_dwordx4 v4, s[12:15], s25 offen offset:3072 lds
    s_add_u32 m0, s24, 122880
    s_add_u32 s25, s40, 40960
    buffer_load_dwordx4 v4, s[12:15], s25 offen offset:0 lds
    buffer_load_dwordx4 v4, s[12:15], s25 offen offset:1024 lds
    buffer_load_dwordx4 v4, s[12:15], s25 offen offset:2048 lds
    buffer_load_dwordx4 v4, s[12:15], s25 offen offset:3072 lds
    s_add_u32 m0, s24, 126976
    s_add_u32 s25, s40, 45056
    buffer_load_dwordx4 v4, s[12:15], s25 offen offset:0 lds
    s_waitcnt vmcnt(9)
    s_barrier
    ds_read_b64_tr_b16 a[0:1], v9 offset:0
    ds_read_b64_tr_b16 a[2:3], v9 offset:18432
    ds_read_b64_tr_b16 a[16:17], v9 offset:8
    ds_read_b64_tr_b16 a[18:19], v9 offset:18440
    ds_read_b64_tr_b16 a[32:33], v9 offset:64
    ds_read_b64_tr_b16 a[34:35], v9 offset:18496
    ds_read_b64_tr_b16 a[48:49], v9 offset:72
    ds_read_b64_tr_b16 a[50:51], v9 offset:18504
    ds_read_b64_tr_b16 a[64:65], v9 offset:128
    ds_read_b64_tr_b16 a[66:67], v9 offset:18560
    ds_read_b64_tr_b16 a[80:81], v9 offset:136
    ds_read_b64_tr_b16 a[82:83], v9 offset:18568
    ds_read_b64_tr_b16 a[96:97], v9 offset:192
    ds_read_b64_tr_b16 a[98:99], v9 offset:18624
    ds_read_b64_tr_b16 a[112:113], v9 offset:200
    ds_read_b64_tr_b16 a[114:115], v9 offset:18632
    ds_read_b64_tr_b16 a[128:129], v10 offset:256
    ds_read_b64_tr_b16 a[130:131], v10 offset:18688
    s_waitcnt lgkmcnt(0)
    s_barrier
    s_add_u32 m0, s24, 81920
    s_add_u32 s25, s40, 73728
    buffer_load_dwordx4 v4, s[12:15], s25 offen offset:0 lds
    buffer_load_dwordx4 v4, s[12:15], s25 offen offset:1024 lds
    buffer_load_dwordx4 v4, s[12:15], s25 offen offset:2048 lds
    buffer_load_dwordx4 v4, s[12:15], s25 offen offset:3072 lds
    s_add_u32 m0, s24, 86016
    s_add_u32 s25, s40, 77824
    buffer_load_dwordx4 v4, s[12:15], s25 offen offset:0 lds
    buffer_load_dwordx4 v4, s[12:15], s25 offen offset:1024 lds
    buffer_load_dwordx4 v4, s[12:15], s25 offen offset:2048 lds
    buffer_load_dwordx4 v4, s[12:15], s25 offen offset:3072 lds
    s_add_u32 m0, s24, 90112
    s_add_u32 s25, s40, 81920
    buffer_load_dwordx4 v4, s[12:15], s25 offen offset:0 lds
    s_waitcnt vmcnt(9)
    s_barrier
    ds_read_b64_tr_b16 a[4:5], v11 offset:0
    ds_read_b64_tr_b16 a[6:7], v11 offset:18432
    ds_read_b64_tr_b16 a[20:21], v11 offset:8
    ds_read_b64_tr_b16 a[22:23], v11 offset:18440
    ds_read_b64_tr_b16 a[36:37], v11 offset:64
    ds_read_b64_tr_b16 a[38:39], v11 offset:18496
    ds_read_b64_tr_b16 a[52:53], v11 offset:72
    ds_read_b64_tr_b16 a[54:55], v11 offset:18504
    ds_read_b64_tr_b16 a[68:69], v11 offset:128
    ds_read_b64_tr_b16 a[70:71], v11 offset:18560
    ds_read_b64_tr_b16 a[84:85], v11 offset:136
    ds_read_b64_tr_b16 a[86:87], v11 offset:18568
    ds_read_b64_tr_b16 a[100:101], v11 offset:192
    ds_read_b64_tr_b16 a[102:103], v11 offset:18624
    ds_read_b64_tr_b16 a[116:117], v11 offset:200
    ds_read_b64_tr_b16 a[118:119], v11 offset:18632
    ds_read_b64_tr_b16 a[132:133], v12 offset:256
    ds_read_b64_tr_b16 a[134:135], v12 offset:18688
    s_waitcnt lgkmcnt(0)
    s_barrier
    s_add_u32 m0, s24, 118784
    s_add_u32 s25, s40, 110592
    buffer_load_dwordx4 v4, s[12:15], s25 offen offset:0 lds
    buffer_load_dwordx4 v4, s[12:15], s25 offen offset:1024 lds
    buffer_load_dwordx4 v4, s[12:15], s25 offen offset:2048 lds
    buffer_load_dwordx4 v4, s[12:15], s25 offen offset:3072 lds
    s_add_u32 m0, s24, 122880
    s_add_u32 s25, s40, 114688
    buffer_load_dwordx4 v4, s[12:15], s25 offen offset:0 lds
    buffer_load_dwordx4 v4, s[12:15], s25 offen offset:1024 lds
    buffer_load_dwordx4 v4, s[12:15], s25 offen offset:2048 lds
    buffer_load_dwordx4 v4, s[12:15], s25 offen offset:3072 lds
    s_add_u32 m0, s24, 126976
    s_add_u32 s25, s40, 118784
    buffer_load_dwordx4 v4, s[12:15], s25 offen offset:0 lds
    s_waitcnt vmcnt(9)
    s_barrier
    ds_read_b64_tr_b16 a[8:9], v9 offset:0
    ds_read_b64_tr_b16 a[10:11], v9 offset:18432
    ds_read_b64_tr_b16 a[24:25], v9 offset:8
    ds_read_b64_tr_b16 a[26:27], v9 offset:18440
    ds_read_b64_tr_b16 a[40:41], v9 offset:64
    ds_read_b64_tr_b16 a[42:43], v9 offset:18496
    ds_read_b64_tr_b16 a[56:57], v9 offset:72
    ds_read_b64_tr_b16 a[58:59], v9 offset:18504
    ds_read_b64_tr_b16 a[72:73], v9 offset:128
    ds_read_b64_tr_b16 a[74:75], v9 offset:18560
    ds_read_b64_tr_b16 a[88:89], v9 offset:136
    ds_read_b64_tr_b16 a[90:91], v9 offset:18568
    ds_read_b64_tr_b16 a[104:105], v9 offset:192
    ds_read_b64_tr_b16 a[106:107], v9 offset:18624
    ds_read_b64_tr_b16 a[120:121], v9 offset:200
    ds_read_b64_tr_b16 a[122:123], v9 offset:18632
    ds_read_b64_tr_b16 a[136:137], v10 offset:256
    ds_read_b64_tr_b16 a[138:139], v10 offset:18688
    s_waitcnt lgkmcnt(0)
    s_barrier
    s_waitcnt vmcnt(0)
    s_barrier
    ds_read_b64_tr_b16 a[12:13], v11 offset:0
    ds_read_b64_tr_b16 a[14:15], v11 offset:18432
    ds_read_b64_tr_b16 a[28:29], v11 offset:8
    ds_read_b64_tr_b16 a[30:31], v11 offset:18440
    ds_read_b64_tr_b16 a[44:45], v11 offset:64
    ds_read_b64_tr_b16 a[46:47], v11 offset:18496
    ds_read_b64_tr_b16 a[60:61], v11 offset:72
    ds_read_b64_tr_b16 a[62:63], v11 offset:18504
    ds_read_b64_tr_b16 a[76:77], v11 offset:128
    ds_read_b64_tr_b16 a[78:79], v11 offset:18560
    ds_read_b64_tr_b16 a[92:93], v11 offset:136
    ds_read_b64_tr_b16 a[94:95], v11 offset:18568
    ds_read_b64_tr_b16 a[108:109], v11 offset:192
    ds_read_b64_tr_b16 a[110:111], v11 offset:18624
    ds_read_b64_tr_b16 a[124:125], v11 offset:200
    ds_read_b64_tr_b16 a[126:127], v11 offset:18632
    ds_read_b64_tr_b16 a[140:141], v12 offset:256
    ds_read_b64_tr_b16 a[142:143], v12 offset:18688
    s_waitcnt lgkmcnt(0)
    s_barrier
    s_barrier
    s_mov_b32 s12, s36
    s_and_b32 s13, s37, 0xffff
    s_lshl_b32 s23, s79, 8
    v_and_b32 v1, 63, v0
    v_lshrrev_b32 v2, 6, v0
    s_nop 0
    v_readfirstlane_b32 s22, v2
    v_lshrrev_b32 v3, 4, v1
    v_and_b32 v4, 15, v1
    v_lshl_add_u32 v5, v2, 2, v3
    v_mul_u32_u24 v5, 8192, v5
    v_lshlrev_b32 v6, 2, v3
    v_xor_b32 v6, v4, v6
    v_lshl_add_u32 v5, v6, 4, v5
    v_add_u32 v5, s23, v5
    v_lshrrev_b32 v6, 1, v3
    v_and_b32 v7, 1, v3
    v_lshrrev_b32 v8, 2, v4
    v_and_b32 v9, 3, v1
    v_lshl_add_u32 v10, v6, 3, v8
    v_lshlrev_b32 v10, 8, v10
    v_lshlrev_b32 v11, 2, v2
    v_lshl_add_u32 v11, v7, 1, v11
    v_lshrrev_b32 v12, 1, v9
    v_add_u32 v11, v11, v12
    v_lshlrev_b32 v12, 2, v8
    v_xor_b32 v11, v11, v12
    v_lshl_add_u32 v10, v11, 4, v10
    v_and_b32 v12, 1, v9
    v_lshl_add_u32 v10, v12, 3, v10
    v_add_u32 v10, 73728, v10
    s_lshl_b32 s24, s22, 10
    s_add_u32 m0, s24, 73728
    s_mov_b32 s25, 0
    buffer_load_dwordx4 v5, s[12:15], s25 offen lds
    s_add_u32 m0, s24, 77824
    s_mov_b32 s25, 131072
    buffer_load_dwordx4 v5, s[12:15], s25 offen lds
    s_add_u32 m0, s24, 81920
    s_mov_b32 s25, 262144
    buffer_load_dwordx4 v5, s[12:15], s25 offen lds
    s_add_u32 m0, s24, 86016
    s_mov_b32 s25, 393216
    buffer_load_dwordx4 v5, s[12:15], s25 offen lds
    s_add_u32 m0, s24, 90112
    s_mov_b32 s25, 524288
    buffer_load_dwordx4 v5, s[12:15], s25 offen lds
    s_add_u32 m0, s24, 94208
    s_mov_b32 s25, 655360
    buffer_load_dwordx4 v5, s[12:15], s25 offen lds
    s_add_u32 m0, s24, 98304
    s_mov_b32 s25, 786432
    buffer_load_dwordx4 v5, s[12:15], s25 offen lds
    s_add_u32 m0, s24, 102400
    s_mov_b32 s25, 917504
    buffer_load_dwordx4 v5, s[12:15], s25 offen lds
    s_add_u32 m0, s24, 106496
    s_mov_b32 s25, 1048576
    buffer_load_dwordx4 v5, s[12:15], s25 offen lds
    s_add_u32 m0, s24, 110592
    s_mov_b32 s25, 1179648
    buffer_load_dwordx4 v5, s[12:15], s25 offen lds
    s_add_u32 m0, s24, 114688
    s_mov_b32 s25, 1310720
    buffer_load_dwordx4 v5, s[12:15], s25 offen lds
    s_add_u32 m0, s24, 118784
    s_mov_b32 s25, 1441792
    buffer_load_dwordx4 v5, s[12:15], s25 offen lds
    s_waitcnt vmcnt(8)
    s_barrier
    s_add_u32 m0, s24, 122880
    s_mov_b32 s25, 1572864
    buffer_load_dwordx4 v5, s[12:15], s25 offen lds
    s_add_u32 m0, s24, 126976
    s_mov_b32 s25, 1703936
    buffer_load_dwordx4 v5, s[12:15], s25 offen lds
    s_add_u32 m0, s24, 131072
    s_mov_b32 s25, 1835008
    buffer_load_dwordx4 v5, s[12:15], s25 offen lds
    s_add_u32 m0, s24, 135168
    s_mov_b32 s25, 1966080
    buffer_load_dwordx4 v5, s[12:15], s25 offen lds
    ds_read_b64_tr_b16 a[144:145], v10 offset:0
    ds_read_b64_tr_b16 a[146:147], v10 offset:1024
    ds_read_b64_tr_b16 a[148:149], v10 offset:4096
    ds_read_b64_tr_b16 a[150:151], v10 offset:5120
    ds_read_b64_tr_b16 a[152:153], v10 offset:8192
    ds_read_b64_tr_b16 a[154:155], v10 offset:9216
    ds_read_b64_tr_b16 a[156:157], v10 offset:12288
    ds_read_b64_tr_b16 a[158:159], v10 offset:13312
    s_waitcnt lgkmcnt(0)
    s_waitcnt vmcnt(8)
    s_barrier
    s_add_u32 m0, s24, 73728
    s_mov_b32 s25, 2097152
    buffer_load_dwordx4 v5, s[12:15], s25 offen lds
    s_add_u32 m0, s24, 77824
    s_mov_b32 s25, 2228224
    buffer_load_dwordx4 v5, s[12:15], s25 offen lds
    s_add_u32 m0, s24, 81920
    s_mov_b32 s25, 2359296
    buffer_load_dwordx4 v5, s[12:15], s25 offen lds
    s_add_u32 m0, s24, 86016
    s_mov_b32 s25, 2490368
    buffer_load_dwordx4 v5, s[12:15], s25 offen lds
    ds_read_b64_tr_b16 a[160:161], v10 offset:16384
    ds_read_b64_tr_b16 a[162:163], v10 offset:17408
    ds_read_b64_tr_b16 a[164:165], v10 offset:20480
    ds_read_b64_tr_b16 a[166:167], v10 offset:21504
    ds_read_b64_tr_b16 a[168:169], v10 offset:24576
    ds_read_b64_tr_b16 a[170:171], v10 offset:25600
    ds_read_b64_tr_b16 a[172:173], v10 offset:28672
    ds_read_b64_tr_b16 a[174:175], v10 offset:29696
    s_waitcnt lgkmcnt(0)
    s_waitcnt vmcnt(8)
    s_barrier
    s_add_u32 m0, s24, 90112
    s_mov_b32 s25, 2621440
    buffer_load_dwordx4 v5, s[12:15], s25 offen lds
    s_add_u32 m0, s24, 94208
    s_mov_b32 s25, 2752512
    buffer_load_dwordx4 v5, s[12:15], s25 offen lds
    s_add_u32 m0, s24, 98304
    s_mov_b32 s25, 2883584
    buffer_load_dwordx4 v5, s[12:15], s25 offen lds
    s_add_u32 m0, s24, 102400
    s_mov_b32 s25, 3014656
    buffer_load_dwordx4 v5, s[12:15], s25 offen lds
    ds_read_b64_tr_b16 a[176:177], v10 offset:32768
    ds_read_b64_tr_b16 a[178:179], v10 offset:33792
    ds_read_b64_tr_b16 a[180:181], v10 offset:36864
    ds_read_b64_tr_b16 a[182:183], v10 offset:37888
    ds_read_b64_tr_b16 a[184:185], v10 offset:40960
    ds_read_b64_tr_b16 a[186:187], v10 offset:41984
    ds_read_b64_tr_b16 a[188:189], v10 offset:45056
    ds_read_b64_tr_b16 a[190:191], v10 offset:46080
    s_waitcnt lgkmcnt(0)
    s_waitcnt vmcnt(8)
    s_barrier
    s_add_u32 m0, s24, 106496
    s_mov_b32 s25, 3145728
    buffer_load_dwordx4 v5, s[12:15], s25 offen lds
    s_add_u32 m0, s24, 110592
    s_mov_b32 s25, 3276800
    buffer_load_dwordx4 v5, s[12:15], s25 offen lds
    s_add_u32 m0, s24, 114688
    s_mov_b32 s25, 3407872
    buffer_load_dwordx4 v5, s[12:15], s25 offen lds
    s_add_u32 m0, s24, 118784
    s_mov_b32 s25, 3538944
    buffer_load_dwordx4 v5, s[12:15], s25 offen lds
    ds_read_b64_tr_b16 a[192:193], v10 offset:49152
    ds_read_b64_tr_b16 a[194:195], v10 offset:50176
    ds_read_b64_tr_b16 a[196:197], v10 offset:53248
    ds_read_b64_tr_b16 a[198:199], v10 offset:54272
    ds_read_b64_tr_b16 a[200:201], v10 offset:57344
    ds_read_b64_tr_b16 a[202:203], v10 offset:58368
    ds_read_b64_tr_b16 a[204:205], v10 offset:61440
    ds_read_b64_tr_b16 a[206:207], v10 offset:62464
    s_waitcnt lgkmcnt(0)
    s_waitcnt vmcnt(8)
    s_barrier
    s_add_u32 m0, s24, 122880
    s_mov_b32 s25, 3670016
    buffer_load_dwordx4 v5, s[12:15], s25 offen lds
    s_add_u32 m0, s24, 126976
    s_mov_b32 s25, 3801088
    buffer_load_dwordx4 v5, s[12:15], s25 offen lds
    s_add_u32 m0, s24, 131072
    s_mov_b32 s25, 3932160
    buffer_load_dwordx4 v5, s[12:15], s25 offen lds
    s_add_u32 m0, s24, 135168
    s_mov_b32 s25, 4063232
    buffer_load_dwordx4 v5, s[12:15], s25 offen lds
    ds_read_b64_tr_b16 a[208:209], v10 offset:0
    ds_read_b64_tr_b16 a[210:211], v10 offset:1024
    ds_read_b64_tr_b16 a[212:213], v10 offset:4096
    ds_read_b64_tr_b16 a[214:215], v10 offset:5120
    ds_read_b64_tr_b16 a[216:217], v10 offset:8192
    ds_read_b64_tr_b16 a[218:219], v10 offset:9216
    ds_read_b64_tr_b16 a[220:221], v10 offset:12288
    ds_read_b64_tr_b16 a[222:223], v10 offset:13312
    s_waitcnt lgkmcnt(0)
    s_waitcnt vmcnt(8)
    s_barrier
    s_add_u32 m0, s24, 73728
    s_mov_b32 s25, 4194304
    buffer_load_dwordx4 v5, s[12:15], s25 offen lds
    s_add_u32 m0, s24, 77824
    s_mov_b32 s25, 4325376
    buffer_load_dwordx4 v5, s[12:15], s25 offen lds
    s_add_u32 m0, s24, 81920
    s_mov_b32 s25, 4456448
    buffer_load_dwordx4 v5, s[12:15], s25 offen lds
    s_add_u32 m0, s24, 86016
    s_mov_b32 s25, 4587520
    buffer_load_dwordx4 v5, s[12:15], s25 offen lds
    ds_read_b64_tr_b16 a[224:225], v10 offset:16384
    ds_read_b64_tr_b16 a[226:227], v10 offset:17408
    ds_read_b64_tr_b16 a[228:229], v10 offset:20480
    ds_read_b64_tr_b16 a[230:231], v10 offset:21504
    ds_read_b64_tr_b16 a[232:233], v10 offset:24576
    ds_read_b64_tr_b16 a[234:235], v10 offset:25600
    ds_read_b64_tr_b16 a[236:237], v10 offset:28672
    ds_read_b64_tr_b16 a[238:239], v10 offset:29696
    s_waitcnt lgkmcnt(0)
    s_waitcnt vmcnt(8)
    s_barrier
    ds_read_b64_tr_b16 a[240:241], v10 offset:32768
    ds_read_b64_tr_b16 a[242:243], v10 offset:33792
    ds_read_b64_tr_b16 a[244:245], v10 offset:36864
    ds_read_b64_tr_b16 a[246:247], v10 offset:37888
    ds_read_b64_tr_b16 a[248:249], v10 offset:40960
    ds_read_b64_tr_b16 a[250:251], v10 offset:41984
    ds_read_b64_tr_b16 a[252:253], v10 offset:45056
    ds_read_b64_tr_b16 a[254:255], v10 offset:46080
    s_waitcnt lgkmcnt(0)
    s_waitcnt vmcnt(4)
    s_barrier
    ds_read_b64_tr_b16 v[216:217], v10 offset:49152
    ds_read_b64_tr_b16 v[218:219], v10 offset:50176
    ds_read_b64_tr_b16 v[220:221], v10 offset:53248
    ds_read_b64_tr_b16 v[222:223], v10 offset:54272
    ds_read_b64_tr_b16 v[224:225], v10 offset:57344
    ds_read_b64_tr_b16 v[226:227], v10 offset:58368
    ds_read_b64_tr_b16 v[228:229], v10 offset:61440
    ds_read_b64_tr_b16 v[230:231], v10 offset:62464
    s_waitcnt lgkmcnt(0)
    s_waitcnt vmcnt(0)
    s_barrier
    ds_read_b64_tr_b16 v[232:233], v10 offset:0
    ds_read_b64_tr_b16 v[234:235], v10 offset:1024
    ds_read_b64_tr_b16 v[236:237], v10 offset:4096
    ds_read_b64_tr_b16 v[238:239], v10 offset:5120
    ds_read_b64_tr_b16 v[240:241], v10 offset:8192
    ds_read_b64_tr_b16 v[242:243], v10 offset:9216
    ds_read_b64_tr_b16 v[244:245], v10 offset:12288
    ds_read_b64_tr_b16 v[246:247], v10 offset:13312
    s_waitcnt lgkmcnt(0)
    s_barrier
    v_and_b32 v1, 63, v0
    v_lshrrev_b32 v2, 6, v0
    v_lshlrev_b32 v3, 4, v1
    v_lshl_add_u32 v4, v2, 11, v3
    v_lshlrev_b32 v5, 4, v0
    v_and_b32 v6, 15, v1
    v_lshrrev_b32 v7, 4, v1
    v_mul_u32_u24 v8, 1152, v6
    v_mul_u32_u24 v9, 288, v2
    v_add_u32 v8, v8, v9
    v_lshl_add_u32 v9, v7, 3, v8
    v_add_u32 v9, 256, v9
    v_lshl_add_u32 v8, v7, 4, v8
    v_lshlrev_b32 v10, 2, v7
    s_and_b32 s41, s22, 1
    s_lshr_b32 s42, s22, 1
    s_mov_b32 s43, s82
    s_mov_b32 s44, 0
    s_mov_b32 s45, 0
    s_mov_b32 s46, 0
    s_mov_b32 s47, 0
    s_mov_b32 s48, 0
    s_mov_b32 s68, 0
    s_lshl_b32 s49, s79, 7
    s_add_u32 s49, s49, 73400320
    v_lshrrev_b32 v11, 2, v6
    v_and_b32 v12, 1, v6
    v_bfe_u32 v13, v6, 1, 1
    v_lshl_add_u32 v14, v11, 1, v12
    v_lshl_add_u32 v15, v7, 1, v13
    v_mul_u32_u24 v16, 36864, v15
    v_lshl_add_u32 v204, v14, 4, v16
    v_lshlrev_b32 v16, 4, v14
    v_mov_b32 v17, 0x7fff0000
    v_cmp_eq_u32 vcc, 0, v15
    s_nop 1
    v_cndmask_b32 v205, v17, v16, vcc
    v_and_b32 v16, 1, v1
    v_lshlrev_b32 v16, 4, v16
    v_mov_b32 v17, 0x3f80
    v_lshlrev_b32 v16, v16, v17
    v_bfe_u32 v17, v1, 1, 2
    v_cmp_eq_u32 vcc, 0, v17
    s_nop 1
    v_cndmask_b32 v200, 0, v16, vcc
    v_cmp_eq_u32 vcc, 1, v17
    s_nop 1
    v_cndmask_b32 v201, 0, v16, vcc
    v_cmp_eq_u32 vcc, 2, v17
    s_nop 1
    v_cndmask_b32 v202, 0, v16, vcc
    v_cmp_eq_u32 vcc, 3, v17
    s_nop 1
    v_cndmask_b32 v203, 0, v16, vcc
    v_and_b32 v16, 7, v1
    v_lshl_add_u32 v16, v7, 4, v16
    v_lshlrev_b32 v16, 1, v16
    v_add_u32 v16, 102400, v16
    v_lshl_add_u32 v206, v2, 7, v16
    v_lshlrev_b32 v207, 3, v2
    v_add_u32 v207, 102400, v207
    v_mul_u32_u24 v16, 911, v0
    v_lshrrev_b32 v16, 16, v16
    v_mul_u32_u24 v17, 72, v16
    v_sub_u32 v17, v0, v17
    v_mul_u32_u24 v18, 1280, v16
    v_lshl_add_u32 v209, v17, 4, v18
    v_add_u32 v209, 102400, v209
    v_lshlrev_b32 v18, 4, v17
    v_lshrrev_b32 v19, 1, v17
    v_lshlrev_b32 v19, 10, v19
    v_and_b32 v20, 1, v17
    v_lshl_add_u32 v19, v20, 9, v19
    s_lshl_b32 s50, s79, 4
    v_add_u32 v19, s50, v19
    v_add_u32 v19, 115343360, v19
    s_mul_i32 s50, s79, 1152
    v_add_u32 v18, s50, v18
    v_add_u32 v20, 109051904, v18
    v_add_u32 v21, 112197632, v18
    v_cmp_eq_u32 vcc, 0, v16
    s_nop 1
    v_cndmask_b32 v208, v21, v20, vcc
    v_cmp_eq_u32 vcc, 2, v16
    s_nop 1
    v_cndmask_b32 v208, v208, v19, vcc
    v_mov_b32 v17, 0x7fff0000
    v_cmp_lt_u32 vcc, 215, v0
    s_nop 1
    v_cndmask_b32 v208, v208, v17, vcc
    v_add_u32 v11, 0, v10
    v_cmp_gt_u32 s[60:61], v11, v6
    v_add_u32 v11, 1, v10
    v_cmp_gt_u32 s[62:63], v11, v6
    v_add_u32 v11, 2, v10
    v_cmp_gt_u32 s[64:65], v11, v6
    v_add_u32 v11, 3, v10
    v_cmp_gt_u32 s[66:67], v11, v6
    v_lshrrev_b32 v11, 2, v6
    v_and_b32 v12, 1, v6
    v_lshl_add_u32 v11, v11, 1, v12
    v_lshl_add_u32 v11, v7, 3, v11
    v_lshlrev_b32 v11, 4, v11
    v_lshl_add_u32 v213, v2, 9, v11
    v_mul_u32_u24 v11, 9216, v2
    v_add_u32 v210, v11, v3
    v_add_u32 v211, 65536, v3
    v_and_b32 v11, 31, v1
    v_lshrrev_b32 v11, 4, v11
    v_lshlrev_b32 v11, 10, v11
    v_lshrrev_b32 v12, 5, v1
    v_lshl_add_u32 v12, v12, 4, v6
    v_lshl_add_u32 v11, v12, 4, v11
    v_lshl_add_u32 v212, v2, 11, v11
    s_mov_b32 s38, 0x3e0293ee
    s_mov_b32 s39, 0x3e0293ee
    v_mov_b32 v15, 192
    s_mov_b32 s90, 0
att_wa:
    buffer_load_dword v14, v15, s[16:19], 0 offen sc1
    s_add_u32 s90, s90, 1
    s_cmp_gt_u32 s90, 65536
    s_cbranch_scc1 L_exit
    s_waitcnt vmcnt(0)
    v_readfirstlane_b32 s91, v14
    s_cmp_ge_u32 s91, 256
    s_cbranch_scc1 att_wa_ok
    s_sleep 4
    s_branch att_wa
att_wa_ok:
    s_mov_b32 s51, 73416704
    s_mov_b32 s50, 1
    v_and_b32 v250, 63, v0
    v_min_u32 v250, 63, v250
    v_mul_u32_u24 v250, 128, v250
    s_mov_b32 s90, 0
att_pl_ln1:
    buffer_load_dword v251, v250, s[8:11], s51 offen sc1
    s_add_u32 s90, s90, 1
    s_cmp_gt_u32 s90, 65536
    s_cbranch_scc1 att_timeout
    s_waitcnt vmcnt(0)
    v_cmp_gt_u32 vcc, s50, v251
    s_cbranch_vccz att_pl_ok_ln1
    s_sleep 2
    s_branch att_pl_ln1
att_pl_ok_ln1:
    s_mov_b32 s37, 0
    s_mov_b32 s35, 0
    s_mov_b32 s33, 0
att_loop:
    s_and_b32 s57, s44, 1
    s_mul_i32 s57, s57, 24576
    s_cmp_eq_u32 s68, 1
    s_cbranch_scc1 att_haveq
    s_add_u32 s50, s43, 1
    s_add_u32 s51, s49, 4096
    s_cmp_ge_u32 s46, s50
    s_cbranch_scc1 att_pf_ok_a0
    s_mov_b32 s90, 0
    v_mov_b32 v251, 0
att_pf_a0:
    buffer_load_dword v250, v251, s[8:11], s51 offen sc1
    s_add_u32 s90, s90, 1
    s_cmp_gt_u32 s90, 65536
    s_cbranch_scc1 att_timeout
    s_waitcnt vmcnt(0)
    v_readfirstlane_b32 s46, v250
    s_cmp_ge_u32 s46, s50
    s_cbranch_scc1 att_pf_ok_a0
    s_sleep 2
    s_branch att_pf_a0
att_pf_ok_a0:
    s_add_u32 s51, s49, 8192
    s_cmp_ge_u32 s47, s50
    s_cbranch_scc1 att_pf_ok_a1
    s_mov_b32 s90, 0
    v_mov_b32 v251, 0
att_pf_a1:
    buffer_load_dword v250, v251, s[8:11], s51 offen sc1
    s_add_u32 s90, s90, 1
    s_cmp_gt_u32 s90, 65536
    s_cbranch_scc1 att_timeout
    s_waitcnt vmcnt(0)
    v_readfirstlane_b32 s47, v250
    s_cmp_ge_u32 s47, s50
    s_cbranch_scc1 att_pf_ok_a1
    s_sleep 2
    s_branch att_pf_a1
att_pf_ok_a1:
    s_lshl_b32 s52, s43, 5
    s_add_u32 s52, s52, s79
    s_lshl_b32 s53, s52, 13
    s_lshl_b32 s55, s22, 11
    s_add_u32 s55, s55, s57
    s_add_u32 m0, s55, 8192
    s_add_u32 s56, s53, 20971520
    buffer_load_dwordx4 v4, s[8:11], s56 offen sc1 lds
    buffer_load_dwordx4 v4, s[8:11], s56 offen offset:1024 sc1 lds
    s_add_u32 m0, s55, 16384
    s_add_u32 s56, s53, 37748736
    buffer_load_dwordx4 v4, s[8:11], s56 offen sc1 lds
    buffer_load_dwordx4 v4, s[8:11], s56 offen offset:1024 sc1 lds
    s_mul_i32 s53, s43, 36864
    s_add_u32 s53, s53, 0
    s_mul_i32 s55, s22, 9216
    s_add_u32 m0, s55, 65536
    s_add_u32 s56, s53, 0
    buffer_load_dwordx4 v210, s[8:11], s56 offen offset:0 sc1 lds
    buffer_load_dwordx4 v210, s[8:11], s56 offen offset:1024 sc1 lds
    buffer_load_dwordx4 v210, s[8:11], s56 offen offset:2048 sc1 lds
    buffer_load_dwordx4 v210, s[8:11], s56 offen offset:3072 sc1 lds
    s_add_u32 m0, s55, 69632
    s_add_u32 s56, s53, 4096
    buffer_load_dwordx4 v210, s[8:11], s56 offen offset:0 sc1 lds
    buffer_load_dwordx4 v210, s[8:11], s56 offen offset:1024 sc1 lds
    buffer_load_dwordx4 v210, s[8:11], s56 offen offset:2048 sc1 lds
    buffer_load_dwordx4 v210, s[8:11], s56 offen offset:3072 sc1 lds
    s_add_u32 m0, s55, 73728
    s_add_u32 s56, s53, 8192
    buffer_load_dwordx4 v210, s[8:11], s56 offen offset:0 sc1 lds
    s_waitcnt vmcnt(0)
    s_barrier
    ds_read_b128 v[16:19], v211 offset:0
    ds_read_b128 v[20:23], v211 offset:1024
    ds_read_b128 v[24:27], v211 offset:2048
    ds_read_b128 v[28:31], v211 offset:3072
    s_waitcnt lgkmcnt(3)
    v_mfma_f32_32x32x16_bf16 v[32:47], a[144:147], v[16:19], 0
    ds_read_b128 v[16:19], v211 offset:4096
    s_waitcnt lgkmcnt(3)
    v_mfma_f32_32x32x16_bf16 v[32:47], a[148:151], v[20:23], v[32:47]
    ds_read_b128 v[20:23], v211 offset:5120
    s_waitcnt lgkmcnt(3)
    v_mfma_f32_32x32x16_bf16 v[32:47], a[152:155], v[24:27], v[32:47]
    ds_read_b128 v[24:27], v211 offset:6144
    s_waitcnt lgkmcnt(3)
    v_mfma_f32_32x32x16_bf16 v[32:47], a[156:159], v[28:31], v[32:47]
    ds_read_b128 v[28:31], v211 offset:7168
    s_waitcnt lgkmcnt(3)
    v_mfma_f32_32x32x16_bf16 v[32:47], a[160:163], v[16:19], v[32:47]
    ds_read_b128 v[16:19], v211 offset:8192
    s_waitcnt lgkmcnt(3)
    v_mfma_f32_32x32x16_bf16 v[32:47], a[164:167], v[20:23], v[32:47]
    ds_read_b128 v[20:23], v211 offset:9216
    s_waitcnt lgkmcnt(3)
    v_mfma_f32_32x32x16_bf16 v[32:47], a[168:171], v[24:27], v[32:47]
    ds_read_b128 v[24:27], v211 offset:10240
    s_waitcnt lgkmcnt(3)
    v_mfma_f32_32x32x16_bf16 v[32:47], a[172:175], v[28:31], v[32:47]
    ds_read_b128 v[28:31], v211 offset:11264
    s_waitcnt lgkmcnt(3)
    v_mfma_f32_32x32x16_bf16 v[32:47], a[176:179], v[16:19], v[32:47]
    ds_read_b128 v[16:19], v211 offset:12288
    s_waitcnt lgkmcnt(3)
    v_mfma_f32_32x32x16_bf16 v[32:47], a[180:183], v[20:23], v[32:47]
    ds_read_b128 v[20:23], v211 offset:13312
    s_waitcnt lgkmcnt(3)
    v_mfma_f32_32x32x16_bf16 v[32:47], a[184:187], v[24:27], v[32:47]
    ds_read_b128 v[24:27], v211 offset:14336
    s_waitcnt lgkmcnt(3)
    v_mfma_f32_32x32x16_bf16 v[32:47], a[188:191], v[28:31], v[32:47]
    ds_read_b128 v[28:31], v211 offset:15360
    s_waitcnt lgkmcnt(3)
    v_mfma_f32_32x32x16_bf16 v[32:47], a[192:195], v[16:19], v[32:47]
    ds_read_b128 v[16:19], v211 offset:16384
    s_waitcnt lgkmcnt(3)
    v_mfma_f32_32x32x16_bf16 v[32:47], a[196:199], v[20:23], v[32:47]
    ds_read_b128 v[20:23], v211 offset:17408
    s_waitcnt lgkmcnt(3)
    v_mfma_f32_32x32x16_bf16 v[32:47], a[200:203], v[24:27], v[32:47]
    ds_read_b128 v[24:27], v211 offset:18432
    s_waitcnt lgkmcnt(3)
    v_mfma_f32_32x32x16_bf16 v[32:47], a[204:207], v[28:31], v[32:47]
    ds_read_b128 v[28:31], v211 offset:19456
    s_waitcnt lgkmcnt(3)
    v_mfma_f32_32x32x16_bf16 v[32:47], a[208:211], v[16:19], v[32:47]
    ds_read_b128 v[16:19], v211 offset:20480
    s_waitcnt lgkmcnt(3)
    v_mfma_f32_32x32x16_bf16 v[32:47], a[212:215], v[20:23], v[32:47]
    ds_read_b128 v[20:23], v211 offset:21504
    s_waitcnt lgkmcnt(3)
    v_mfma_f32_32x32x16_bf16 v[32:47], a[216:219], v[24:27], v[32:47]
    ds_read_b128 v[24:27], v211 offset:22528
    s_waitcnt lgkmcnt(3)
    v_mfma_f32_32x32x16_bf16 v[32:47], a[220:223], v[28:31], v[32:47]
    ds_read_b128 v[28:31], v211 offset:23552
    s_waitcnt lgkmcnt(3)
    v_mfma_f32_32x32x16_bf16 v[32:47], a[224:227], v[16:19], v[32:47]
    ds_read_b128 v[16:19], v211 offset:24576
    s_waitcnt lgkmcnt(3)
    v_mfma_f32_32x32x16_bf16 v[32:47], a[228:231], v[20:23], v[32:47]
    ds_read_b128 v[20:23], v211 offset:25600
    s_waitcnt lgkmcnt(3)
    v_mfma_f32_32x32x16_bf16 v[32:47], a[232:235], v[24:27], v[32:47]
    ds_read_b128 v[24:27], v211 offset:26624
    s_waitcnt lgkmcnt(3)
    v_mfma_f32_32x32x16_bf16 v[32:47], a[236:239], v[28:31], v[32:47]
    ds_read_b128 v[28:31], v211 offset:27648
    s_waitcnt lgkmcnt(3)
    v_mfma_f32_32x32x16_bf16 v[32:47], a[240:243], v[16:19], v[32:47]
    ds_read_b128 v[16:19], v211 offset:28672
    s_waitcnt lgkmcnt(3)
    v_mfma_f32_32x32x16_bf16 v[32:47], a[244:247], v[20:23], v[32:47]
    ds_read_b128 v[20:23], v211 offset:29696
    s_waitcnt lgkmcnt(3)
    v_mfma_f32_32x32x16_bf16 v[32:47], a[248:251], v[24:27], v[32:47]
    ds_read_b128 v[24:27], v211 offset:30720
    s_waitcnt lgkmcnt(3)
    v_mfma_f32_32x32x16_bf16 v[32:47], a[252:255], v[28:31], v[32:47]
    ds_read_b128 v[28:31], v211 offset:31744
    s_waitcnt lgkmcnt(3)
    v_mfma_f32_32x32x16_bf16 v[32:47], v[216:219], v[16:19], v[32:47]
    ds_read_b128 v[16:19], v211 offset:32768
    s_waitcnt lgkmcnt(3)
    v_mfma_f32_32x32x16_bf16 v[32:47], v[220:223], v[20:23], v[32:47]
    ds_read_b128 v[20:23], v211 offset:33792
    s_waitcnt lgkmcnt(3)
    v_mfma_f32_32x32x16_bf16 v[32:47], v[224:227], v[24:27], v[32:47]
    ds_read_b128 v[24:27], v211 offset:34816
    s_waitcnt lgkmcnt(3)
    v_mfma_f32_32x32x16_bf16 v[32:47], v[228:231], v[28:31], v[32:47]
    ds_read_b128 v[28:31], v211 offset:35840
    s_waitcnt lgkmcnt(3)
    v_mfma_f32_32x32x16_bf16 v[32:47], v[232:235], v[16:19], v[32:47]
    s_waitcnt lgkmcnt(2)
    v_mfma_f32_32x32x16_bf16 v[32:47], v[236:239], v[20:23], v[32:47]
    s_waitcnt lgkmcnt(1)
    v_mfma_f32_32x32x16_bf16 v[32:47], v[240:243], v[24:27], v[32:47]
    s_waitcnt lgkmcnt(0)
    v_mfma_f32_32x32x16_bf16 v[32:47], v[244:247], v[28:31], v[32:47]
    s_nop 11
    v_pk_mul_f32 v[32:33], v[32:33], s[38:39]
    v_pk_mul_f32 v[34:35], v[34:35], s[38:39]
    v_pk_mul_f32 v[36:37], v[36:37], s[38:39]
    v_pk_mul_f32 v[38:39], v[38:39], s[38:39]
    v_pk_mul_f32 v[40:41], v[40:41], s[38:39]
    v_pk_mul_f32 v[42:43], v[42:43], s[38:39]
    v_pk_mul_f32 v[44:45], v[44:45], s[38:39]
    v_pk_mul_f32 v[46:47], v[46:47], s[38:39]
    v_cvt_pk_bf16_f32 v48, v32, v33
    v_cvt_pk_bf16_f32 v49, v34, v35
    v_cvt_pk_bf16_f32 v50, v36, v37
    v_cvt_pk_bf16_f32 v51, v38, v39
    v_cvt_pk_bf16_f32 v52, v40, v41
    v_cvt_pk_bf16_f32 v53, v42, v43
    v_cvt_pk_bf16_f32 v54, v44, v45
    v_cvt_pk_bf16_f32 v55, v46, v47
    v_permlane32_swap_b32 v48, v50
    v_permlane32_swap_b32 v49, v51
    v_permlane32_swap_b32 v52, v54
    v_permlane32_swap_b32 v53, v55
    v_add_u32 v11, s57, v212
    ds_write_b128 v11, v[48:51] offset:0
    ds_write_b128 v11, v[52:55] offset:512
    s_waitcnt lgkmcnt(0)
att_haveq:
    s_cmp_eq_u32 s37, 0
    s_cbranch_scc1 att_notop
    s_cmp_gt_u32 s35, s43
    s_cbranch_scc1 att_notop
    s_waitcnt vmcnt(0)
    s_barrier
    s_cmp_eq_u32 s22, 0
    s_cbranch_scc0 att_nph_top
    s_lshl_b32 s73, s82, 5
    s_add_u32 s73, s73, s79
    s_lshl_b32 s73, s73, 7
    s_add_u32 s73, s73, 73424896
    v_mov_b32 v214, s37
    v_mov_b32 v215, 0
    s_mov_b64 exec, 1
    buffer_store_dword v214, v215, s[8:11], s73 offen sc1
    s_mov_b64 exec, -1
att_nph_top:
    s_mov_b32 s37, 0
att_notop:
    s_and_b32 s34, s44, 1
    s_mul_i32 s34, s34, 57344
    s_add_u32 s34, s34, 49152
    s_cmp_eq_u32 s33, 1
    s_cbranch_scc1 att_havekm
    s_add_u32 s50, s43, 1
    s_add_u32 s51, s49, 12288
    s_cmp_ge_u32 s48, s50
    s_cbranch_scc1 att_pf_ok_km
    s_mov_b32 s90, 0
    v_mov_b32 v251, 0
att_pf_km:
    buffer_load_dword v250, v251, s[8:11], s51 offen sc1
    s_add_u32 s90, s90, 1
    s_cmp_gt_u32 s90, 65536
    s_cbranch_scc1 att_timeout
    s_waitcnt vmcnt(0)
    v_readfirstlane_b32 s48, v250
    s_cmp_ge_u32 s48, s50
    s_cbranch_scc1 att_pf_ok_km
    s_sleep 2
    s_branch att_pf_km
att_pf_ok_km:
    s_lshl_b32 s52, s43, 5
    s_add_u32 s52, s52, s79
    s_lshl_b32 s54, s52, 12
    s_lshl_b32 s55, s22, 10
    s_add_u32 s55, s55, s34
    s_mov_b32 m0, s55
    s_add_u32 s56, s54, 54525952
    buffer_load_dwordx4 v213, s[8:11], s56 offen sc1 lds
    s_add_u32 m0, s55, 4096
    s_add_u32 s56, s54, 62914560
    buffer_load_dwordx4 v5, s[8:11], s56 offen sc1 lds
att_havekm:
    s_mov_b32 s33, 0
    v_add_u32 v11, s57, v3
    s_barrier
    s_cmp_eq_u32 s41, 0
    s_cbranch_scc0 att_qt1
    ds_read_b128 v[16:19], v11 offset:0
    ds_read_b128 v[20:23], v11 offset:2048
    ds_read_b128 v[24:27], v11 offset:4096
    ds_read_b128 v[28:31], v11 offset:6144
    ds_read_b128 v[32:35], v11 offset:8192
    ds_read_b128 v[36:39], v11 offset:10240
    ds_read_b128 v[40:43], v11 offset:12288
    ds_read_b128 v[44:47], v11 offset:14336
    s_lshl_b32 s58, s42, 12
    v_add_u32 v12, s58, v11
    ds_read_b128 v[64:67], v12 offset:16384
    ds_read_b128 v[68:71], v12 offset:17408
    ds_read_b128 v[72:75], v12 offset:18432
    ds_read_b128 v[76:79], v12 offset:19456
    s_waitcnt lgkmcnt(7)
    v_mfma_f32_16x16x32_bf16 v[48:51], v[32:35], v[16:19], 0
    s_waitcnt lgkmcnt(6)
    v_mfma_f32_16x16x32_bf16 v[48:51], v[36:39], v[20:23], v[48:51]
    s_waitcnt lgkmcnt(5)
    v_mfma_f32_16x16x32_bf16 v[48:51], v[40:43], v[24:27], v[48:51]
    s_waitcnt lgkmcnt(4)
    v_mfma_f32_16x16x32_bf16 v[48:51], v[44:47], v[28:31], v[48:51]
    s_waitcnt lgkmcnt(0)
    s_waitcnt vmcnt(0)
    s_barrier
    s_cmp_eq_u32 s37, 0
    s_cbranch_scc1 att_nopend0
    s_cmp_eq_u32 s22, 0
    s_cbranch_scc0 att_nph_d0
    s_lshl_b32 s73, s82, 5
    s_add_u32 s73, s73, s79
    s_lshl_b32 s73, s73, 7
    s_add_u32 s73, s73, 73424896
    v_mov_b32 v214, s37
    v_mov_b32 v215, 0
    s_mov_b64 exec, 1
    buffer_store_dword v214, v215, s[8:11], s73 offen sc1
    s_mov_b64 exec, -1
att_nph_d0:
    s_mov_b32 s37, 0
att_nopend0:
    s_mov_b32 s68, 0
    s_add_u32 s69, s43, 3
    s_cmp_ge_u32 s69, 64
    s_cbranch_scc1 att_nopf0
    s_min_u32 s50, s46, s47
    s_cmp_gt_u32 s50, s69
    s_cbranch_scc0 att_nopf0
    s_sub_u32 s70, 24576, s57
    s_lshl_b32 s52, s69, 5
    s_add_u32 s52, s52, s79
    s_lshl_b32 s53, s52, 13
    s_lshl_b32 s55, s22, 11
    s_add_u32 s55, s55, s70
    s_add_u32 m0, s55, 8192
    s_add_u32 s56, s53, 20971520
    buffer_load_dwordx4 v4, s[8:11], s56 offen sc1 lds
    buffer_load_dwordx4 v4, s[8:11], s56 offen offset:1024 sc1 lds
    s_add_u32 m0, s55, 16384
    s_add_u32 s56, s53, 37748736
    buffer_load_dwordx4 v4, s[8:11], s56 offen sc1 lds
    buffer_load_dwordx4 v4, s[8:11], s56 offen offset:1024 sc1 lds
    s_mul_i32 s53, s69, 36864
    s_add_u32 s53, s53, 0
    s_mul_i32 s55, s22, 9216
    s_add_u32 m0, s55, 65536
    s_add_u32 s56, s53, 0
    buffer_load_dwordx4 v210, s[8:11], s56 offen offset:0 sc1 lds
    buffer_load_dwordx4 v210, s[8:11], s56 offen offset:1024 sc1 lds
    buffer_load_dwordx4 v210, s[8:11], s56 offen offset:2048 sc1 lds
    buffer_load_dwordx4 v210, s[8:11], s56 offen offset:3072 sc1 lds
    s_add_u32 m0, s55, 69632
    s_add_u32 s56, s53, 4096
    buffer_load_dwordx4 v210, s[8:11], s56 offen offset:0 sc1 lds
    buffer_load_dwordx4 v210, s[8:11], s56 offen offset:1024 sc1 lds
    buffer_load_dwordx4 v210, s[8:11], s56 offen offset:2048 sc1 lds
    buffer_load_dwordx4 v210, s[8:11], s56 offen offset:3072 sc1 lds
    s_add_u32 m0, s55, 73728
    s_add_u32 s56, s53, 8192
    buffer_load_dwordx4 v210, s[8:11], s56 offen offset:0 sc1 lds
    s_mov_b32 s68, 1
att_nopf0:
    v_add_u32 v15, s34, v3
    ds_read_b128 v[32:35], v15 offset:0
    ds_read_b128 v[36:39], v15 offset:1024
    ds_read_b128 v[40:43], v15 offset:2048
    ds_read_b128 v[44:47], v15 offset:3072
    s_lshl_b32 s58, s42, 10
    s_add_u32 s58, s58, s34
    v_lshrrev_b32 v13, 1, v3
    v_add_u32 v13, s58, v13
    ds_read_b32 v80, v13 offset:4096
    ds_read_b32 v82, v13 offset:4100
    ds_read_b32 v84, v13 offset:4608
    ds_read_b32 v86, v13 offset:4612
    v_mov_b32 v81, 0
    v_mov_b32 v83, 0
    v_mov_b32 v85, 0
    v_mov_b32 v87, 0
    v_mov_b32 v14, 0xff7fffff
    v_cndmask_b32 v48, v48, v14, s[60:61]
    v_cndmask_b32 v49, v49, v14, s[62:63]
    v_cndmask_b32 v50, v50, v14, s[64:65]
    v_cndmask_b32 v51, v51, v14, s[66:67]
    v_max3_f32 v14, v48, v49, v50
    v_max_f32 v14, v14, v51
    s_waitcnt lgkmcnt(7)
    v_mfma_f32_16x16x32_bf16 v[52:55], v[32:35], v[16:19], 0
    s_waitcnt lgkmcnt(6)
    v_mfma_f32_16x16x32_bf16 v[52:55], v[36:39], v[20:23], v[52:55]
    s_waitcnt lgkmcnt(5)
    v_mfma_f32_16x16x32_bf16 v[52:55], v[40:43], v[24:27], v[52:55]
    s_waitcnt lgkmcnt(4)
    v_mfma_f32_16x16x32_bf16 v[52:55], v[44:47], v[28:31], v[52:55]
    s_nop 7
    v_max3_f32 v14, v14, v52, v53
    v_mov_b32 v15, v14
    s_nop 1
    v_permlane32_swap_b32 v14, v15
    v_max_f32 v14, v14, v15
    v_mov_b32 v15, v14
    s_nop 1
    v_permlane16_swap_b32 v14, v15
    v_max_f32 v14, v14, v15
    v_sub_f32 v48, v48, v14
    v_sub_f32 v49, v49, v14
    v_sub_f32 v50, v50, v14
    v_sub_f32 v51, v51, v14
    v_sub_f32 v52, v52, v14
    v_sub_f32 v53, v53, v14
    v_exp_f32 v48, v48
    v_exp_f32 v49, v49
    v_exp_f32 v50, v50
    v_exp_f32 v51, v51
    v_exp_f32 v52, v52
    v_exp_f32 v53, v53
    v_cvt_pk_bf16_f32 v60, v48, v49
    v_cvt_pk_bf16_f32 v61, v50, v51
    v_mov_b64 v[62:63], 0
    v_cvt_pk_bf16_f32 v88, v52, v53
    v_cvt_pk_bf16_f32 v89, v52, v53
    v_mov_b32 v92, 0x3f803f80
    v_mov_b32 v93, 0x3f803f80
    v_mov_b32 v94, 0x3f803f80
    v_mov_b32 v95, 0x3f803f80
    v_mov_b32 v96, 0x3f003f00
    v_mov_b32 v97, 0x3f003f00
    v_mfma_f32_16x16x32_bf16 v[100:103], v[92:95], v[60:63], 0
    s_waitcnt lgkmcnt(0)
    v_mfma_f32_16x16x32_bf16 v[104:107], v[64:67], v[60:63], 0
    v_mfma_f32_16x16x32_bf16 v[108:111], v[68:71], v[60:63], 0
    v_mfma_f32_16x16x32_bf16 v[112:115], v[72:75], v[60:63], 0
    v_mfma_f32_16x16x32_bf16 v[116:119], v[76:79], v[60:63], 0
    v_mfma_f32_16x16x16_bf16 v[100:103], v[96:97], v[88:89], v[100:103]
    v_mfma_f32_16x16x16_bf16 v[104:107], v[80:81], v[88:89], v[104:107]
    v_mfma_f32_16x16x16_bf16 v[108:111], v[82:83], v[88:89], v[108:111]
    v_mfma_f32_16x16x16_bf16 v[112:115], v[84:85], v[88:89], v[112:115]
    v_mfma_f32_16x16x16_bf16 v[116:119], v[86:87], v[88:89], v[116:119]
    v_rcp_f32 v100, v100
    s_nop 0
    v_pk_mul_f32 v[104:105], v[104:105], v[100:101] op_sel_hi:[1,0]
    v_pk_mul_f32 v[106:107], v[106:107], v[100:101] op_sel_hi:[1,0]
    v_pk_mul_f32 v[108:109], v[108:109], v[100:101] op_sel_hi:[1,0]
    v_pk_mul_f32 v[110:111], v[110:111], v[100:101] op_sel_hi:[1,0]
    v_pk_mul_f32 v[112:113], v[112:113], v[100:101] op_sel_hi:[1,0]
    v_pk_mul_f32 v[114:115], v[114:115], v[100:101] op_sel_hi:[1,0]
    v_pk_mul_f32 v[116:117], v[116:117], v[100:101] op_sel_hi:[1,0]
    v_pk_mul_f32 v[118:119], v[118:119], v[100:101] op_sel_hi:[1,0]
    v_cvt_pk_bf16_f32 v120, v104, v105
    v_cvt_pk_bf16_f32 v121, v106, v107
    v_cvt_pk_bf16_f32 v122, v108, v109
    v_cvt_pk_bf16_f32 v123, v110, v111
    v_cvt_pk_bf16_f32 v124, v112, v113
    v_cvt_pk_bf16_f32 v125, v114, v115
    v_cvt_pk_bf16_f32 v126, v116, v117
    v_cvt_pk_bf16_f32 v127, v118, v119
    s_lshl_b32 s58, s42, 11
    v_add_u32 v12, s58, v3
    ds_write_b128 v12, v[120:123] offset:57344
    ds_write_b128 v12, v[124:127] offset:58368
    s_waitcnt lgkmcnt(0)
    s_branch att_att_done
att_qt1:
    ds_read_b128 v[16:19], v11 offset:1024
    ds_read_b128 v[20:23], v11 offset:3072
    ds_read_b128 v[24:27], v11 offset:5120
    ds_read_b128 v[28:31], v11 offset:7168
    ds_read_b128 v[32:35], v11 offset:9216
    ds_read_b128 v[36:39], v11 offset:11264
    ds_read_b128 v[40:43], v11 offset:13312
    ds_read_b128 v[44:47], v11 offset:15360
    ds_read_b128 v[128:131], v11 offset:8192
    ds_read_b128 v[132:135], v11 offset:10240
    ds_read_b128 v[136:139], v11 offset:12288
    ds_read_b128 v[140:143], v11 offset:14336
    s_lshl_b32 s58, s42, 12
    v_add_u32 v12, s58, v11
    ds_read_b128 v[64:67], v12 offset:16384
    ds_read_b128 v[68:71], v12 offset:17408
    ds_read_b128 v[72:75], v12 offset:18432
    ds_read_b128 v[76:79], v12 offset:19456
    s_waitcnt lgkmcnt(11)
    v_mfma_f32_16x16x32_bf16 v[48:51], v[32:35], v[16:19], 0
    s_waitcnt lgkmcnt(10)
    v_mfma_f32_16x16x32_bf16 v[48:51], v[36:39], v[20:23], v[48:51]
    s_waitcnt lgkmcnt(9)
    v_mfma_f32_16x16x32_bf16 v[48:51], v[40:43], v[24:27], v[48:51]
    s_waitcnt lgkmcnt(8)
    v_mfma_f32_16x16x32_bf16 v[48:51], v[44:47], v[28:31], v[48:51]
    s_waitcnt lgkmcnt(7)
    v_mfma_f32_16x16x32_bf16 v[56:59], v[128:131], v[16:19], 0
    s_waitcnt lgkmcnt(6)
    v_mfma_f32_16x16x32_bf16 v[56:59], v[132:135], v[20:23], v[56:59]
    s_waitcnt lgkmcnt(5)
    v_mfma_f32_16x16x32_bf16 v[56:59], v[136:139], v[24:27], v[56:59]
    s_waitcnt lgkmcnt(4)
    v_mfma_f32_16x16x32_bf16 v[56:59], v[140:143], v[28:31], v[56:59]
    s_waitcnt lgkmcnt(0)
    s_waitcnt vmcnt(0)
    s_barrier
    s_cmp_eq_u32 s37, 0
    s_cbranch_scc1 att_nopend1
    s_cmp_eq_u32 s22, 0
    s_cbranch_scc0 att_nph_d1
    s_lshl_b32 s73, s82, 5
    s_add_u32 s73, s73, s79
    s_lshl_b32 s73, s73, 7
    s_add_u32 s73, s73, 73424896
    v_mov_b32 v214, s37
    v_mov_b32 v215, 0
    s_mov_b64 exec, 1
    buffer_store_dword v214, v215, s[8:11], s73 offen sc1
    s_mov_b64 exec, -1
att_nph_d1:
    s_mov_b32 s37, 0
att_nopend1:
    s_mov_b32 s68, 0
    s_add_u32 s69, s43, 3
    s_cmp_ge_u32 s69, 64
    s_cbranch_scc1 att_nopf1
    s_min_u32 s50, s46, s47
    s_cmp_gt_u32 s50, s69
    s_cbranch_scc0 att_nopf1
    s_sub_u32 s70, 24576, s57
    s_lshl_b32 s52, s69, 5
    s_add_u32 s52, s52, s79
    s_lshl_b32 s53, s52, 13
    s_lshl_b32 s55, s22, 11
    s_add_u32 s55, s55, s70
    s_add_u32 m0, s55, 8192
    s_add_u32 s56, s53, 20971520
    buffer_load_dwordx4 v4, s[8:11], s56 offen sc1 lds
    buffer_load_dwordx4 v4, s[8:11], s56 offen offset:1024 sc1 lds
    s_add_u32 m0, s55, 16384
    s_add_u32 s56, s53, 37748736
    buffer_load_dwordx4 v4, s[8:11], s56 offen sc1 lds
    buffer_load_dwordx4 v4, s[8:11], s56 offen offset:1024 sc1 lds
    s_mul_i32 s53, s69, 36864
    s_add_u32 s53, s53, 0
    s_mul_i32 s55, s22, 9216
    s_add_u32 m0, s55, 65536
    s_add_u32 s56, s53, 0
    buffer_load_dwordx4 v210, s[8:11], s56 offen offset:0 sc1 lds
    buffer_load_dwordx4 v210, s[8:11], s56 offen offset:1024 sc1 lds
    buffer_load_dwordx4 v210, s[8:11], s56 offen offset:2048 sc1 lds
    buffer_load_dwordx4 v210, s[8:11], s56 offen offset:3072 sc1 lds
    s_add_u32 m0, s55, 69632
    s_add_u32 s56, s53, 4096
    buffer_load_dwordx4 v210, s[8:11], s56 offen offset:0 sc1 lds
    buffer_load_dwordx4 v210, s[8:11], s56 offen offset:1024 sc1 lds
    buffer_load_dwordx4 v210, s[8:11], s56 offen offset:2048 sc1 lds
    buffer_load_dwordx4 v210, s[8:11], s56 offen offset:3072 sc1 lds
    s_add_u32 m0, s55, 73728
    s_add_u32 s56, s53, 8192
    buffer_load_dwordx4 v210, s[8:11], s56 offen offset:0 sc1 lds
    s_mov_b32 s68, 1
att_nopf1:
    v_add_u32 v15, s34, v3
    ds_read_b128 v[32:35], v15 offset:0
    ds_read_b128 v[36:39], v15 offset:1024
    ds_read_b128 v[40:43], v15 offset:2048
    ds_read_b128 v[44:47], v15 offset:3072
    s_lshl_b32 s58, s42, 10
    s_add_u32 s58, s58, s34
    v_lshrrev_b32 v13, 1, v3
    v_add_u32 v13, s58, v13
    ds_read_b32 v80, v13 offset:4096
    ds_read_b32 v82, v13 offset:4100
    ds_read_b32 v84, v13 offset:4608
    ds_read_b32 v86, v13 offset:4612
    v_mov_b32 v81, 0
    v_mov_b32 v83, 0
    v_mov_b32 v85, 0
    v_mov_b32 v87, 0
    v_mov_b32 v14, 0xff7fffff
    v_cndmask_b32 v48, v48, v14, s[60:61]
    v_cndmask_b32 v49, v49, v14, s[62:63]
    v_cndmask_b32 v50, v50, v14, s[64:65]
    v_cndmask_b32 v51, v51, v14, s[66:67]
    v_max3_f32 v14, v48, v49, v50
    v_max_f32 v14, v14, v51
    v_max3_f32 v14, v14, v56, v57
    v_max3_f32 v14, v14, v58, v59
    s_waitcnt lgkmcnt(7)
    v_mfma_f32_16x16x32_bf16 v[52:55], v[32:35], v[16:19], 0
    s_waitcnt lgkmcnt(6)
    v_mfma_f32_16x16x32_bf16 v[52:55], v[36:39], v[20:23], v[52:55]
    s_waitcnt lgkmcnt(5)
    v_mfma_f32_16x16x32_bf16 v[52:55], v[40:43], v[24:27], v[52:55]
    s_waitcnt lgkmcnt(4)
    v_mfma_f32_16x16x32_bf16 v[52:55], v[44:47], v[28:31], v[52:55]
    s_nop 7
    v_max3_f32 v14, v14, v52, v53
    v_mov_b32 v15, v14
    s_nop 1
    v_permlane32_swap_b32 v14, v15
    v_max_f32 v14, v14, v15
    v_mov_b32 v15, v14
    s_nop 1
    v_permlane16_swap_b32 v14, v15
    v_max_f32 v14, v14, v15
    v_sub_f32 v48, v48, v14
    v_sub_f32 v49, v49, v14
    v_sub_f32 v50, v50, v14
    v_sub_f32 v51, v51, v14
    v_sub_f32 v52, v52, v14
    v_sub_f32 v53, v53, v14
    v_sub_f32 v56, v56, v14
    v_sub_f32 v57, v57, v14
    v_sub_f32 v58, v58, v14
    v_sub_f32 v59, v59, v14
    v_exp_f32 v48, v48
    v_exp_f32 v49, v49
    v_exp_f32 v50, v50
    v_exp_f32 v51, v51
    v_exp_f32 v52, v52
    v_exp_f32 v53, v53
    v_exp_f32 v56, v56
    v_exp_f32 v57, v57
    v_exp_f32 v58, v58
    v_exp_f32 v59, v59
    v_cvt_pk_bf16_f32 v60, v56, v57
    v_cvt_pk_bf16_f32 v61, v58, v59
    v_cvt_pk_bf16_f32 v62, v48, v49
    v_cvt_pk_bf16_f32 v63, v50, v51
    v_cvt_pk_bf16_f32 v88, v52, v53
    v_cvt_pk_bf16_f32 v89, v52, v53
    v_mov_b32 v92, 0x3f803f80
    v_mov_b32 v93, 0x3f803f80
    v_mov_b32 v94, 0x3f803f80
    v_mov_b32 v95, 0x3f803f80
    v_mov_b32 v96, 0x3f003f00
    v_mov_b32 v97, 0x3f003f00
    v_mfma_f32_16x16x32_bf16 v[100:103], v[92:95], v[60:63], 0
    s_waitcnt lgkmcnt(0)
    v_mfma_f32_16x16x32_bf16 v[104:107], v[64:67], v[60:63], 0
    v_mfma_f32_16x16x32_bf16 v[108:111], v[68:71], v[60:63], 0
    v_mfma_f32_16x16x32_bf16 v[112:115], v[72:75], v[60:63], 0
    v_mfma_f32_16x16x32_bf16 v[116:119], v[76:79], v[60:63], 0
    v_mfma_f32_16x16x16_bf16 v[100:103], v[96:97], v[88:89], v[100:103]
    v_mfma_f32_16x16x16_bf16 v[104:107], v[80:81], v[88:89], v[104:107]
    v_mfma_f32_16x16x16_bf16 v[108:111], v[82:83], v[88:89], v[108:111]
    v_mfma_f32_16x16x16_bf16 v[112:115], v[84:85], v[88:89], v[112:115]
    v_mfma_f32_16x16x16_bf16 v[116:119], v[86:87], v[88:89], v[116:119]
    v_rcp_f32 v100, v100
    s_nop 0
    v_pk_mul_f32 v[104:105], v[104:105], v[100:101] op_sel_hi:[1,0]
    v_pk_mul_f32 v[106:107], v[106:107], v[100:101] op_sel_hi:[1,0]
    v_pk_mul_f32 v[108:109], v[108:109], v[100:101] op_sel_hi:[1,0]
    v_pk_mul_f32 v[110:111], v[110:111], v[100:101] op_sel_hi:[1,0]
    v_pk_mul_f32 v[112:113], v[112:113], v[100:101] op_sel_hi:[1,0]
    v_pk_mul_f32 v[114:115], v[114:115], v[100:101] op_sel_hi:[1,0]
    v_pk_mul_f32 v[116:117], v[116:117], v[100:101] op_sel_hi:[1,0]
    v_pk_mul_f32 v[118:119], v[118:119], v[100:101] op_sel_hi:[1,0]
    v_cvt_pk_bf16_f32 v120, v104, v105
    v_cvt_pk_bf16_f32 v121, v106, v107
    v_cvt_pk_bf16_f32 v122, v108, v109
    v_cvt_pk_bf16_f32 v123, v110, v111
    v_cvt_pk_bf16_f32 v124, v112, v113
    v_cvt_pk_bf16_f32 v125, v114, v115
    v_cvt_pk_bf16_f32 v126, v116, v117
    v_cvt_pk_bf16_f32 v127, v118, v119
    s_lshl_b32 s58, s42, 11
    v_add_u32 v12, s58, v3
    ds_write_b128 v12, v[120:123] offset:61440
    ds_write_b128 v12, v[124:127] offset:62464
    s_waitcnt lgkmcnt(0)
att_att_done:
    s_barrier
    ds_read_b128 v[16:19], v3 offset:57344
    ds_read_b128 v[20:23], v3 offset:58368
    ds_read_b128 v[24:27], v3 offset:59392
    ds_read_b128 v[28:31], v3 offset:60416
    ds_read_b128 v[32:35], v3 offset:61440
    ds_read_b128 v[36:39], v3 offset:62464
    ds_read_b128 v[40:43], v3 offset:63488
    ds_read_b128 v[44:47], v3 offset:64512
    s_and_b32 s58, s44, 1
    s_mul_i32 s58, s58, 1179648
    s_mul_i32 s59, s82, 2359296
    s_add_u32 s58, s58, s59
    s_add_u32 s58, s58, 100663296
    s_mul_i32 s59, s79, 36864
    s_add_u32 s59, s59, s58
    s_add_u32 s70, s59, 18432
    s_waitcnt lgkmcnt(7)
    v_mfma_f32_16x16x32_bf16 v[64:67], a[0:3], v[16:19], 0
    s_waitcnt lgkmcnt(3)
    v_mfma_f32_16x16x32_bf16 v[68:71], a[0:3], v[32:35], 0
    v_mfma_f32_16x16x32_bf16 v[64:67], a[4:7], v[20:23], v[64:67]
    s_waitcnt lgkmcnt(2)
    v_mfma_f32_16x16x32_bf16 v[68:71], a[4:7], v[36:39], v[68:71]
    v_mfma_f32_16x16x32_bf16 v[64:67], a[8:11], v[24:27], v[64:67]
    s_waitcnt lgkmcnt(1)
    v_mfma_f32_16x16x32_bf16 v[68:71], a[8:11], v[40:43], v[68:71]
    v_mfma_f32_16x16x32_bf16 v[64:67], a[12:15], v[28:31], v[64:67]
    s_waitcnt lgkmcnt(0)
    v_mfma_f32_16x16x32_bf16 v[68:71], a[12:15], v[44:47], v[68:71]
    v_mfma_f32_16x16x32_bf16 v[72:75], a[16:19], v[16:19], 0
    v_mfma_f32_16x16x32_bf16 v[76:79], a[16:19], v[32:35], 0
    v_mfma_f32_16x16x32_bf16 v[72:75], a[20:23], v[20:23], v[72:75]
    v_mfma_f32_16x16x32_bf16 v[76:79], a[20:23], v[36:39], v[76:79]
    v_mfma_f32_16x16x32_bf16 v[72:75], a[24:27], v[24:27], v[72:75]
    v_mfma_f32_16x16x32_bf16 v[76:79], a[24:27], v[40:43], v[76:79]
    v_mfma_f32_16x16x32_bf16 v[72:75], a[28:31], v[28:31], v[72:75]
    v_mfma_f32_16x16x32_bf16 v[76:79], a[28:31], v[44:47], v[76:79]
    v_mfma_f32_16x16x32_bf16 v[80:83], a[32:35], v[16:19], 0
    v_mfma_f32_16x16x32_bf16 v[84:87], a[32:35], v[32:35], 0
    v_mfma_f32_16x16x32_bf16 v[80:83], a[36:39], v[20:23], v[80:83]
    v_mfma_f32_16x16x32_bf16 v[84:87], a[36:39], v[36:39], v[84:87]
    v_mfma_f32_16x16x32_bf16 v[80:83], a[40:43], v[24:27], v[80:83]
    v_mfma_f32_16x16x32_bf16 v[84:87], a[40:43], v[40:43], v[84:87]
    v_mfma_f32_16x16x32_bf16 v[80:83], a[44:47], v[28:31], v[80:83]
    v_mfma_f32_16x16x32_bf16 v[84:87], a[44:47], v[44:47], v[84:87]
    v_mfma_f32_16x16x32_bf16 v[88:91], a[48:51], v[16:19], 0
    v_mfma_f32_16x16x32_bf16 v[92:95], a[48:51], v[32:35], 0
    v_mfma_f32_16x16x32_bf16 v[88:91], a[52:55], v[20:23], v[88:91]
    v_mfma_f32_16x16x32_bf16 v[92:95], a[52:55], v[36:39], v[92:95]
    v_mfma_f32_16x16x32_bf16 v[88:91], a[56:59], v[24:27], v[88:91]
    v_mfma_f32_16x16x32_bf16 v[92:95], a[56:59], v[40:43], v[92:95]
    v_mfma_f32_16x16x32_bf16 v[88:91], a[60:63], v[28:31], v[88:91]
    v_mfma_f32_16x16x32_bf16 v[92:95], a[60:63], v[44:47], v[92:95]
    v_cvt_pk_bf16_f32 v96, v64, v65
    v_cvt_pk_bf16_f32 v97, v66, v67
    v_cvt_pk_bf16_f32 v98, v72, v73
    v_cvt_pk_bf16_f32 v99, v74, v75
    buffer_store_dwordx4 v[96:99], v8, s[8:11], s59 offen offset:0
    v_cvt_pk_bf16_f32 v100, v68, v69
    v_cvt_pk_bf16_f32 v101, v70, v71
    v_cvt_pk_bf16_f32 v102, v76, v77
    v_cvt_pk_bf16_f32 v103, v78, v79
    buffer_store_dwordx4 v[100:103], v8, s[8:11], s70 offen offset:0
    v_mfma_f32_16x16x32_bf16 v[64:67], a[64:67], v[16:19], 0
    v_mfma_f32_16x16x32_bf16 v[68:71], a[64:67], v[32:35], 0
    v_mfma_f32_16x16x32_bf16 v[64:67], a[68:71], v[20:23], v[64:67]
    v_mfma_f32_16x16x32_bf16 v[68:71], a[68:71], v[36:39], v[68:71]
    v_mfma_f32_16x16x32_bf16 v[64:67], a[72:75], v[24:27], v[64:67]
    v_mfma_f32_16x16x32_bf16 v[68:71], a[72:75], v[40:43], v[68:71]
    v_mfma_f32_16x16x32_bf16 v[64:67], a[76:79], v[28:31], v[64:67]
    v_mfma_f32_16x16x32_bf16 v[68:71], a[76:79], v[44:47], v[68:71]
    v_mfma_f32_16x16x32_bf16 v[72:75], a[80:83], v[16:19], 0
    v_mfma_f32_16x16x32_bf16 v[76:79], a[80:83], v[32:35], 0
    v_mfma_f32_16x16x32_bf16 v[72:75], a[84:87], v[20:23], v[72:75]
    v_mfma_f32_16x16x32_bf16 v[76:79], a[84:87], v[36:39], v[76:79]
    v_mfma_f32_16x16x32_bf16 v[72:75], a[88:91], v[24:27], v[72:75]
    v_mfma_f32_16x16x32_bf16 v[76:79], a[88:91], v[40:43], v[76:79]
    v_mfma_f32_16x16x32_bf16 v[72:75], a[92:95], v[28:31], v[72:75]
    v_mfma_f32_16x16x32_bf16 v[76:79], a[92:95], v[44:47], v[76:79]
    v_cvt_pk_bf16_f32 v104, v80, v81
    v_cvt_pk_bf16_f32 v105, v82, v83
    v_cvt_pk_bf16_f32 v106, v88, v89
    v_cvt_pk_bf16_f32 v107, v90, v91
    buffer_store_dwordx4 v[104:107], v8, s[8:11], s59 offen offset:64
    v_cvt_pk_bf16_f32 v108, v84, v85
    v_cvt_pk_bf16_f32 v109, v86, v87
    v_cvt_pk_bf16_f32 v110, v92, v93
    v_cvt_pk_bf16_f32 v111, v94, v95
    buffer_store_dwordx4 v[108:111], v8, s[8:11], s70 offen offset:64
    v_mfma_f32_16x16x32_bf16 v[80:83], a[96:99], v[16:19], 0
    v_mfma_f32_16x16x32_bf16 v[84:87], a[96:99], v[32:35], 0
    v_mfma_f32_16x16x32_bf16 v[80:83], a[100:103], v[20:23], v[80:83]
    v_mfma_f32_16x16x32_bf16 v[84:87], a[100:103], v[36:39], v[84:87]
    v_mfma_f32_16x16x32_bf16 v[80:83], a[104:107], v[24:27], v[80:83]
    v_mfma_f32_16x16x32_bf16 v[84:87], a[104:107], v[40:43], v[84:87]
    v_mfma_f32_16x16x32_bf16 v[80:83], a[108:111], v[28:31], v[80:83]
    v_mfma_f32_16x16x32_bf16 v[84:87], a[108:111], v[44:47], v[84:87]
    v_mfma_f32_16x16x32_bf16 v[88:91], a[112:115], v[16:19], 0
    v_mfma_f32_16x16x32_bf16 v[92:95], a[112:115], v[32:35], 0
    v_mfma_f32_16x16x32_bf16 v[88:91], a[116:119], v[20:23], v[88:91]
    v_mfma_f32_16x16x32_bf16 v[92:95], a[116:119], v[36:39], v[92:95]
    v_mfma_f32_16x16x32_bf16 v[88:91], a[120:123], v[24:27], v[88:91]
    v_mfma_f32_16x16x32_bf16 v[92:95], a[120:123], v[40:43], v[92:95]
    v_mfma_f32_16x16x32_bf16 v[88:91], a[124:127], v[28:31], v[88:91]
    v_mfma_f32_16x16x32_bf16 v[92:95], a[124:127], v[44:47], v[92:95]
    v_cvt_pk_bf16_f32 v96, v64, v65
    v_cvt_pk_bf16_f32 v97, v66, v67
    v_cvt_pk_bf16_f32 v98, v72, v73
    v_cvt_pk_bf16_f32 v99, v74, v75
    buffer_store_dwordx4 v[96:99], v8, s[8:11], s59 offen offset:128
    v_cvt_pk_bf16_f32 v100, v68, v69
    v_cvt_pk_bf16_f32 v101, v70, v71
    v_cvt_pk_bf16_f32 v102, v76, v77
    v_cvt_pk_bf16_f32 v103, v78, v79
    buffer_store_dwordx4 v[100:103], v8, s[8:11], s70 offen offset:128
    v_mfma_f32_16x16x32_bf16 v[112:115], a[128:131], v[16:19], 0
    v_mfma_f32_16x16x32_bf16 v[116:119], a[128:131], v[32:35], 0
    v_mfma_f32_16x16x32_bf16 v[112:115], a[132:135], v[20:23], v[112:115]
    v_mfma_f32_16x16x32_bf16 v[116:119], a[132:135], v[36:39], v[116:119]
    v_mfma_f32_16x16x32_bf16 v[112:115], a[136:139], v[24:27], v[112:115]
    v_mfma_f32_16x16x32_bf16 v[116:119], a[136:139], v[40:43], v[116:119]
    v_mfma_f32_16x16x32_bf16 v[112:115], a[140:143], v[28:31], v[112:115]
    v_mfma_f32_16x16x32_bf16 v[116:119], a[140:143], v[44:47], v[116:119]
    v_cvt_pk_bf16_f32 v104, v80, v81
    v_cvt_pk_bf16_f32 v105, v82, v83
    v_cvt_pk_bf16_f32 v106, v88, v89
    v_cvt_pk_bf16_f32 v107, v90, v91
    buffer_store_dwordx4 v[104:107], v8, s[8:11], s59 offen offset:192
    v_cvt_pk_bf16_f32 v108, v84, v85
    v_cvt_pk_bf16_f32 v109, v86, v87
    v_cvt_pk_bf16_f32 v110, v92, v93
    v_cvt_pk_bf16_f32 v111, v94, v95
    buffer_store_dwordx4 v[108:111], v8, s[8:11], s70 offen offset:192
    v_cvt_pk_bf16_f32 v120, v112, v113
    v_cvt_pk_bf16_f32 v121, v114, v115
    buffer_store_dwordx2 v[120:121], v9, s[8:11], s59 offen
    v_cvt_pk_bf16_f32 v122, v116, v117
    v_cvt_pk_bf16_f32 v123, v118, v119
    buffer_store_dwordx2 v[122:123], v9, s[8:11], s70 offen
    s_waitcnt vmcnt(0)
    s_barrier
    s_and_b32 s71, s44, 1
    s_lshl_b32 s72, s82, 1
    s_add_u32 s71, s71, s72
    s_lshl_b32 s71, s71, 7
    s_add_u32 s71, s71, 73441280
    s_add_u32 s72, s43, 1
    s_cmp_eq_u32 s22, 0
    s_cbranch_scc0 att_nopub
    v_mov_b32 v16, s72
    s_lshl_b32 s73, s79, 2
    v_mov_b32 v17, s73
    s_mov_b64 exec, 1
    buffer_store_dword v16, v17, s[8:11], s71 offen
    s_mov_b64 exec, -1
att_nopub:
    s_cmp_eq_u32 s68, 1
    s_cbranch_scc0 att_noq2
    s_sub_u32 s76, 24576, s57
    ds_read_b128 v[16:19], v211 offset:0
    ds_read_b128 v[20:23], v211 offset:1024
    ds_read_b128 v[24:27], v211 offset:2048
    ds_read_b128 v[28:31], v211 offset:3072
    s_waitcnt lgkmcnt(3)
    v_mfma_f32_32x32x16_bf16 v[32:47], a[144:147], v[16:19], 0
    ds_read_b128 v[16:19], v211 offset:4096
    s_waitcnt lgkmcnt(3)
    v_mfma_f32_32x32x16_bf16 v[32:47], a[148:151], v[20:23], v[32:47]
    ds_read_b128 v[20:23], v211 offset:5120
    s_waitcnt lgkmcnt(3)
    v_mfma_f32_32x32x16_bf16 v[32:47], a[152:155], v[24:27], v[32:47]
    ds_read_b128 v[24:27], v211 offset:6144
    s_waitcnt lgkmcnt(3)
    v_mfma_f32_32x32x16_bf16 v[32:47], a[156:159], v[28:31], v[32:47]
    ds_read_b128 v[28:31], v211 offset:7168
    s_waitcnt lgkmcnt(3)
    v_mfma_f32_32x32x16_bf16 v[32:47], a[160:163], v[16:19], v[32:47]
    ds_read_b128 v[16:19], v211 offset:8192
    s_waitcnt lgkmcnt(3)
    v_mfma_f32_32x32x16_bf16 v[32:47], a[164:167], v[20:23], v[32:47]
    ds_read_b128 v[20:23], v211 offset:9216
    s_waitcnt lgkmcnt(3)
    v_mfma_f32_32x32x16_bf16 v[32:47], a[168:171], v[24:27], v[32:47]
    ds_read_b128 v[24:27], v211 offset:10240
    s_waitcnt lgkmcnt(3)
    v_mfma_f32_32x32x16_bf16 v[32:47], a[172:175], v[28:31], v[32:47]
    ds_read_b128 v[28:31], v211 offset:11264
    s_waitcnt lgkmcnt(3)
    v_mfma_f32_32x32x16_bf16 v[32:47], a[176:179], v[16:19], v[32:47]
    ds_read_b128 v[16:19], v211 offset:12288
    s_waitcnt lgkmcnt(3)
    v_mfma_f32_32x32x16_bf16 v[32:47], a[180:183], v[20:23], v[32:47]
    ds_read_b128 v[20:23], v211 offset:13312
    s_waitcnt lgkmcnt(3)
    v_mfma_f32_32x32x16_bf16 v[32:47], a[184:187], v[24:27], v[32:47]
    ds_read_b128 v[24:27], v211 offset:14336
    s_waitcnt lgkmcnt(3)
    v_mfma_f32_32x32x16_bf16 v[32:47], a[188:191], v[28:31], v[32:47]
    ds_read_b128 v[28:31], v211 offset:15360
    s_waitcnt lgkmcnt(3)
    v_mfma_f32_32x32x16_bf16 v[32:47], a[192:195], v[16:19], v[32:47]
    ds_read_b128 v[16:19], v211 offset:16384
    s_waitcnt lgkmcnt(3)
    v_mfma_f32_32x32x16_bf16 v[32:47], a[196:199], v[20:23], v[32:47]
    ds_read_b128 v[20:23], v211 offset:17408
    s_waitcnt lgkmcnt(3)
    v_mfma_f32_32x32x16_bf16 v[32:47], a[200:203], v[24:27], v[32:47]
    ds_read_b128 v[24:27], v211 offset:18432
    s_waitcnt lgkmcnt(3)
    v_mfma_f32_32x32x16_bf16 v[32:47], a[204:207], v[28:31], v[32:47]
    ds_read_b128 v[28:31], v211 offset:19456
    s_waitcnt lgkmcnt(3)
    v_mfma_f32_32x32x16_bf16 v[32:47], a[208:211], v[16:19], v[32:47]
    ds_read_b128 v[16:19], v211 offset:20480
    s_waitcnt lgkmcnt(3)
    v_mfma_f32_32x32x16_bf16 v[32:47], a[212:215], v[20:23], v[32:47]
    ds_read_b128 v[20:23], v211 offset:21504
    s_waitcnt lgkmcnt(3)
    v_mfma_f32_32x32x16_bf16 v[32:47], a[216:219], v[24:27], v[32:47]
    ds_read_b128 v[24:27], v211 offset:22528
    s_waitcnt lgkmcnt(3)
    v_mfma_f32_32x32x16_bf16 v[32:47], a[220:223], v[28:31], v[32:47]
    ds_read_b128 v[28:31], v211 offset:23552
    s_waitcnt lgkmcnt(3)
    v_mfma_f32_32x32x16_bf16 v[32:47], a[224:227], v[16:19], v[32:47]
    ds_read_b128 v[16:19], v211 offset:24576
    s_waitcnt lgkmcnt(3)
    v_mfma_f32_32x32x16_bf16 v[32:47], a[228:231], v[20:23], v[32:47]
    ds_read_b128 v[20:23], v211 offset:25600
    s_waitcnt lgkmcnt(3)
    v_mfma_f32_32x32x16_bf16 v[32:47], a[232:235], v[24:27], v[32:47]
    ds_read_b128 v[24:27], v211 offset:26624
    s_waitcnt lgkmcnt(3)
    v_mfma_f32_32x32x16_bf16 v[32:47], a[236:239], v[28:31], v[32:47]
    ds_read_b128 v[28:31], v211 offset:27648
    s_waitcnt lgkmcnt(3)
    v_mfma_f32_32x32x16_bf16 v[32:47], a[240:243], v[16:19], v[32:47]
    ds_read_b128 v[16:19], v211 offset:28672
    s_waitcnt lgkmcnt(3)
    v_mfma_f32_32x32x16_bf16 v[32:47], a[244:247], v[20:23], v[32:47]
    ds_read_b128 v[20:23], v211 offset:29696
    s_waitcnt lgkmcnt(3)
    v_mfma_f32_32x32x16_bf16 v[32:47], a[248:251], v[24:27], v[32:47]
    ds_read_b128 v[24:27], v211 offset:30720
    s_waitcnt lgkmcnt(3)
    v_mfma_f32_32x32x16_bf16 v[32:47], a[252:255], v[28:31], v[32:47]
    ds_read_b128 v[28:31], v211 offset:31744
    s_waitcnt lgkmcnt(3)
    v_mfma_f32_32x32x16_bf16 v[32:47], v[216:219], v[16:19], v[32:47]
    ds_read_b128 v[16:19], v211 offset:32768
    s_waitcnt lgkmcnt(3)
    v_mfma_f32_32x32x16_bf16 v[32:47], v[220:223], v[20:23], v[32:47]
    ds_read_b128 v[20:23], v211 offset:33792
    s_waitcnt lgkmcnt(3)
    v_mfma_f32_32x32x16_bf16 v[32:47], v[224:227], v[24:27], v[32:47]
    ds_read_b128 v[24:27], v211 offset:34816
    s_waitcnt lgkmcnt(3)
    v_mfma_f32_32x32x16_bf16 v[32:47], v[228:231], v[28:31], v[32:47]
    ds_read_b128 v[28:31], v211 offset:35840
    s_waitcnt lgkmcnt(3)
    v_mfma_f32_32x32x16_bf16 v[32:47], v[232:235], v[16:19], v[32:47]
    s_waitcnt lgkmcnt(2)
    v_mfma_f32_32x32x16_bf16 v[32:47], v[236:239], v[20:23], v[32:47]
    s_waitcnt lgkmcnt(1)
    v_mfma_f32_32x32x16_bf16 v[32:47], v[240:243], v[24:27], v[32:47]
    s_waitcnt lgkmcnt(0)
    v_mfma_f32_32x32x16_bf16 v[32:47], v[244:247], v[28:31], v[32:47]
    s_nop 11
    v_pk_mul_f32 v[32:33], v[32:33], s[38:39]
    v_pk_mul_f32 v[34:35], v[34:35], s[38:39]
    v_pk_mul_f32 v[36:37], v[36:37], s[38:39]
    v_pk_mul_f32 v[38:39], v[38:39], s[38:39]
    v_pk_mul_f32 v[40:41], v[40:41], s[38:39]
    v_pk_mul_f32 v[42:43], v[42:43], s[38:39]
    v_pk_mul_f32 v[44:45], v[44:45], s[38:39]
    v_pk_mul_f32 v[46:47], v[46:47], s[38:39]
    v_cvt_pk_bf16_f32 v48, v32, v33
    v_cvt_pk_bf16_f32 v49, v34, v35
    v_cvt_pk_bf16_f32 v50, v36, v37
    v_cvt_pk_bf16_f32 v51, v38, v39
    v_cvt_pk_bf16_f32 v52, v40, v41
    v_cvt_pk_bf16_f32 v53, v42, v43
    v_cvt_pk_bf16_f32 v54, v44, v45
    v_cvt_pk_bf16_f32 v55, v46, v47
    v_permlane32_swap_b32 v48, v50
    v_permlane32_swap_b32 v49, v51
    v_permlane32_swap_b32 v52, v54
    v_permlane32_swap_b32 v53, v55
    v_add_u32 v11, s76, v212
    ds_write_b128 v11, v[48:51] offset:0
    ds_write_b128 v11, v[52:55] offset:512
    s_waitcnt lgkmcnt(0)
att_noq2:
    s_mul_i32 s74, s79, 1152
    s_add_u32 s74, s74, s58
    s_lshl_b32 s75, s43, 5
    s_add_u32 s75, s75, s79
    s_mul_i32 s75, s75, 1152
    s_lshl_b32 s76, s22, 7
    s_add_u32 s74, s74, s76
    s_add_u32 s75, s75, s76
    v_and_b32 v17, 31, v0
    v_lshlrev_b32 v17, 2, v17
    s_mov_b32 s73, 0
    v_mov_b32 v19, 0
    s_add_u32 s51, s49, 12288
    buffer_load_dword v18, v19, s[8:11], s51 offen sc1
att_p3poll:
    buffer_load_dword v16, v17, s[8:11], s71 offen sc1
    s_add_u32 s73, s73, 1
    s_cmp_gt_u32 s73, 65536
    s_cbranch_scc1 att_timeout
    s_waitcnt vmcnt(0)
    v_cmp_ne_u32 vcc, s72, v16
    s_cbranch_vccnz att_p3poll
    v_readfirstlane_b32 s50, v18
    s_max_u32 s48, s48, s50
    s_add_u32 s76, s74, 0
    buffer_load_dwordx4 v[16:19], v204, s[8:11], s76 offen sc1
    s_add_u32 s76, s74, 294912
    buffer_load_dwordx4 v[20:23], v204, s[8:11], s76 offen sc1
    s_add_u32 s76, s74, 589824
    buffer_load_dwordx4 v[24:27], v204, s[8:11], s76 offen sc1
    s_add_u32 s76, s74, 884736
    buffer_load_dwordx4 v[28:31], v204, s[8:11], s76 offen sc1
    s_add_u32 s76, s75, 0
    buffer_load_dwordx4 v[32:35], v205, s[4:7], s76 offen
    s_add_u32 s76, s74, 512
    buffer_load_dwordx4 v[36:39], v204, s[8:11], s76 offen sc1
    s_add_u32 s76, s74, 295424
    buffer_load_dwordx4 v[40:43], v204, s[8:11], s76 offen sc1
    s_add_u32 s76, s74, 590336
    buffer_load_dwordx4 v[44:47], v204, s[8:11], s76 offen sc1
    s_add_u32 s76, s74, 885248
    buffer_load_dwordx4 v[48:51], v204, s[8:11], s76 offen sc1
    s_add_u32 s76, s75, 512
    buffer_load_dwordx4 v[52:55], v205, s[4:7], s76 offen
    v_mov_b64 v[88:89], 0
    v_mov_b64 v[90:91], 0
    s_cmp_eq_u32 s22, 0
    s_cbranch_scc0 att_two
    s_add_u32 s76, s74, 1024
    buffer_load_dwordx4 v[56:59], v204, s[8:11], s76 offen sc1
    s_add_u32 s76, s74, 295936
    buffer_load_dwordx4 v[60:63], v204, s[8:11], s76 offen sc1
    s_add_u32 s76, s74, 590848
    buffer_load_dwordx4 v[64:67], v204, s[8:11], s76 offen sc1
    s_add_u32 s76, s74, 885760
    buffer_load_dwordx4 v[68:71], v204, s[8:11], s76 offen sc1
    s_add_u32 s76, s75, 1024
    buffer_load_dwordx4 v[72:75], v205, s[4:7], s76 offen
    s_waitcnt vmcnt(14)
    v_mfma_f32_16x16x32_bf16 v[80:83], v[16:19], v[200:203], 0
    s_waitcnt vmcnt(13)
    v_mfma_f32_16x16x32_bf16 v[80:83], v[20:23], v[200:203], v[80:83]
    s_waitcnt vmcnt(12)
    v_mfma_f32_16x16x32_bf16 v[80:83], v[24:27], v[200:203], v[80:83]
    s_waitcnt vmcnt(11)
    v_mfma_f32_16x16x32_bf16 v[80:83], v[28:31], v[200:203], v[80:83]
    s_waitcnt vmcnt(10)
    v_mfma_f32_16x16x32_bf16 v[80:83], v[32:35], v[200:203], v[80:83]
    s_waitcnt vmcnt(9)
    v_mfma_f32_16x16x32_bf16 v[84:87], v[36:39], v[200:203], 0
    s_waitcnt vmcnt(8)
    v_mfma_f32_16x16x32_bf16 v[84:87], v[40:43], v[200:203], v[84:87]
    s_waitcnt vmcnt(7)
    v_mfma_f32_16x16x32_bf16 v[84:87], v[44:47], v[200:203], v[84:87]
    s_waitcnt vmcnt(6)
    v_mfma_f32_16x16x32_bf16 v[84:87], v[48:51], v[200:203], v[84:87]
    s_waitcnt vmcnt(5)
    v_mfma_f32_16x16x32_bf16 v[84:87], v[52:55], v[200:203], v[84:87]
    s_waitcnt vmcnt(4)
    v_mfma_f32_16x16x32_bf16 v[88:91], v[56:59], v[200:203], 0
    s_waitcnt vmcnt(3)
    v_mfma_f32_16x16x32_bf16 v[88:91], v[60:63], v[200:203], v[88:91]
    s_waitcnt vmcnt(2)
    v_mfma_f32_16x16x32_bf16 v[88:91], v[64:67], v[200:203], v[88:91]
    s_waitcnt vmcnt(1)
    v_mfma_f32_16x16x32_bf16 v[88:91], v[68:71], v[200:203], v[88:91]
    s_waitcnt vmcnt(0)
    v_mfma_f32_16x16x32_bf16 v[88:91], v[72:75], v[200:203], v[88:91]
    s_branch att_red
att_two:
    s_waitcnt vmcnt(9)
    v_mfma_f32_16x16x32_bf16 v[80:83], v[16:19], v[200:203], 0
    s_waitcnt vmcnt(8)
    v_mfma_f32_16x16x32_bf16 v[80:83], v[20:23], v[200:203], v[80:83]
    s_waitcnt vmcnt(7)
    v_mfma_f32_16x16x32_bf16 v[80:83], v[24:27], v[200:203], v[80:83]
    s_waitcnt vmcnt(6)
    v_mfma_f32_16x16x32_bf16 v[80:83], v[28:31], v[200:203], v[80:83]
    s_waitcnt vmcnt(5)
    v_mfma_f32_16x16x32_bf16 v[80:83], v[32:35], v[200:203], v[80:83]
    s_waitcnt vmcnt(4)
    v_mfma_f32_16x16x32_bf16 v[84:87], v[36:39], v[200:203], 0
    s_waitcnt vmcnt(3)
    v_mfma_f32_16x16x32_bf16 v[84:87], v[40:43], v[200:203], v[84:87]
    s_waitcnt vmcnt(2)
    v_mfma_f32_16x16x32_bf16 v[84:87], v[44:47], v[200:203], v[84:87]
    s_waitcnt vmcnt(1)
    v_mfma_f32_16x16x32_bf16 v[84:87], v[48:51], v[200:203], v[84:87]
    s_waitcnt vmcnt(0)
    v_mfma_f32_16x16x32_bf16 v[84:87], v[52:55], v[200:203], v[84:87]
att_red:
    s_add_u32 s69, s43, 3
    s_cmp_ge_u32 s69, 64
    s_cbranch_scc1 att_nokpf
    s_cmp_gt_u32 s48, s69
    s_cbranch_scc0 att_nokpf
    s_sub_u32 s70, 155648, s34
    s_lshl_b32 s52, s69, 5
    s_add_u32 s52, s52, s79
    s_lshl_b32 s54, s52, 12
    s_lshl_b32 s55, s22, 10
    s_add_u32 s55, s55, s70
    s_mov_b32 m0, s55
    s_add_u32 s56, s54, 54525952
    buffer_load_dwordx4 v213, s[8:11], s56 offen sc1 lds
    s_add_u32 m0, s55, 4096
    s_add_u32 s56, s54, 62914560
    buffer_load_dwordx4 v5, s[8:11], s56 offen sc1 lds
    s_mov_b32 s33, 1
att_nokpf:
    s_nop 7
    v_pk_add_f32 v[80:81], v[80:81], v[82:83]
    v_cvt_pk_bf16_f32 v116, v80, v81
    v_lshlrev_b32 v92, 16, v116
    v_and_b32 v93, 0xffff0000, v116
    v_pk_add_f32 v[84:85], v[84:85], v[86:87]
    v_cvt_pk_bf16_f32 v117, v84, v85
    v_lshlrev_b32 v94, 16, v117
    v_and_b32 v95, 0xffff0000, v117
    v_pk_add_f32 v[88:89], v[88:89], v[90:91]
    v_cvt_pk_bf16_f32 v118, v88, v89
    v_lshlrev_b32 v96, 16, v118
    v_and_b32 v97, 0xffff0000, v118
    ds_write_b16 v206, v116 offset:0
    ds_write_b16_d16_hi v206, v116 offset:16
    ds_write_b16 v206, v117 offset:512
    ds_write_b16_d16_hi v206, v117 offset:528
    s_cmp_eq_u32 s22, 0
    s_cbranch_scc0 att_t3a
    ds_write_b16 v206, v118 offset:1024
    ds_write_b16_d16_hi v206, v118 offset:1040
att_t3a:
    v_add_f32 v100, v92, v93
    v_mul_f32 v101, v92, v92
    v_fmac_f32 v101, v93, v93
    v_add_f32 v100, v100, v94
    v_fmac_f32 v101, v94, v94
    v_add_f32 v100, v100, v95
    v_fmac_f32 v101, v95, v95
    v_add_f32 v100, v100, v96
    v_fmac_f32 v101, v96, v96
    v_add_f32 v100, v100, v97
    v_fmac_f32 v101, v97, v97
    s_nop 0
    v_add_f32_dpp v100, v100, v100 row_ror:8 row_mask:0xf bank_mask:0xf
    v_add_f32_dpp v101, v101, v101 row_ror:8 row_mask:0xf bank_mask:0xf
    s_nop 0
    v_add_f32_dpp v100, v100, v100 row_ror:4 row_mask:0xf bank_mask:0xf
    v_add_f32_dpp v101, v101, v101 row_ror:4 row_mask:0xf bank_mask:0xf
    s_nop 0
    v_add_f32_dpp v100, v100, v100 row_ror:2 row_mask:0xf bank_mask:0xf
    v_add_f32_dpp v101, v101, v101 row_ror:2 row_mask:0xf bank_mask:0xf
    s_nop 0
    v_add_f32_dpp v100, v100, v100 row_ror:1 row_mask:0xf bank_mask:0xf
    v_add_f32_dpp v101, v101, v101 row_ror:1 row_mask:0xf bank_mask:0xf
    v_mov_b32 v112, v100
    v_mov_b32 v113, v101
    s_nop 0
    v_permlane16_swap_b32 v100, v112
    v_permlane16_swap_b32 v101, v113
    v_add_f32 v100, v100, v112
    v_add_f32 v101, v101, v113
    v_mov_b32 v112, v100
    v_mov_b32 v113, v101
    s_nop 0
    v_permlane32_swap_b32 v100, v112
    v_permlane32_swap_b32 v101, v113
    v_add_f32 v100, v100, v112
    v_add_f32 v101, v101, v113
    v_mov_b32 v112, v100
    v_mov_b32 v113, v101
    s_mov_b64 exec, 1
    ds_write_b64 v207, v[112:113] offset:3840
    s_mov_b64 exec, -1
    s_waitcnt lgkmcnt(0)
    s_barrier
    v_mov_b32 v112, 102400
    ds_read_b128 v[104:107], v112 offset:3840
    ds_read_b128 v[108:111], v112 offset:3856
    s_waitcnt lgkmcnt(0)
    v_pk_add_f32 v[104:105], v[104:105], v[106:107]
    v_pk_add_f32 v[108:109], v[108:109], v[110:111]
    v_pk_add_f32 v[104:105], v[104:105], v[108:109]
    v_mul_f32 v100, 0x3a638e39, v104
    v_mul_f32 v101, 0x3a638e39, v105
    v_fma_f32 v101, -v100, v100, v101
    v_max_f32 v104, 0, v101
    v_add_f32 v101, 0x3727c5ac, v104
    v_rsq_f32 v101, v101
    v_sub_f32 v92, v92, v100
    v_mul_f32 v92, v92, v101
    v_sub_f32 v93, v93, v100
    v_mul_f32 v93, v93, v101
    v_sub_f32 v94, v94, v100
    v_mul_f32 v94, v94, v101
    v_sub_f32 v95, v95, v100
    v_mul_f32 v95, v95, v101
    v_sub_f32 v96, v96, v100
    v_mul_f32 v96, v96, v101
    v_sub_f32 v97, v97, v100
    v_mul_f32 v97, v97, v101
    v_cvt_pk_bf16_f32 v116, v92, v93
    v_lshlrev_b32 v92, 16, v116
    v_and_b32 v93, 0xffff0000, v116
    v_cvt_pk_bf16_f32 v117, v94, v95
    v_lshlrev_b32 v94, 16, v117
    v_and_b32 v95, 0xffff0000, v117
    v_cvt_pk_bf16_f32 v118, v96, v97
    v_lshlrev_b32 v96, 16, v118
    v_and_b32 v97, 0xffff0000, v118
    ds_write_b16 v206, v116 offset:1280
    ds_write_b16_d16_hi v206, v116 offset:1296
    ds_write_b16 v206, v117 offset:1792
    ds_write_b16_d16_hi v206, v117 offset:1808
    s_cmp_eq_u32 s22, 0
    s_cbranch_scc0 att_t3b
    ds_write_b16 v206, v118 offset:2304
    ds_write_b16_d16_hi v206, v118 offset:2320
att_t3b:
    v_mul_f32 v104, v104, v101
    v_mov_b32 v105, 0x3727c5ac
    v_fmac_f32 v105, v104, v101
    v_rsq_f32 v105, v105
    s_nop 0
    v_mul_f32 v92, v92, v105
    v_mul_f32 v93, v93, v105
    v_mul_f32 v94, v94, v105
    v_mul_f32 v95, v95, v105
    v_mul_f32 v96, v96, v105
    v_mul_f32 v97, v97, v105
    v_cvt_pk_bf16_f32 v116, v92, v93
    v_cvt_pk_bf16_f32 v117, v94, v95
    v_cvt_pk_bf16_f32 v118, v96, v97
    ds_write_b16 v206, v116 offset:2560
    ds_write_b16_d16_hi v206, v116 offset:2576
    ds_write_b16 v206, v117 offset:3072
    ds_write_b16_d16_hi v206, v117 offset:3088
    s_cmp_eq_u32 s22, 0
    s_cbranch_scc0 att_t3c
    ds_write_b16 v206, v118 offset:3584
    ds_write_b16_d16_hi v206, v118 offset:3600
att_t3c:
    s_cmp_eq_u32 s22, 0
    s_cbranch_scc0 att_nobc
    v_mov_b32 v20, s48
    v_mov_b32 v21, 102400
    ds_write_b32 v21, v20 offset:3968
att_nobc:
    s_waitcnt lgkmcnt(0)
    s_barrier
    ds_read_b128 v[16:19], v209 offset:0
    s_mul_i32 s76, s43, 36864
    v_mov_b32 v21, 102400
    ds_read_b32 v20, v21 offset:3968
    s_waitcnt lgkmcnt(0)
    v_readfirstlane_b32 s35, v20
    buffer_store_dwordx4 v[16:19], v208, s[8:11], s76 offen sc1
    s_mov_b32 s37, s72
    s_add_u32 s73, s43, 3
    s_cmp_lt_u32 s73, 64
    s_cbranch_scc1 att_defer
    s_waitcnt vmcnt(0)
    s_barrier
    s_cmp_eq_u32 s22, 0
    s_cbranch_scc0 att_nph_now
    s_lshl_b32 s73, s82, 5
    s_add_u32 s73, s73, s79
    s_lshl_b32 s73, s73, 7
    s_add_u32 s73, s73, 73424896
    v_mov_b32 v214, s72
    v_mov_b32 v215, 0
    s_mov_b64 exec, 1
    buffer_store_dword v214, v215, s[8:11], s73 offen sc1
    s_mov_b64 exec, -1
att_nph_now:
att_defer:
    s_add_u32 s43, s43, 3
    s_add_u32 s44, s44, 1
    s_cmp_lt_u32 s43, 64
    s_cbranch_scc1 att_loop
att_timeout:
    s_branch L_exit
L_mlp:
    s_load_dwordx2 s[4:5], s[0:1], 96
    s_load_dwordx2 s[12:13], s[0:1], 88
    s_load_dwordx2 s[24:25], s[0:1], 80
    s_waitcnt lgkmcnt(0)
    s_and_b32 s5, s5, 0xffff
    s_mov_b32 s6, 2359296
    s_mov_b32 s7, 0x20000
    s_and_b32 s13, s13, 0xffff
    s_mov_b32 s14, 5308416
    s_mov_b32 s15, 0x20000
    s_lshl_b32 s86, s82, 8
    s_lshl_b32 s87, s79, 2
    s_add_u32 s86, s86, s87
    s_add_u32 s86, s86, 73442304
    s_add_u32 s87, s86, 128
    v_mov_b32 v1, 0
    v_mov_b32 v2, 0
    buffer_store_dword v1, v2, s[8:11], s86 offen sc1
    buffer_store_dword v1, v2, s[8:11], s87 offen sc1
    s_waitcnt vmcnt(0)
    s_barrier
    v_cmp_eq_u32 vcc, 0, v0
    s_and_saveexec_b64 s[20:21], vcc
    s_cbranch_execz mlp_arr
    v_mov_b32 v1, 1
    v_mov_b32 v2, 192
    buffer_atomic_add v1, v2, s[16:19], 0 offen
mlp_arr:
    s_mov_b64 exec, s[20:21]
    v_mov_b32 v2, 192
    s_mov_b32 s90, 0
mlp_wa:
    buffer_load_dword v1, v2, s[16:19], 0 offen sc1
    s_add_u32 s90, s90, 1
    s_cmp_gt_u32 s90, 65536
    s_cbranch_scc1 L_exit
    s_waitcnt vmcnt(0)
    v_readfirstlane_b32 s91, v1
    s_cmp_ge_u32 s91, 256
    s_cbranch_scc1 mlp_wa_ok
    s_sleep 4
    s_branch mlp_wa
mlp_wa_ok:
    s_mov_b32 s16, s24
    s_mov_b32 s17, s25
    s_and_b32 s17, s17, 0xffff
    s_mov_b32 s18, 5308416
    s_mov_b32 s19, 0x20000
    v_lshrrev_b32 v2, 6, v0
    s_nop 0
    v_readfirstlane_b32 s22, v2
    s_mul_i32 s40, s79, 221184
    v_and_b32 v1, 63, v0
    v_lshrrev_b32 v2, 6, v0
    v_lshlrev_b32 v3, 4, v1
    v_mul_u32_u24 v4, 9216, v2
    v_add_u32 v4, v4, v3
    v_lshrrev_b32 v5, 4, v1
    v_bfe_u32 v6, v1, 2, 2
    v_and_b32 v7, 3, v1
    v_lshl_add_u32 v8, v5, 2, v6
    v_mul_u32_u24 v8, 1152, v8
    v_mul_u32_u24 v9, 288, v2
    v_add_u32 v8, v8, v9
    v_lshl_add_u32 v9, v7, 4, v8
    v_lshl_add_u32 v10, v7, 3, v8
    v_add_u32 v9, 81920, v9
    v_add_u32 v10, 81920, v10
    v_add_u32 v11, 36864, v9
    v_add_u32 v12, 36864, v10
    s_mul_i32 s24, s22, 9216
    s_add_u32 m0, s24, 81920
    s_add_u32 s25, s40, 0
    buffer_load_dwordx4 v4, s[12:15], s25 offen offset:0 lds
    buffer_load_dwordx4 v4, s[12:15], s25 offen offset:1024 lds
    buffer_load_dwordx4 v4, s[12:15], s25 offen offset:2048 lds
    buffer_load_dwordx4 v4, s[12:15], s25 offen offset:3072 lds
    s_add_u32 m0, s24, 86016
    s_add_u32 s25, s40, 4096
    buffer_load_dwordx4 v4, s[12:15], s25 offen offset:0 lds
    buffer_load_dwordx4 v4, s[12:15], s25 offen offset:1024 lds
    buffer_load_dwordx4 v4, s[12:15], s25 offen offset:2048 lds
    buffer_load_dwordx4 v4, s[12:15], s25 offen offset:3072 lds
    s_add_u32 m0, s24, 90112
    s_add_u32 s25, s40, 8192
    buffer_load_dwordx4 v4, s[12:15], s25 offen offset:0 lds
    s_add_u32 m0, s24, 118784
    s_add_u32 s25, s40, 36864
    buffer_load_dwordx4 v4, s[12:15], s25 offen offset:0 lds
    buffer_load_dwordx4 v4, s[12:15], s25 offen offset:1024 lds
    buffer_load_dwordx4 v4, s[12:15], s25 offen offset:2048 lds
    buffer_load_dwordx4 v4, s[12:15], s25 offen offset:3072 lds
    s_add_u32 m0, s24, 122880
    s_add_u32 s25, s40, 40960
    buffer_load_dwordx4 v4, s[12:15], s25 offen offset:0 lds
    buffer_load_dwordx4 v4, s[12:15], s25 offen offset:1024 lds
    buffer_load_dwordx4 v4, s[12:15], s25 offen offset:2048 lds
    buffer_load_dwordx4 v4, s[12:15], s25 offen offset:3072 lds
    s_add_u32 m0, s24, 126976
    s_add_u32 s25, s40, 45056
    buffer_load_dwordx4 v4, s[12:15], s25 offen offset:0 lds
    s_waitcnt vmcnt(9)
    s_barrier
    ds_read_b64_tr_b16 a[0:1], v9 offset:0
    ds_read_b64_tr_b16 a[2:3], v9 offset:18432
    ds_read_b64_tr_b16 a[24:25], v9 offset:8
    ds_read_b64_tr_b16 a[26:27], v9 offset:18440
    ds_read_b64_tr_b16 a[48:49], v9 offset:64
    ds_read_b64_tr_b16 a[50:51], v9 offset:18496
    ds_read_b64_tr_b16 a[72:73], v9 offset:72
    ds_read_b64_tr_b16 a[74:75], v9 offset:18504
    ds_read_b64_tr_b16 a[96:97], v9 offset:128
    ds_read_b64_tr_b16 a[98:99], v9 offset:18560
    ds_read_b64_tr_b16 a[120:121], v9 offset:136
    ds_read_b64_tr_b16 a[122:123], v9 offset:18568
    ds_read_b64_tr_b16 a[144:145], v9 offset:192
    ds_read_b64_tr_b16 a[146:147], v9 offset:18624
    ds_read_b64_tr_b16 a[168:169], v9 offset:200
    ds_read_b64_tr_b16 a[170:171], v9 offset:18632
    ds_read_b64_tr_b16 a[192:193], v10 offset:256
    ds_read_b64_tr_b16 a[194:195], v10 offset:18688
    s_waitcnt lgkmcnt(0)
    s_barrier
    s_add_u32 m0, s24, 81920
    s_add_u32 s25, s40, 73728
    buffer_load_dwordx4 v4, s[12:15], s25 offen offset:0 lds
    buffer_load_dwordx4 v4, s[12:15], s25 offen offset:1024 lds
    buffer_load_dwordx4 v4, s[12:15], s25 offen offset:2048 lds
    buffer_load_dwordx4 v4, s[12:15], s25 offen offset:3072 lds
    s_add_u32 m0, s24, 86016
    s_add_u32 s25, s40, 77824
    buffer_load_dwordx4 v4, s[12:15], s25 offen offset:0 lds
    buffer_load_dwordx4 v4, s[12:15], s25 offen offset:1024 lds
    buffer_load_dwordx4 v4, s[12:15], s25 offen offset:2048 lds
    buffer_load_dwordx4 v4, s[12:15], s25 offen offset:3072 lds
    s_add_u32 m0, s24, 90112
    s_add_u32 s25, s40, 81920
    buffer_load_dwordx4 v4, s[12:15], s25 offen offset:0 lds
    s_waitcnt vmcnt(9)
    s_barrier
    ds_read_b64_tr_b16 a[4:5], v11 offset:0
    ds_read_b64_tr_b16 a[6:7], v11 offset:18432
    ds_read_b64_tr_b16 a[28:29], v11 offset:8
    ds_read_b64_tr_b16 a[30:31], v11 offset:18440
    ds_read_b64_tr_b16 a[52:53], v11 offset:64
    ds_read_b64_tr_b16 a[54:55], v11 offset:18496
    ds_read_b64_tr_b16 a[76:77], v11 offset:72
    ds_read_b64_tr_b16 a[78:79], v11 offset:18504
    ds_read_b64_tr_b16 a[100:101], v11 offset:128
    ds_read_b64_tr_b16 a[102:103], v11 offset:18560
    ds_read_b64_tr_b16 a[124:125], v11 offset:136
    ds_read_b64_tr_b16 a[126:127], v11 offset:18568
    ds_read_b64_tr_b16 a[148:149], v11 offset:192
    ds_read_b64_tr_b16 a[150:151], v11 offset:18624
    ds_read_b64_tr_b16 a[172:173], v11 offset:200
    ds_read_b64_tr_b16 a[174:175], v11 offset:18632
    ds_read_b64_tr_b16 a[196:197], v12 offset:256
    ds_read_b64_tr_b16 a[198:199], v12 offset:18688
    s_waitcnt lgkmcnt(0)
    s_barrier
    s_add_u32 m0, s24, 118784
    s_add_u32 s25, s40, 110592
    buffer_load_dwordx4 v4, s[12:15], s25 offen offset:0 lds
    buffer_load_dwordx4 v4, s[12:15], s25 offen offset:1024 lds
    buffer_load_dwordx4 v4, s[12:15], s25 offen offset:2048 lds
    buffer_load_dwordx4 v4, s[12:15], s25 offen offset:3072 lds
    s_add_u32 m0, s24, 122880
    s_add_u32 s25, s40, 114688
    buffer_load_dwordx4 v4, s[12:15], s25 offen offset:0 lds
    buffer_load_dwordx4 v4, s[12:15], s25 offen offset:1024 lds
    buffer_load_dwordx4 v4, s[12:15], s25 offen offset:2048 lds
    buffer_load_dwordx4 v4, s[12:15], s25 offen offset:3072 lds
    s_add_u32 m0, s24, 126976
    s_add_u32 s25, s40, 118784
    buffer_load_dwordx4 v4, s[12:15], s25 offen offset:0 lds
    s_waitcnt vmcnt(9)
    s_barrier
    ds_read_b64_tr_b16 a[8:9], v9 offset:0
    ds_read_b64_tr_b16 a[10:11], v9 offset:18432
    ds_read_b64_tr_b16 a[32:33], v9 offset:8
    ds_read_b64_tr_b16 a[34:35], v9 offset:18440
    ds_read_b64_tr_b16 a[56:57], v9 offset:64
    ds_read_b64_tr_b16 a[58:59], v9 offset:18496
    ds_read_b64_tr_b16 a[80:81], v9 offset:72
    ds_read_b64_tr_b16 a[82:83], v9 offset:18504
    ds_read_b64_tr_b16 a[104:105], v9 offset:128
    ds_read_b64_tr_b16 a[106:107], v9 offset:18560
    ds_read_b64_tr_b16 a[128:129], v9 offset:136
    ds_read_b64_tr_b16 a[130:131], v9 offset:18568
    ds_read_b64_tr_b16 a[152:153], v9 offset:192
    ds_read_b64_tr_b16 a[154:155], v9 offset:18624
    ds_read_b64_tr_b16 a[176:177], v9 offset:200
    ds_read_b64_tr_b16 a[178:179], v9 offset:18632
    ds_read_b64_tr_b16 a[200:201], v10 offset:256
    ds_read_b64_tr_b16 a[202:203], v10 offset:18688
    s_waitcnt lgkmcnt(0)
    s_barrier
    s_add_u32 m0, s24, 81920
    s_add_u32 s25, s40, 147456
    buffer_load_dwordx4 v4, s[12:15], s25 offen offset:0 lds
    buffer_load_dwordx4 v4, s[12:15], s25 offen offset:1024 lds
    buffer_load_dwordx4 v4, s[12:15], s25 offen offset:2048 lds
    buffer_load_dwordx4 v4, s[12:15], s25 offen offset:3072 lds
    s_add_u32 m0, s24, 86016
    s_add_u32 s25, s40, 151552
    buffer_load_dwordx4 v4, s[12:15], s25 offen offset:0 lds
    buffer_load_dwordx4 v4, s[12:15], s25 offen offset:1024 lds
    buffer_load_dwordx4 v4, s[12:15], s25 offen offset:2048 lds
    buffer_load_dwordx4 v4, s[12:15], s25 offen offset:3072 lds
    s_add_u32 m0, s24, 90112
    s_add_u32 s25, s40, 155648
    buffer_load_dwordx4 v4, s[12:15], s25 offen offset:0 lds
    s_waitcnt vmcnt(9)
    s_barrier
    ds_read_b64_tr_b16 a[12:13], v11 offset:0
    ds_read_b64_tr_b16 a[14:15], v11 offset:18432
    ds_read_b64_tr_b16 a[36:37], v11 offset:8
    ds_read_b64_tr_b16 a[38:39], v11 offset:18440
    ds_read_b64_tr_b16 a[60:61], v11 offset:64
    ds_read_b64_tr_b16 a[62:63], v11 offset:18496
    ds_read_b64_tr_b16 a[84:85], v11 offset:72
    ds_read_b64_tr_b16 a[86:87], v11 offset:18504
    ds_read_b64_tr_b16 a[108:109], v11 offset:128
    ds_read_b64_tr_b16 a[110:111], v11 offset:18560
    ds_read_b64_tr_b16 a[132:133], v11 offset:136
    ds_read_b64_tr_b16 a[134:135], v11 offset:18568
    ds_read_b64_tr_b16 a[156:157], v11 offset:192
    ds_read_b64_tr_b16 a[158:159], v11 offset:18624
    ds_read_b64_tr_b16 a[180:181], v11 offset:200
    ds_read_b64_tr_b16 a[182:183], v11 offset:18632
    ds_read_b64_tr_b16 a[204:205], v12 offset:256
    ds_read_b64_tr_b16 a[206:207], v12 offset:18688
    s_waitcnt lgkmcnt(0)
    s_barrier
    s_add_u32 m0, s24, 118784
    s_add_u32 s25, s40, 184320
    buffer_load_dwordx4 v4, s[12:15], s25 offen offset:0 lds
    buffer_load_dwordx4 v4, s[12:15], s25 offen offset:1024 lds
    buffer_load_dwordx4 v4, s[12:15], s25 offen offset:2048 lds
    buffer_load_dwordx4 v4, s[12:15], s25 offen offset:3072 lds
    s_add_u32 m0, s24, 122880
    s_add_u32 s25, s40, 188416
    buffer_load_dwordx4 v4, s[12:15], s25 offen offset:0 lds
    buffer_load_dwordx4 v4, s[12:15], s25 offen offset:1024 lds
    buffer_load_dwordx4 v4, s[12:15], s25 offen offset:2048 lds
    buffer_load_dwordx4 v4, s[12:15], s25 offen offset:3072 lds
    s_add_u32 m0, s24, 126976
    s_add_u32 s25, s40, 192512
    buffer_load_dwordx4 v4, s[12:15], s25 offen offset:0 lds
    s_waitcnt vmcnt(9)
    s_barrier
    ds_read_b64_tr_b16 a[16:17], v9 offset:0
    ds_read_b64_tr_b16 a[18:19], v9 offset:18432
    ds_read_b64_tr_b16 a[40:41], v9 offset:8
    ds_read_b64_tr_b16 a[42:43], v9 offset:18440
    ds_read_b64_tr_b16 a[64:65], v9 offset:64
    ds_read_b64_tr_b16 a[66:67], v9 offset:18496
    ds_read_b64_tr_b16 a[88:89], v9 offset:72
    ds_read_b64_tr_b16 a[90:91], v9 offset:18504
    ds_read_b64_tr_b16 a[112:113], v9 offset:128
    ds_read_b64_tr_b16 a[114:115], v9 offset:18560
    ds_read_b64_tr_b16 a[136:137], v9 offset:136
    ds_read_b64_tr_b16 a[138:139], v9 offset:18568
    ds_read_b64_tr_b16 a[160:161], v9 offset:192
    ds_read_b64_tr_b16 a[162:163], v9 offset:18624
    ds_read_b64_tr_b16 a[184:185], v9 offset:200
    ds_read_b64_tr_b16 a[186:187], v9 offset:18632
    ds_read_b64_tr_b16 a[208:209], v10 offset:256
    ds_read_b64_tr_b16 a[210:211], v10 offset:18688
    s_waitcnt lgkmcnt(0)
    s_barrier
    s_waitcnt vmcnt(0)
    s_barrier
    ds_read_b64_tr_b16 a[20:21], v11 offset:0
    ds_read_b64_tr_b16 a[22:23], v11 offset:18432
    ds_read_b64_tr_b16 a[44:45], v11 offset:8
    ds_read_b64_tr_b16 a[46:47], v11 offset:18440
    ds_read_b64_tr_b16 a[68:69], v11 offset:64
    ds_read_b64_tr_b16 a[70:71], v11 offset:18496
    ds_read_b64_tr_b16 a[92:93], v11 offset:72
    ds_read_b64_tr_b16 a[94:95], v11 offset:18504
    ds_read_b64_tr_b16 a[116:117], v11 offset:128
    ds_read_b64_tr_b16 a[118:119], v11 offset:18560
    ds_read_b64_tr_b16 a[140:141], v11 offset:136
    ds_read_b64_tr_b16 a[142:143], v11 offset:18568
    ds_read_b64_tr_b16 a[164:165], v11 offset:192
    ds_read_b64_tr_b16 a[166:167], v11 offset:18624
    ds_read_b64_tr_b16 a[188:189], v11 offset:200
    ds_read_b64_tr_b16 a[190:191], v11 offset:18632
    ds_read_b64_tr_b16 a[212:213], v12 offset:256
    ds_read_b64_tr_b16 a[214:215], v12 offset:18688
    s_waitcnt lgkmcnt(0)
    s_barrier
    s_mul_i32 s40, s79, 384
    v_and_b32 v1, 63, v0
    v_lshrrev_b32 v2, 6, v0
    v_mul_u32_u24 v3, 192, v2
    v_add_u32 v3, 0, v3
    v_add_u32 v3, v3, v1
    v_mul_u32_u24 v4, 2731, v3
    v_lshrrev_b32 v4, 16, v4
    v_mul_u32_u24 v5, 24, v4
    v_sub_u32 v5, v3, v5
    v_mul_u32_u24 v4, 9216, v4
    v_lshl_add_u32 v4, v5, 4, v4
    v_add_u32 v8, s40, v4
    v_mul_u32_u24 v3, 192, v2
    v_add_u32 v3, 64, v3
    v_add_u32 v3, v3, v1
    v_mul_u32_u24 v4, 2731, v3
    v_lshrrev_b32 v4, 16, v4
    v_mul_u32_u24 v5, 24, v4
    v_sub_u32 v5, v3, v5
    v_mul_u32_u24 v4, 9216, v4
    v_lshl_add_u32 v4, v5, 4, v4
    v_add_u32 v9, s40, v4
    v_mul_u32_u24 v3, 192, v2
    v_add_u32 v3, 128, v3
    v_add_u32 v3, v3, v1
    v_mul_u32_u24 v4, 2731, v3
    v_lshrrev_b32 v4, 16, v4
    v_mul_u32_u24 v5, 24, v4
    v_sub_u32 v5, v3, v5
    v_mul_u32_u24 v4, 9216, v4
    v_lshl_add_u32 v4, v5, 4, v4
    v_add_u32 v10, s40, v4
    v_lshrrev_b32 v3, 4, v1
    v_bfe_u32 v4, v1, 2, 2
    v_and_b32 v5, 3, v1
    v_lshl_add_u32 v6, v3, 3, v4
    v_mul_u32_u24 v6, 384, v6
    v_mul_u32_u24 v7, 96, v2
    v_add_u32 v6, v6, v7
    v_lshl_add_u32 v6, v5, 3, v6
    v_add_u32 v6, 81920, v6
    s_mul_i32 s24, s22, 3072
    s_mov_b32 s25, 0
    s_add_u32 m0, s24, 81920
    s_nop 0
    buffer_load_dwordx4 v8, s[16:19], s25 offen lds
    s_add_u32 m0, s24, 82944
    s_nop 0
    buffer_load_dwordx4 v9, s[16:19], s25 offen lds
    s_add_u32 m0, s24, 83968
    s_nop 0
    buffer_load_dwordx4 v10, s[16:19], s25 offen lds
    s_mov_b32 s25, 294912
    s_add_u32 m0, s24, 94208
    s_nop 0
    buffer_load_dwordx4 v8, s[16:19], s25 offen lds
    s_add_u32 m0, s24, 95232
    s_nop 0
    buffer_load_dwordx4 v9, s[16:19], s25 offen lds
    s_add_u32 m0, s24, 96256
    s_nop 0
    buffer_load_dwordx4 v10, s[16:19], s25 offen lds
    s_mov_b32 s25, 589824
    s_add_u32 m0, s24, 106496
    s_nop 0
    buffer_load_dwordx4 v8, s[16:19], s25 offen lds
    s_add_u32 m0, s24, 107520
    s_nop 0
    buffer_load_dwordx4 v9, s[16:19], s25 offen lds
    s_add_u32 m0, s24, 108544
    s_nop 0
    buffer_load_dwordx4 v10, s[16:19], s25 offen lds
    s_waitcnt vmcnt(6)
    s_barrier
    s_mov_b32 s25, 884736
    s_add_u32 m0, s24, 118784
    s_nop 0
    buffer_load_dwordx4 v8, s[16:19], s25 offen lds
    s_add_u32 m0, s24, 119808
    s_nop 0
    buffer_load_dwordx4 v9, s[16:19], s25 offen lds
    s_add_u32 m0, s24, 120832
    s_nop 0
    buffer_load_dwordx4 v10, s[16:19], s25 offen lds
    ds_read_b64_tr_b16 v[80:81], v6 offset:0
    ds_read_b64_tr_b16 v[82:83], v6 offset:1536
    ds_read_b64_tr_b16 v[152:153], v6 offset:32
    ds_read_b64_tr_b16 v[154:155], v6 offset:1568
    ds_read_b64_tr_b16 v[224:225], v6 offset:64
    ds_read_b64_tr_b16 v[226:227], v6 offset:1600
    s_waitcnt lgkmcnt(0)
    s_waitcnt vmcnt(6)
    s_barrier
    s_mov_b32 s25, 1179648
    s_add_u32 m0, s24, 81920
    s_nop 0
    buffer_load_dwordx4 v8, s[16:19], s25 offen lds
    s_add_u32 m0, s24, 82944
    s_nop 0
    buffer_load_dwordx4 v9, s[16:19], s25 offen lds
    s_add_u32 m0, s24, 83968
    s_nop 0
    buffer_load_dwordx4 v10, s[16:19], s25 offen lds
    ds_read_b64_tr_b16 v[84:85], v6 offset:12288
    ds_read_b64_tr_b16 v[86:87], v6 offset:13824
    ds_read_b64_tr_b16 v[156:157], v6 offset:12320
    ds_read_b64_tr_b16 v[158:159], v6 offset:13856
    ds_read_b64_tr_b16 v[228:229], v6 offset:12352
    ds_read_b64_tr_b16 v[230:231], v6 offset:13888
    s_waitcnt lgkmcnt(0)
    s_waitcnt vmcnt(6)
    s_barrier
    s_mov_b32 s25, 1474560
    s_add_u32 m0, s24, 94208
    s_nop 0
    buffer_load_dwordx4 v8, s[16:19], s25 offen lds
    s_add_u32 m0, s24, 95232
    s_nop 0
    buffer_load_dwordx4 v9, s[16:19], s25 offen lds
    s_add_u32 m0, s24, 96256
    s_nop 0
    buffer_load_dwordx4 v10, s[16:19], s25 offen lds
    ds_read_b64_tr_b16 v[88:89], v6 offset:24576
    ds_read_b64_tr_b16 v[90:91], v6 offset:26112
    ds_read_b64_tr_b16 v[160:161], v6 offset:24608
    ds_read_b64_tr_b16 v[162:163], v6 offset:26144
    ds_read_b64_tr_b16 v[232:233], v6 offset:24640
    ds_read_b64_tr_b16 v[234:235], v6 offset:26176
    s_waitcnt lgkmcnt(0)
    s_waitcnt vmcnt(6)
    s_barrier
    s_mov_b32 s25, 1769472
    s_add_u32 m0, s24, 106496
    s_nop 0
    buffer_load_dwordx4 v8, s[16:19], s25 offen lds
    s_add_u32 m0, s24, 107520
    s_nop 0
    buffer_load_dwordx4 v9, s[16:19], s25 offen lds
    s_add_u32 m0, s24, 108544
    s_nop 0
    buffer_load_dwordx4 v10, s[16:19], s25 offen lds
    ds_read_b64_tr_b16 v[92:93], v6 offset:36864
    ds_read_b64_tr_b16 v[94:95], v6 offset:38400
    ds_read_b64_tr_b16 v[164:165], v6 offset:36896
    ds_read_b64_tr_b16 v[166:167], v6 offset:38432
    ds_read_b64_tr_b16 v[236:237], v6 offset:36928
    ds_read_b64_tr_b16 v[238:239], v6 offset:38464
    s_waitcnt lgkmcnt(0)
    s_waitcnt vmcnt(6)
    s_barrier
    s_mov_b32 s25, 2064384
    s_add_u32 m0, s24, 118784
    s_nop 0
    buffer_load_dwordx4 v8, s[16:19], s25 offen lds
    s_add_u32 m0, s24, 119808
    s_nop 0
    buffer_load_dwordx4 v9, s[16:19], s25 offen lds
    s_add_u32 m0, s24, 120832
    s_nop 0
    buffer_load_dwordx4 v10, s[16:19], s25 offen lds
    ds_read_b64_tr_b16 v[96:97], v6 offset:0
    ds_read_b64_tr_b16 v[98:99], v6 offset:1536
    ds_read_b64_tr_b16 v[168:169], v6 offset:32
    ds_read_b64_tr_b16 v[170:171], v6 offset:1568
    ds_read_b64_tr_b16 v[240:241], v6 offset:64
    ds_read_b64_tr_b16 v[242:243], v6 offset:1600
    s_waitcnt lgkmcnt(0)
    s_waitcnt vmcnt(6)
    s_barrier
    s_mov_b32 s25, 2359296
    s_add_u32 m0, s24, 81920
    s_nop 0
    buffer_load_dwordx4 v8, s[16:19], s25 offen lds
    s_add_u32 m0, s24, 82944
    s_nop 0
    buffer_load_dwordx4 v9, s[16:19], s25 offen lds
    s_add_u32 m0, s24, 83968
    s_nop 0
    buffer_load_dwordx4 v10, s[16:19], s25 offen lds
    ds_read_b64_tr_b16 v[100:101], v6 offset:12288
    ds_read_b64_tr_b16 v[102:103], v6 offset:13824
    ds_read_b64_tr_b16 v[172:173], v6 offset:12320
    ds_read_b64_tr_b16 v[174:175], v6 offset:13856
    ds_read_b64_tr_b16 v[244:245], v6 offset:12352
    ds_read_b64_tr_b16 v[246:247], v6 offset:13888
    s_waitcnt lgkmcnt(0)
    s_waitcnt vmcnt(6)
    s_barrier
    s_mov_b32 s25, 2654208
    s_add_u32 m0, s24, 94208
    s_nop 0
    buffer_load_dwordx4 v8, s[16:19], s25 offen lds
    s_add_u32 m0, s24, 95232
    s_nop 0
    buffer_load_dwordx4 v9, s[16:19], s25 offen lds
    s_add_u32 m0, s24, 96256
    s_nop 0
    buffer_load_dwordx4 v10, s[16:19], s25 offen lds
    ds_read_b64_tr_b16 v[104:105], v6 offset:24576
    ds_read_b64_tr_b16 v[106:107], v6 offset:26112
    ds_read_b64_tr_b16 v[176:177], v6 offset:24608
    ds_read_b64_tr_b16 v[178:179], v6 offset:26144
    ds_read_b64_tr_b16 v[248:249], v6 offset:24640
    ds_read_b64_tr_b16 v[250:251], v6 offset:26176
    s_waitcnt lgkmcnt(0)
    s_waitcnt vmcnt(6)
    s_barrier
    s_mov_b32 s25, 2949120
    s_add_u32 m0, s24, 106496
    s_nop 0
    buffer_load_dwordx4 v8, s[16:19], s25 offen lds
    s_add_u32 m0, s24, 107520
    s_nop 0
    buffer_load_dwordx4 v9, s[16:19], s25 offen lds
    s_add_u32 m0, s24, 108544
    s_nop 0
    buffer_load_dwordx4 v10, s[16:19], s25 offen lds
    ds_read_b64_tr_b16 v[108:109], v6 offset:36864
    ds_read_b64_tr_b16 v[110:111], v6 offset:38400
    ds_read_b64_tr_b16 v[180:181], v6 offset:36896
    ds_read_b64_tr_b16 v[182:183], v6 offset:38432
    ds_read_b64_tr_b16 v[252:253], v6 offset:36928
    ds_read_b64_tr_b16 v[254:255], v6 offset:38464
    s_waitcnt lgkmcnt(0)
    s_waitcnt vmcnt(6)
    s_barrier
    s_mov_b32 s25, 3244032
    s_add_u32 m0, s24, 118784
    s_nop 0
    buffer_load_dwordx4 v8, s[16:19], s25 offen lds
    s_add_u32 m0, s24, 119808
    s_nop 0
    buffer_load_dwordx4 v9, s[16:19], s25 offen lds
    s_add_u32 m0, s24, 120832
    s_nop 0
    buffer_load_dwordx4 v10, s[16:19], s25 offen lds
    ds_read_b64_tr_b16 v[112:113], v6 offset:0
    ds_read_b64_tr_b16 v[114:115], v6 offset:1536
    ds_read_b64_tr_b16 v[184:185], v6 offset:32
    ds_read_b64_tr_b16 v[186:187], v6 offset:1568
    ds_read_b64_tr_b16 a[216:217], v6 offset:64
    ds_read_b64_tr_b16 a[218:219], v6 offset:1600
    s_waitcnt lgkmcnt(0)
    s_waitcnt vmcnt(6)
    s_barrier
    s_mov_b32 s25, 3538944
    s_add_u32 m0, s24, 81920
    s_nop 0
    buffer_load_dwordx4 v8, s[16:19], s25 offen lds
    s_add_u32 m0, s24, 82944
    s_nop 0
    buffer_load_dwordx4 v9, s[16:19], s25 offen lds
    s_add_u32 m0, s24, 83968
    s_nop 0
    buffer_load_dwordx4 v10, s[16:19], s25 offen lds
    ds_read_b64_tr_b16 v[116:117], v6 offset:12288
    ds_read_b64_tr_b16 v[118:119], v6 offset:13824
    ds_read_b64_tr_b16 v[188:189], v6 offset:12320
    ds_read_b64_tr_b16 v[190:191], v6 offset:13856
    ds_read_b64_tr_b16 a[220:221], v6 offset:12352
    ds_read_b64_tr_b16 a[222:223], v6 offset:13888
    s_waitcnt lgkmcnt(0)
    s_waitcnt vmcnt(6)
    s_barrier
    s_mov_b32 s25, 3833856
    s_add_u32 m0, s24, 94208
    s_nop 0
    buffer_load_dwordx4 v8, s[16:19], s25 offen lds
    s_add_u32 m0, s24, 95232
    s_nop 0
    buffer_load_dwordx4 v9, s[16:19], s25 offen lds
    s_add_u32 m0, s24, 96256
    s_nop 0
    buffer_load_dwordx4 v10, s[16:19], s25 offen lds
    ds_read_b64_tr_b16 v[120:121], v6 offset:24576
    ds_read_b64_tr_b16 v[122:123], v6 offset:26112
    ds_read_b64_tr_b16 v[192:193], v6 offset:24608
    ds_read_b64_tr_b16 v[194:195], v6 offset:26144
    ds_read_b64_tr_b16 a[224:225], v6 offset:24640
    ds_read_b64_tr_b16 a[226:227], v6 offset:26176
    s_waitcnt lgkmcnt(0)
    s_waitcnt vmcnt(6)
    s_barrier
    s_mov_b32 s25, 4128768
    s_add_u32 m0, s24, 106496
    s_nop 0
    buffer_load_dwordx4 v8, s[16:19], s25 offen lds
    s_add_u32 m0, s24, 107520
    s_nop 0
    buffer_load_dwordx4 v9, s[16:19], s25 offen lds
    s_add_u32 m0, s24, 108544
    s_nop 0
    buffer_load_dwordx4 v10, s[16:19], s25 offen lds
    ds_read_b64_tr_b16 v[124:125], v6 offset:36864
    ds_read_b64_tr_b16 v[126:127], v6 offset:38400
    ds_read_b64_tr_b16 v[196:197], v6 offset:36896
    ds_read_b64_tr_b16 v[198:199], v6 offset:38432
    ds_read_b64_tr_b16 a[228:229], v6 offset:36928
    ds_read_b64_tr_b16 a[230:231], v6 offset:38464
    s_waitcnt lgkmcnt(0)
    s_waitcnt vmcnt(6)
    s_barrier
    s_mov_b32 s25, 4423680
    s_add_u32 m0, s24, 118784
    s_nop 0
    buffer_load_dwordx4 v8, s[16:19], s25 offen lds
    s_add_u32 m0, s24, 119808
    s_nop 0
    buffer_load_dwordx4 v9, s[16:19], s25 offen lds
    s_add_u32 m0, s24, 120832
    s_nop 0
    buffer_load_dwordx4 v10, s[16:19], s25 offen lds
    ds_read_b64_tr_b16 v[128:129], v6 offset:0
    ds_read_b64_tr_b16 v[130:131], v6 offset:1536
    ds_read_b64_tr_b16 v[200:201], v6 offset:32
    ds_read_b64_tr_b16 v[202:203], v6 offset:1568
    ds_read_b64_tr_b16 a[232:233], v6 offset:64
    ds_read_b64_tr_b16 a[234:235], v6 offset:1600
    s_waitcnt lgkmcnt(0)
    s_waitcnt vmcnt(6)
    s_barrier
    s_mov_b32 s25, 4718592
    s_add_u32 m0, s24, 81920
    s_nop 0
    buffer_load_dwordx4 v8, s[16:19], s25 offen lds
    s_add_u32 m0, s24, 82944
    s_nop 0
    buffer_load_dwordx4 v9, s[16:19], s25 offen lds
    s_add_u32 m0, s24, 83968
    s_nop 0
    buffer_load_dwordx4 v10, s[16:19], s25 offen lds
    ds_read_b64_tr_b16 v[132:133], v6 offset:12288
    ds_read_b64_tr_b16 v[134:135], v6 offset:13824
    ds_read_b64_tr_b16 v[204:205], v6 offset:12320
    ds_read_b64_tr_b16 v[206:207], v6 offset:13856
    ds_read_b64_tr_b16 a[236:237], v6 offset:12352
    ds_read_b64_tr_b16 a[238:239], v6 offset:13888
    s_waitcnt lgkmcnt(0)
    s_waitcnt vmcnt(6)
    s_barrier
    s_mov_b32 s25, 5013504
    s_add_u32 m0, s24, 94208
    s_nop 0
    buffer_load_dwordx4 v8, s[16:19], s25 offen lds
    s_add_u32 m0, s24, 95232
    s_nop 0
    buffer_load_dwordx4 v9, s[16:19], s25 offen lds
    s_add_u32 m0, s24, 96256
    s_nop 0
    buffer_load_dwordx4 v10, s[16:19], s25 offen lds
    ds_read_b64_tr_b16 v[136:137], v6 offset:24576
    ds_read_b64_tr_b16 v[138:139], v6 offset:26112
    ds_read_b64_tr_b16 v[208:209], v6 offset:24608
    ds_read_b64_tr_b16 v[210:211], v6 offset:26144
    ds_read_b64_tr_b16 a[240:241], v6 offset:24640
    ds_read_b64_tr_b16 a[242:243], v6 offset:26176
    s_waitcnt lgkmcnt(0)
    s_waitcnt vmcnt(6)
    s_barrier
    ds_read_b64_tr_b16 v[140:141], v6 offset:36864
    ds_read_b64_tr_b16 v[142:143], v6 offset:38400
    ds_read_b64_tr_b16 v[212:213], v6 offset:36896
    ds_read_b64_tr_b16 v[214:215], v6 offset:38432
    ds_read_b64_tr_b16 a[244:245], v6 offset:36928
    ds_read_b64_tr_b16 a[246:247], v6 offset:38464
    s_waitcnt lgkmcnt(0)
    s_waitcnt vmcnt(3)
    s_barrier
    ds_read_b64_tr_b16 v[144:145], v6 offset:0
    ds_read_b64_tr_b16 v[146:147], v6 offset:1536
    ds_read_b64_tr_b16 v[216:217], v6 offset:32
    ds_read_b64_tr_b16 v[218:219], v6 offset:1568
    ds_read_b64_tr_b16 a[248:249], v6 offset:64
    ds_read_b64_tr_b16 a[250:251], v6 offset:1600
    s_waitcnt lgkmcnt(0)
    s_waitcnt vmcnt(0)
    s_barrier
    ds_read_b64_tr_b16 v[148:149], v6 offset:12288
    ds_read_b64_tr_b16 v[150:151], v6 offset:13824
    ds_read_b64_tr_b16 v[220:221], v6 offset:12320
    ds_read_b64_tr_b16 v[222:223], v6 offset:13856
    ds_read_b64_tr_b16 a[252:253], v6 offset:12352
    ds_read_b64_tr_b16 a[254:255], v6 offset:13888
    s_waitcnt lgkmcnt(0)
    s_barrier
    v_mov_b32 v16, 0x3f803f80
    v_mov_b32 v17, 0x3f803f80
    v_mov_b32 v18, 0x3f803f80
    v_mov_b32 v19, 0x3f803f80
    s_nop 1
    v_mfma_f32_16x16x32_bf16 v[68:71], v[80:83], v[16:19], 0
    v_mfma_f32_16x16x32_bf16 v[72:75], v[152:155], v[16:19], 0
    v_mfma_f32_16x16x32_bf16 v[76:79], v[224:227], v[16:19], 0
    v_mfma_f32_16x16x32_bf16 v[68:71], v[84:87], v[16:19], v[68:71]
    v_mfma_f32_16x16x32_bf16 v[72:75], v[156:159], v[16:19], v[72:75]
    v_mfma_f32_16x16x32_bf16 v[76:79], v[228:231], v[16:19], v[76:79]
    v_mfma_f32_16x16x32_bf16 v[68:71], v[88:91], v[16:19], v[68:71]
    v_mfma_f32_16x16x32_bf16 v[72:75], v[160:163], v[16:19], v[72:75]
    v_mfma_f32_16x16x32_bf16 v[76:79], v[232:235], v[16:19], v[76:79]
    v_mfma_f32_16x16x32_bf16 v[68:71], v[92:95], v[16:19], v[68:71]
    v_mfma_f32_16x16x32_bf16 v[72:75], v[164:167], v[16:19], v[72:75]
    v_mfma_f32_16x16x32_bf16 v[76:79], v[236:239], v[16:19], v[76:79]
    v_mfma_f32_16x16x32_bf16 v[68:71], v[96:99], v[16:19], v[68:71]
    v_mfma_f32_16x16x32_bf16 v[72:75], v[168:171], v[16:19], v[72:75]
    v_mfma_f32_16x16x32_bf16 v[76:79], v[240:243], v[16:19], v[76:79]
    v_mfma_f32_16x16x32_bf16 v[68:71], v[100:103], v[16:19], v[68:71]
    v_mfma_f32_16x16x32_bf16 v[72:75], v[172:175], v[16:19], v[72:75]
    v_mfma_f32_16x16x32_bf16 v[76:79], v[244:247], v[16:19], v[76:79]
    v_mfma_f32_16x16x32_bf16 v[68:71], v[104:107], v[16:19], v[68:71]
    v_mfma_f32_16x16x32_bf16 v[72:75], v[176:179], v[16:19], v[72:75]
    v_mfma_f32_16x16x32_bf16 v[76:79], v[248:251], v[16:19], v[76:79]
    v_mfma_f32_16x16x32_bf16 v[68:71], v[108:111], v[16:19], v[68:71]
    v_mfma_f32_16x16x32_bf16 v[72:75], v[180:183], v[16:19], v[72:75]
    v_mfma_f32_16x16x32_bf16 v[76:79], v[252:255], v[16:19], v[76:79]
    v_mfma_f32_16x16x32_bf16 v[68:71], v[112:115], v[16:19], v[68:71]
    v_mfma_f32_16x16x32_bf16 v[72:75], v[184:187], v[16:19], v[72:75]
    v_mfma_f32_16x16x32_bf16 v[76:79], a[216:219], v[16:19], v[76:79]
    v_mfma_f32_16x16x32_bf16 v[68:71], v[116:119], v[16:19], v[68:71]
    v_mfma_f32_16x16x32_bf16 v[72:75], v[188:191], v[16:19], v[72:75]
    v_mfma_f32_16x16x32_bf16 v[76:79], a[220:223], v[16:19], v[76:79]
    v_mfma_f32_16x16x32_bf16 v[68:71], v[120:123], v[16:19], v[68:71]
    v_mfma_f32_16x16x32_bf16 v[72:75], v[192:195], v[16:19], v[72:75]
    v_mfma_f32_16x16x32_bf16 v[76:79], a[224:227], v[16:19], v[76:79]
    v_mfma_f32_16x16x32_bf16 v[68:71], v[124:127], v[16:19], v[68:71]
    v_mfma_f32_16x16x32_bf16 v[72:75], v[196:199], v[16:19], v[72:75]
    v_mfma_f32_16x16x32_bf16 v[76:79], a[228:231], v[16:19], v[76:79]
    v_mfma_f32_16x16x32_bf16 v[68:71], v[128:131], v[16:19], v[68:71]
    v_mfma_f32_16x16x32_bf16 v[72:75], v[200:203], v[16:19], v[72:75]
    v_mfma_f32_16x16x32_bf16 v[76:79], a[232:235], v[16:19], v[76:79]
    v_mfma_f32_16x16x32_bf16 v[68:71], v[132:135], v[16:19], v[68:71]
    v_mfma_f32_16x16x32_bf16 v[72:75], v[204:207], v[16:19], v[72:75]
    v_mfma_f32_16x16x32_bf16 v[76:79], a[236:239], v[16:19], v[76:79]
    v_mfma_f32_16x16x32_bf16 v[68:71], v[136:139], v[16:19], v[68:71]
    v_mfma_f32_16x16x32_bf16 v[72:75], v[208:211], v[16:19], v[72:75]
    v_mfma_f32_16x16x32_bf16 v[76:79], a[240:243], v[16:19], v[76:79]
    v_mfma_f32_16x16x32_bf16 v[68:71], v[140:143], v[16:19], v[68:71]
    v_mfma_f32_16x16x32_bf16 v[72:75], v[212:215], v[16:19], v[72:75]
    v_mfma_f32_16x16x32_bf16 v[76:79], a[244:247], v[16:19], v[76:79]
    v_mfma_f32_16x16x32_bf16 v[68:71], v[144:147], v[16:19], v[68:71]
    v_mfma_f32_16x16x32_bf16 v[72:75], v[216:219], v[16:19], v[72:75]
    v_mfma_f32_16x16x32_bf16 v[76:79], a[248:251], v[16:19], v[76:79]
    v_mfma_f32_16x16x32_bf16 v[68:71], v[148:151], v[16:19], v[68:71]
    v_mfma_f32_16x16x32_bf16 v[72:75], v[220:223], v[16:19], v[72:75]
    v_mfma_f32_16x16x32_bf16 v[76:79], a[252:255], v[16:19], v[76:79]
    s_mov_b32 s43, s82
    s_mov_b32 s44, 0
    s_mov_b32 s41, 0xbdd2d3e8
    s_lshl_b32 s60, s79, 2
    s_add_u32 s60, s60, s22
    s_mul_hi_u32 s61, s60, 0x55555556
    s_mul_i32 s62, s61, 3
    s_sub_u32 s62, s60, s62
    s_mul_i32 s62, s62, 3
mlp_loop:
    v_and_b32 v1, 63, v0
    v_lshrrev_b32 v2, 6, v0
    v_lshlrev_b32 v3, 4, v1
    v_mul_u32_u24 v4, 9216, v2
    v_add_u32 v4, v4, v3
    v_and_b32 v6, 15, v1
    v_lshrrev_b32 v7, 4, v1
    v_mul_u32_u24 v8, 1152, v6
    v_mul_u32_u24 v9, 288, v2
    v_add_u32 v8, v8, v9
    v_lshl_add_u32 v9, v7, 3, v8
    v_add_u32 v9, 256, v9
    v_lshl_add_u32 v8, v7, 4, v8
    v_add_u32 v5, 73728, v3
    v_mul_u32_u24 v11, 40, v6
    v_mov_b32 v10, 0xc0135761
    s_and_b32 s57, s44, 1
    s_mul_i32 s57, s57, 36864
    s_and_b32 s50, s43, 1
    s_mul_i32 s51, s50, 640
    s_add_u32 s51, s51, 73438464
    s_add_u32 s52, s43, 1
    v_and_b32 v66, 63, v0
    v_min_u32 v66, 4, v66
    v_mul_u32_u24 v66, 128, v66
    s_mov_b32 s90, 0
mlp_pl_f:
    buffer_load_dword v67, v66, s[8:11], s51 offen sc1
    s_add_u32 s90, s90, 1
    s_cmp_gt_u32 s90, 65536
    s_cbranch_scc1 mlp_timeout
    s_waitcnt vmcnt(0)
    v_cmp_gt_u32 vcc, s52, v67
    s_cbranch_vccz mlp_pl_ok_f
    s_sleep 2
    s_branch mlp_pl_f
mlp_pl_ok_f:
    s_mul_i32 s48, s43, 36864
    s_add_u32 s48, s48, 124780544
    s_mul_i32 s26, s22, 9216
    s_add_u32 s26, s26, s57
    s_add_u32 m0, s26, 0
    s_add_u32 s32, s48, 0
    buffer_load_dwordx4 v4, s[8:11], s32 offen offset:0 sc1 lds
    buffer_load_dwordx4 v4, s[8:11], s32 offen offset:1024 sc1 lds
    buffer_load_dwordx4 v4, s[8:11], s32 offen offset:2048 sc1 lds
    buffer_load_dwordx4 v4, s[8:11], s32 offen offset:3072 sc1 lds
    s_add_u32 m0, s26, 4096
    s_add_u32 s32, s48, 4096
    buffer_load_dwordx4 v4, s[8:11], s32 offen offset:0 sc1 lds
    buffer_load_dwordx4 v4, s[8:11], s32 offen offset:1024 sc1 lds
    buffer_load_dwordx4 v4, s[8:11], s32 offen offset:2048 sc1 lds
    buffer_load_dwordx4 v4, s[8:11], s32 offen offset:3072 sc1 lds
    s_add_u32 m0, s26, 8192
    s_add_u32 s32, s48, 8192
    buffer_load_dwordx4 v4, s[8:11], s32 offen offset:0 sc1 lds
    s_mul_i32 s49, s43, 1280
    s_add_u32 s49, s49, 127926272
    buffer_load_dwordx4 v[40:43], v11, s[8:11], s49 offen offset:0 sc1
    buffer_load_dwordx4 v[44:47], v11, s[8:11], s49 offen offset:16 sc1
    buffer_load_dwordx2 v[48:49], v11, s[8:11], s49 offen offset:32 sc1
    buffer_load_dwordx4 v[50:53], v11, s[8:11], s49 offen offset:640 sc1
    buffer_load_dwordx4 v[54:57], v11, s[8:11], s49 offen offset:656 sc1
    buffer_load_dwordx2 v[58:59], v11, s[8:11], s49 offen offset:672 sc1
    v_add_u32 v12, s57, v3
    s_waitcnt vmcnt(0)
    v_pk_add_f32 v[40:41], v[40:41], v[42:43]
    v_pk_add_f32 v[44:45], v[44:45], v[46:47]
    v_pk_add_f32 v[40:41], v[40:41], v[48:49]
    v_pk_add_f32 v[40:41], v[40:41], v[44:45]
    v_mul_f32 v64, 0x3ae38e39, v40
    v_mul_f32 v65, 0x3ae38e39, v41
    v_fma_f32 v65, -v64, v64, v65
    v_max_f32 v65, 0, v65
    v_add_f32 v65, 0x3727c5ac, v65
    v_rsq_f32 v65, v65
    v_pk_add_f32 v[50:51], v[50:51], v[52:53]
    v_pk_add_f32 v[54:55], v[54:55], v[56:57]
    v_pk_add_f32 v[50:51], v[50:51], v[58:59]
    v_pk_add_f32 v[50:51], v[50:51], v[54:55]
    v_mul_f32 v38, 0x3ae38e39, v50
    v_mul_f32 v39, 0x3ae38e39, v51
    v_fma_f32 v39, -v38, v38, v39
    v_max_f32 v39, 0, v39
    v_add_f32 v39, 0x3727c5ac, v39
    v_rsq_f32 v39, v39
    s_barrier
    s_mul_i32 s49, s22, 3
    s_add_u32 s49, s49, 0
    s_lshr_b32 s50, s49, 1
    s_lshl_b32 s50, s50, 10
    s_and_b32 s49, s49, 1
    s_lshl_b32 s49, s49, 3
    s_add_u32 s53, s50, s49
    s_mul_i32 s49, s22, 3
    s_add_u32 s49, s49, 1
    s_lshr_b32 s50, s49, 1
    s_lshl_b32 s50, s50, 10
    s_and_b32 s49, s49, 1
    s_lshl_b32 s49, s49, 3
    s_add_u32 s54, s50, s49
    s_mul_i32 s49, s22, 3
    s_add_u32 s49, s49, 2
    s_lshr_b32 s50, s49, 1
    s_lshl_b32 s50, s50, 10
    s_and_b32 s49, s49, 1
    s_lshl_b32 s49, s49, 3
    s_add_u32 s55, s50, s49
    ds_read_b128 v[16:19], v12 offset:0
    ds_read_b128 v[20:23], v12 offset:2048
    ds_read_b128 v[24:27], v12 offset:4096
    ds_read_b128 v[28:31], v12 offset:6144
    s_waitcnt lgkmcnt(3)
    v_mfma_f32_16x16x32_bf16 v[40:43], v[80:83], v[16:19], 0
    v_mfma_f32_16x16x32_bf16 v[44:47], v[152:155], v[16:19], 0
    v_mfma_f32_16x16x32_bf16 v[48:51], v[224:227], v[16:19], 0
    ds_read_b128 v[16:19], v12 offset:8192
    s_waitcnt lgkmcnt(3)
    v_mfma_f32_16x16x32_bf16 v[40:43], v[84:87], v[20:23], v[40:43]
    v_mfma_f32_16x16x32_bf16 v[44:47], v[156:159], v[20:23], v[44:47]
    v_mfma_f32_16x16x32_bf16 v[48:51], v[228:231], v[20:23], v[48:51]
    ds_read_b128 v[20:23], v12 offset:10240
    s_waitcnt lgkmcnt(3)
    v_mfma_f32_16x16x32_bf16 v[40:43], v[88:91], v[24:27], v[40:43]
    v_mfma_f32_16x16x32_bf16 v[44:47], v[160:163], v[24:27], v[44:47]
    v_mfma_f32_16x16x32_bf16 v[48:51], v[232:235], v[24:27], v[48:51]
    ds_read_b128 v[24:27], v12 offset:12288
    s_waitcnt lgkmcnt(3)
    v_mfma_f32_16x16x32_bf16 v[40:43], v[92:95], v[28:31], v[40:43]
    v_mfma_f32_16x16x32_bf16 v[44:47], v[164:167], v[28:31], v[44:47]
    v_mfma_f32_16x16x32_bf16 v[48:51], v[236:239], v[28:31], v[48:51]
    ds_read_b128 v[28:31], v12 offset:14336
    s_waitcnt lgkmcnt(3)
    v_mfma_f32_16x16x32_bf16 v[40:43], v[96:99], v[16:19], v[40:43]
    v_mfma_f32_16x16x32_bf16 v[44:47], v[168:171], v[16:19], v[44:47]
    v_mfma_f32_16x16x32_bf16 v[48:51], v[240:243], v[16:19], v[48:51]
    ds_read_b128 v[16:19], v12 offset:16384
    s_waitcnt lgkmcnt(3)
    v_mfma_f32_16x16x32_bf16 v[40:43], v[100:103], v[20:23], v[40:43]
    v_mfma_f32_16x16x32_bf16 v[44:47], v[172:175], v[20:23], v[44:47]
    v_mfma_f32_16x16x32_bf16 v[48:51], v[244:247], v[20:23], v[48:51]
    ds_read_b128 v[20:23], v12 offset:18432
    s_waitcnt lgkmcnt(3)
    v_mfma_f32_16x16x32_bf16 v[40:43], v[104:107], v[24:27], v[40:43]
    v_mfma_f32_16x16x32_bf16 v[44:47], v[176:179], v[24:27], v[44:47]
    v_mfma_f32_16x16x32_bf16 v[48:51], v[248:251], v[24:27], v[48:51]
    ds_read_b128 v[24:27], v12 offset:20480
    s_waitcnt lgkmcnt(3)
    v_mfma_f32_16x16x32_bf16 v[40:43], v[108:111], v[28:31], v[40:43]
    v_mfma_f32_16x16x32_bf16 v[44:47], v[180:183], v[28:31], v[44:47]
    v_mfma_f32_16x16x32_bf16 v[48:51], v[252:255], v[28:31], v[48:51]
    ds_read_b128 v[28:31], v12 offset:22528
    s_waitcnt lgkmcnt(3)
    v_mfma_f32_16x16x32_bf16 v[40:43], v[112:115], v[16:19], v[40:43]
    v_mfma_f32_16x16x32_bf16 v[44:47], v[184:187], v[16:19], v[44:47]
    v_mfma_f32_16x16x32_bf16 v[48:51], a[216:219], v[16:19], v[48:51]
    ds_read_b128 v[16:19], v12 offset:24576
    s_waitcnt lgkmcnt(3)
    v_mfma_f32_16x16x32_bf16 v[40:43], v[116:119], v[20:23], v[40:43]
    v_mfma_f32_16x16x32_bf16 v[44:47], v[188:191], v[20:23], v[44:47]
    v_mfma_f32_16x16x32_bf16 v[48:51], a[220:223], v[20:23], v[48:51]
    ds_read_b128 v[20:23], v12 offset:26624
    s_waitcnt lgkmcnt(3)
    v_mfma_f32_16x16x32_bf16 v[40:43], v[120:123], v[24:27], v[40:43]
    v_mfma_f32_16x16x32_bf16 v[44:47], v[192:195], v[24:27], v[44:47]
    v_mfma_f32_16x16x32_bf16 v[48:51], a[224:227], v[24:27], v[48:51]
    ds_read_b128 v[24:27], v12 offset:28672
    s_waitcnt lgkmcnt(3)
    v_mfma_f32_16x16x32_bf16 v[40:43], v[124:127], v[28:31], v[40:43]
    v_mfma_f32_16x16x32_bf16 v[44:47], v[196:199], v[28:31], v[44:47]
    v_mfma_f32_16x16x32_bf16 v[48:51], a[228:231], v[28:31], v[48:51]
    ds_read_b128 v[28:31], v12 offset:30720
    s_waitcnt lgkmcnt(3)
    v_mfma_f32_16x16x32_bf16 v[40:43], v[128:131], v[16:19], v[40:43]
    v_mfma_f32_16x16x32_bf16 v[44:47], v[200:203], v[16:19], v[44:47]
    v_mfma_f32_16x16x32_bf16 v[48:51], a[232:235], v[16:19], v[48:51]
    ds_read_b128 v[16:19], v12 offset:32768
    s_waitcnt lgkmcnt(3)
    v_mfma_f32_16x16x32_bf16 v[40:43], v[132:135], v[20:23], v[40:43]
    v_mfma_f32_16x16x32_bf16 v[44:47], v[204:207], v[20:23], v[44:47]
    v_mfma_f32_16x16x32_bf16 v[48:51], a[236:239], v[20:23], v[48:51]
    ds_read_b128 v[20:23], v12 offset:34816
    s_waitcnt lgkmcnt(3)
    v_mfma_f32_16x16x32_bf16 v[40:43], v[136:139], v[24:27], v[40:43]
    v_mfma_f32_16x16x32_bf16 v[44:47], v[208:211], v[24:27], v[44:47]
    v_mfma_f32_16x16x32_bf16 v[48:51], a[240:243], v[24:27], v[48:51]
    ds_read_b128 v[24:27], v12 offset:1024
    s_waitcnt lgkmcnt(3)
    v_mfma_f32_16x16x32_bf16 v[40:43], v[140:143], v[28:31], v[40:43]
    v_mfma_f32_16x16x32_bf16 v[44:47], v[212:215], v[28:31], v[44:47]
    v_mfma_f32_16x16x32_bf16 v[48:51], a[244:247], v[28:31], v[48:51]
    ds_read_b128 v[28:31], v12 offset:3072
    s_waitcnt lgkmcnt(3)
    v_mfma_f32_16x16x32_bf16 v[40:43], v[144:147], v[16:19], v[40:43]
    v_mfma_f32_16x16x32_bf16 v[44:47], v[216:219], v[16:19], v[44:47]
    v_mfma_f32_16x16x32_bf16 v[48:51], a[248:251], v[16:19], v[48:51]
    ds_read_b128 v[16:19], v12 offset:5120
    s_waitcnt lgkmcnt(3)
    v_mfma_f32_16x16x32_bf16 v[40:43], v[148:151], v[20:23], v[40:43]
    v_mfma_f32_16x16x32_bf16 v[44:47], v[220:223], v[20:23], v[44:47]
    v_mfma_f32_16x16x32_bf16 v[48:51], a[252:255], v[20:23], v[48:51]
    ds_read_b128 v[20:23], v12 offset:7168
    s_waitcnt lgkmcnt(3)
    v_mfma_f32_16x16x32_bf16 v[52:55], v[80:83], v[24:27], 0
    v_mfma_f32_16x16x32_bf16 v[56:59], v[152:155], v[24:27], 0
    v_mfma_f32_16x16x32_bf16 v[60:63], v[224:227], v[24:27], 0
    ds_read_b128 v[24:27], v12 offset:9216
    s_waitcnt lgkmcnt(3)
    v_mfma_f32_16x16x32_bf16 v[52:55], v[84:87], v[28:31], v[52:55]
    v_fma_f32 v40, -v64, v68, v40
    v_fma_f32 v41, -v64, v69, v41
    v_mfma_f32_16x16x32_bf16 v[56:59], v[156:159], v[28:31], v[56:59]
    v_fma_f32 v42, -v64, v70, v42
    v_fma_f32 v43, -v64, v71, v43
    v_mfma_f32_16x16x32_bf16 v[60:63], v[228:231], v[28:31], v[60:63]
    v_mul_f32 v40, v40, v65
    v_mul_f32 v41, v41, v65
    ds_read_b128 v[28:31], v12 offset:11264
    s_waitcnt lgkmcnt(3)
    v_mfma_f32_16x16x32_bf16 v[52:55], v[88:91], v[16:19], v[52:55]
    v_mul_f32 v42, v42, v65
    v_mul_f32 v43, v43, v65
    v_mfma_f32_16x16x32_bf16 v[56:59], v[160:163], v[16:19], v[56:59]
    v_mul_f32 v32, v40, v40
    v_mul_f32 v33, v41, v41
    v_mfma_f32_16x16x32_bf16 v[60:63], v[232:235], v[16:19], v[60:63]
    v_mul_f32 v34, v42, v42
    v_mul_f32 v35, v43, v43
    ds_read_b128 v[16:19], v12 offset:13312
    s_waitcnt lgkmcnt(3)
    v_mfma_f32_16x16x32_bf16 v[52:55], v[92:95], v[20:23], v[52:55]
    v_fma_f32 v32, v32, s41, v10
    v_fma_f32 v33, v33, s41, v10
    v_mfma_f32_16x16x32_bf16 v[56:59], v[164:167], v[20:23], v[56:59]
    v_fma_f32 v34, v34, s41, v10
    v_fma_f32 v35, v35, s41, v10
    v_mfma_f32_16x16x32_bf16 v[60:63], v[236:239], v[20:23], v[60:63]
    v_mul_f32 v32, v32, v40
    v_mul_f32 v33, v33, v41
    ds_read_b128 v[20:23], v12 offset:15360
    s_waitcnt lgkmcnt(3)
    v_mfma_f32_16x16x32_bf16 v[52:55], v[96:99], v[24:27], v[52:55]
    v_mul_f32 v34, v34, v42
    v_mul_f32 v35, v35, v43
    v_mfma_f32_16x16x32_bf16 v[56:59], v[168:171], v[24:27], v[56:59]
    v_exp_f32 v32, v32
    v_exp_f32 v33, v33
    v_mfma_f32_16x16x32_bf16 v[60:63], v[240:243], v[24:27], v[60:63]
    v_exp_f32 v34, v34
    v_exp_f32 v35, v35
    ds_read_b128 v[24:27], v12 offset:17408
    s_waitcnt lgkmcnt(3)
    v_mfma_f32_16x16x32_bf16 v[52:55], v[100:103], v[28:31], v[52:55]
    v_add_f32 v32, 1.0, v32
    v_add_f32 v33, 1.0, v33
    v_mfma_f32_16x16x32_bf16 v[56:59], v[172:175], v[28:31], v[56:59]
    v_add_f32 v34, 1.0, v34
    v_add_f32 v35, 1.0, v35
    v_mfma_f32_16x16x32_bf16 v[60:63], v[244:247], v[28:31], v[60:63]
    v_rcp_f32 v32, v32
    v_rcp_f32 v33, v33
    ds_read_b128 v[28:31], v12 offset:19456
    s_waitcnt lgkmcnt(3)
    v_mfma_f32_16x16x32_bf16 v[52:55], v[104:107], v[16:19], v[52:55]
    v_rcp_f32 v34, v34
    v_rcp_f32 v35, v35
    v_mfma_f32_16x16x32_bf16 v[56:59], v[176:179], v[16:19], v[56:59]
    v_mul_f32 v40, v40, v32
    v_mul_f32 v41, v41, v33
    v_mfma_f32_16x16x32_bf16 v[60:63], v[248:251], v[16:19], v[60:63]
    v_mul_f32 v42, v42, v34
    v_mul_f32 v43, v43, v35
    ds_read_b128 v[16:19], v12 offset:21504
    s_waitcnt lgkmcnt(3)
    v_mfma_f32_16x16x32_bf16 v[52:55], v[108:111], v[20:23], v[52:55]
    v_cvt_pk_bf16_f32 v36, v40, v41
    v_cvt_pk_bf16_f32 v37, v42, v43
    v_mfma_f32_16x16x32_bf16 v[56:59], v[180:183], v[20:23], v[56:59]
    v_add_u32 v4, s53, v5
    ds_write_b64 v4, v[36:37] offset:0
    v_mfma_f32_16x16x32_bf16 v[60:63], v[252:255], v[20:23], v[60:63]
    v_fma_f32 v44, -v64, v72, v44
    v_fma_f32 v45, -v64, v73, v45
    ds_read_b128 v[20:23], v12 offset:23552
    s_waitcnt lgkmcnt(4)
    v_mfma_f32_16x16x32_bf16 v[52:55], v[112:115], v[24:27], v[52:55]
    v_fma_f32 v46, -v64, v74, v46
    v_fma_f32 v47, -v64, v75, v47
    v_mfma_f32_16x16x32_bf16 v[56:59], v[184:187], v[24:27], v[56:59]
    v_mul_f32 v44, v44, v65
    v_mul_f32 v45, v45, v65
    v_mfma_f32_16x16x32_bf16 v[60:63], a[216:219], v[24:27], v[60:63]
    v_mul_f32 v46, v46, v65
    v_mul_f32 v47, v47, v65
    ds_read_b128 v[24:27], v12 offset:25600
    s_waitcnt lgkmcnt(4)
    v_mfma_f32_16x16x32_bf16 v[52:55], v[116:119], v[28:31], v[52:55]
    v_mul_f32 v32, v44, v44
    v_mul_f32 v33, v45, v45
    v_mfma_f32_16x16x32_bf16 v[56:59], v[188:191], v[28:31], v[56:59]
    v_mul_f32 v34, v46, v46
    v_mul_f32 v35, v47, v47
    v_mfma_f32_16x16x32_bf16 v[60:63], a[220:223], v[28:31], v[60:63]
    v_fma_f32 v32, v32, s41, v10
    v_fma_f32 v33, v33, s41, v10
    ds_read_b128 v[28:31], v12 offset:27648
    s_waitcnt lgkmcnt(4)
    v_mfma_f32_16x16x32_bf16 v[52:55], v[120:123], v[16:19], v[52:55]
    v_fma_f32 v34, v34, s41, v10
    v_fma_f32 v35, v35, s41, v10
    v_mfma_f32_16x16x32_bf16 v[56:59], v[192:195], v[16:19], v[56:59]
    v_mul_f32 v32, v32, v44
    v_mul_f32 v33, v33, v45
    v_mfma_f32_16x16x32_bf16 v[60:63], a[224:227], v[16:19], v[60:63]
    v_mul_f32 v34, v34, v46
    v_mul_f32 v35, v35, v47
    ds_read_b128 v[16:19], v12 offset:29696
    s_waitcnt lgkmcnt(3)
    v_mfma_f32_16x16x32_bf16 v[52:55], v[124:127], v[20:23], v[52:55]
    v_exp_f32 v32, v32
    v_exp_f32 v33, v33
    v_mfma_f32_16x16x32_bf16 v[56:59], v[196:199], v[20:23], v[56:59]
    v_exp_f32 v34, v34
    v_exp_f32 v35, v35
    v_mfma_f32_16x16x32_bf16 v[60:63], a[228:231], v[20:23], v[60:63]
    v_add_f32 v32, 1.0, v32
    v_add_f32 v33, 1.0, v33
    ds_read_b128 v[20:23], v12 offset:31744
    s_waitcnt lgkmcnt(3)
    v_mfma_f32_16x16x32_bf16 v[52:55], v[128:131], v[24:27], v[52:55]
    v_add_f32 v34, 1.0, v34
    v_add_f32 v35, 1.0, v35
    v_mfma_f32_16x16x32_bf16 v[56:59], v[200:203], v[24:27], v[56:59]
    v_rcp_f32 v32, v32
    v_rcp_f32 v33, v33
    v_mfma_f32_16x16x32_bf16 v[60:63], a[232:235], v[24:27], v[60:63]
    v_rcp_f32 v34, v34
    v_rcp_f32 v35, v35
    ds_read_b128 v[24:27], v12 offset:33792
    s_waitcnt lgkmcnt(3)
    v_mfma_f32_16x16x32_bf16 v[52:55], v[132:135], v[28:31], v[52:55]
    v_mul_f32 v44, v44, v32
    v_mul_f32 v45, v45, v33
    v_mfma_f32_16x16x32_bf16 v[56:59], v[204:207], v[28:31], v[56:59]
    v_mul_f32 v46, v46, v34
    v_mul_f32 v47, v47, v35
    v_mfma_f32_16x16x32_bf16 v[60:63], a[236:239], v[28:31], v[60:63]
    v_cvt_pk_bf16_f32 v36, v44, v45
    v_cvt_pk_bf16_f32 v37, v46, v47
    ds_read_b128 v[28:31], v12 offset:35840
    s_waitcnt lgkmcnt(3)
    v_mfma_f32_16x16x32_bf16 v[52:55], v[136:139], v[16:19], v[52:55]
    v_add_u32 v4, s54, v5
    ds_write_b64 v4, v[36:37] offset:0
    v_mfma_f32_16x16x32_bf16 v[56:59], v[208:211], v[16:19], v[56:59]
    v_fma_f32 v48, -v64, v76, v48
    v_fma_f32 v49, -v64, v77, v49
    v_mfma_f32_16x16x32_bf16 v[60:63], a[240:243], v[16:19], v[60:63]
    v_fma_f32 v50, -v64, v78, v50
    v_fma_f32 v51, -v64, v79, v51
    s_waitcnt lgkmcnt(3)
    v_mfma_f32_16x16x32_bf16 v[52:55], v[140:143], v[20:23], v[52:55]
    v_mul_f32 v48, v48, v65
    v_mul_f32 v49, v49, v65
    v_mfma_f32_16x16x32_bf16 v[56:59], v[212:215], v[20:23], v[56:59]
    v_mul_f32 v50, v50, v65
    v_mul_f32 v51, v51, v65
    v_mfma_f32_16x16x32_bf16 v[60:63], a[244:247], v[20:23], v[60:63]
    v_mul_f32 v32, v48, v48
    v_mul_f32 v33, v49, v49
    s_waitcnt lgkmcnt(2)
    v_mfma_f32_16x16x32_bf16 v[52:55], v[144:147], v[24:27], v[52:55]
    v_mul_f32 v34, v50, v50
    v_mul_f32 v35, v51, v51
    v_mfma_f32_16x16x32_bf16 v[56:59], v[216:219], v[24:27], v[56:59]
    v_fma_f32 v32, v32, s41, v10
    v_fma_f32 v33, v33, s41, v10
    v_mfma_f32_16x16x32_bf16 v[60:63], a[248:251], v[24:27], v[60:63]
    v_fma_f32 v34, v34, s41, v10
    v_fma_f32 v35, v35, s41, v10
    s_waitcnt lgkmcnt(1)
    v_mfma_f32_16x16x32_bf16 v[52:55], v[148:151], v[28:31], v[52:55]
    v_mul_f32 v32, v32, v48
    v_mul_f32 v33, v33, v49
    v_mfma_f32_16x16x32_bf16 v[56:59], v[220:223], v[28:31], v[56:59]
    v_mul_f32 v34, v34, v50
    v_mul_f32 v35, v35, v51
    v_mfma_f32_16x16x32_bf16 v[60:63], a[252:255], v[28:31], v[60:63]
    v_exp_f32 v32, v32
    v_exp_f32 v33, v33
    v_exp_f32 v34, v34
    v_exp_f32 v35, v35
    v_add_f32 v32, 1.0, v32
    v_add_f32 v33, 1.0, v33
    v_add_f32 v34, 1.0, v34
    v_add_f32 v35, 1.0, v35
    v_rcp_f32 v32, v32
    v_rcp_f32 v33, v33
    v_rcp_f32 v34, v34
    v_rcp_f32 v35, v35
    v_mul_f32 v48, v48, v32
    v_mul_f32 v49, v49, v33
    v_mul_f32 v50, v50, v34
    v_mul_f32 v51, v51, v35
    v_cvt_pk_bf16_f32 v36, v48, v49
    v_cvt_pk_bf16_f32 v37, v50, v51
    v_add_u32 v4, s55, v5
    ds_write_b64 v4, v[36:37] offset:0
    s_waitcnt lgkmcnt(0)
    s_barrier
    s_and_b32 s58, s44, 1
    s_mul_i32 s58, s58, 884736
    s_mul_i32 s59, s82, 1769472
    s_add_u32 s58, s58, s59
    s_add_u32 s58, s58, 134217728
    s_mul_i32 s59, s79, 36864
    s_add_u32 s59, s59, s58
    ds_read_b128 v[16:19], v5 offset:0
    ds_read_b128 v[20:23], v5 offset:1024
    ds_read_b128 v[24:27], v5 offset:2048
    ds_read_b128 v[28:31], v5 offset:3072
    ds_read_b128 v[40:43], v5 offset:4096
    ds_read_b128 v[44:47], v5 offset:5120
    s_waitcnt lgkmcnt(5)
    v_mfma_f32_16x16x32_bf16 v[48:51], a[0:3], v[16:19], 0
    v_fma_f32 v52, -v38, v68, v52
    v_fma_f32 v53, -v38, v69, v53
    s_waitcnt lgkmcnt(4)
    v_mfma_f32_16x16x32_bf16 v[48:51], a[4:7], v[20:23], v[48:51]
    v_fma_f32 v54, -v38, v70, v54
    v_fma_f32 v55, -v38, v71, v55
    s_waitcnt lgkmcnt(3)
    v_mfma_f32_16x16x32_bf16 v[48:51], a[8:11], v[24:27], v[48:51]
    v_mul_f32 v52, v52, v39
    v_mul_f32 v53, v53, v39
    s_waitcnt lgkmcnt(2)
    v_mfma_f32_16x16x32_bf16 v[48:51], a[12:15], v[28:31], v[48:51]
    v_mul_f32 v54, v54, v39
    v_mul_f32 v55, v55, v39
    s_waitcnt lgkmcnt(1)
    v_mfma_f32_16x16x32_bf16 v[48:51], a[16:19], v[40:43], v[48:51]
    v_mul_f32 v32, v52, v52
    v_mul_f32 v33, v53, v53
    s_waitcnt lgkmcnt(0)
    v_mfma_f32_16x16x32_bf16 v[48:51], a[20:23], v[44:47], v[48:51]
    v_mul_f32 v34, v54, v54
    v_mul_f32 v35, v55, v55
    v_mfma_f32_16x16x32_bf16 v[12:15], a[24:27], v[16:19], 0
    v_fma_f32 v32, v32, s41, v10
    v_fma_f32 v33, v33, s41, v10
    v_mfma_f32_16x16x32_bf16 v[12:15], a[28:31], v[20:23], v[12:15]
    v_fma_f32 v34, v34, s41, v10
    v_fma_f32 v35, v35, s41, v10
    v_mfma_f32_16x16x32_bf16 v[12:15], a[32:35], v[24:27], v[12:15]
    v_mul_f32 v32, v32, v52
    v_mul_f32 v33, v33, v53
    v_mfma_f32_16x16x32_bf16 v[12:15], a[36:39], v[28:31], v[12:15]
    v_mul_f32 v34, v34, v54
    v_mul_f32 v35, v35, v55
    v_mfma_f32_16x16x32_bf16 v[12:15], a[40:43], v[40:43], v[12:15]
    v_exp_f32 v32, v32
    v_exp_f32 v33, v33
    v_mfma_f32_16x16x32_bf16 v[12:15], a[44:47], v[44:47], v[12:15]
    v_exp_f32 v34, v34
    v_exp_f32 v35, v35
    v_cvt_pk_bf16_f32 v64, v48, v49
    v_cvt_pk_bf16_f32 v65, v50, v51
    v_mfma_f32_16x16x32_bf16 v[48:51], a[48:51], v[16:19], 0
    v_add_f32 v32, 1.0, v32
    v_add_f32 v33, 1.0, v33
    v_mfma_f32_16x16x32_bf16 v[48:51], a[52:55], v[20:23], v[48:51]
    v_add_f32 v34, 1.0, v34
    v_add_f32 v35, 1.0, v35
    v_mfma_f32_16x16x32_bf16 v[48:51], a[56:59], v[24:27], v[48:51]
    v_rcp_f32 v32, v32
    v_rcp_f32 v33, v33
    v_mfma_f32_16x16x32_bf16 v[48:51], a[60:63], v[28:31], v[48:51]
    v_rcp_f32 v34, v34
    v_rcp_f32 v35, v35
    v_mfma_f32_16x16x32_bf16 v[48:51], a[64:67], v[40:43], v[48:51]
    v_mul_f32 v52, v52, v32
    v_mul_f32 v53, v53, v33
    v_mfma_f32_16x16x32_bf16 v[48:51], a[68:71], v[44:47], v[48:51]
    v_mul_f32 v54, v54, v34
    v_mul_f32 v55, v55, v35
    v_cvt_pk_bf16_f32 v66, v12, v13
    v_cvt_pk_bf16_f32 v67, v14, v15
    buffer_store_dwordx4 v[64:67], v8, s[8:11], s59 offen offset:0
    v_mfma_f32_16x16x32_bf16 v[12:15], a[72:75], v[16:19], 0
    v_cvt_pk_bf16_f32 v36, v52, v53
    v_cvt_pk_bf16_f32 v37, v54, v55
    v_mfma_f32_16x16x32_bf16 v[12:15], a[76:79], v[20:23], v[12:15]
    v_add_u32 v4, s53, v5
    ds_write_b64 v4, v[36:37] offset:6144
    v_mfma_f32_16x16x32_bf16 v[12:15], a[80:83], v[24:27], v[12:15]
    v_fma_f32 v56, -v38, v72, v56
    v_fma_f32 v57, -v38, v73, v57
    v_mfma_f32_16x16x32_bf16 v[12:15], a[84:87], v[28:31], v[12:15]
    v_fma_f32 v58, -v38, v74, v58
    v_fma_f32 v59, -v38, v75, v59
    v_mfma_f32_16x16x32_bf16 v[12:15], a[88:91], v[40:43], v[12:15]
    v_mul_f32 v56, v56, v39
    v_mul_f32 v57, v57, v39
    v_mfma_f32_16x16x32_bf16 v[12:15], a[92:95], v[44:47], v[12:15]
    v_mul_f32 v58, v58, v39
    v_mul_f32 v59, v59, v39
    v_cvt_pk_bf16_f32 v64, v48, v49
    v_cvt_pk_bf16_f32 v65, v50, v51
    v_mfma_f32_16x16x32_bf16 v[48:51], a[96:99], v[16:19], 0
    v_mul_f32 v32, v56, v56
    v_mul_f32 v33, v57, v57
    v_mfma_f32_16x16x32_bf16 v[48:51], a[100:103], v[20:23], v[48:51]
    v_mul_f32 v34, v58, v58
    v_mul_f32 v35, v59, v59
    v_mfma_f32_16x16x32_bf16 v[48:51], a[104:107], v[24:27], v[48:51]
    v_fma_f32 v32, v32, s41, v10
    v_fma_f32 v33, v33, s41, v10
    v_mfma_f32_16x16x32_bf16 v[48:51], a[108:111], v[28:31], v[48:51]
    v_fma_f32 v34, v34, s41, v10
    v_fma_f32 v35, v35, s41, v10
    v_mfma_f32_16x16x32_bf16 v[48:51], a[112:115], v[40:43], v[48:51]
    v_mul_f32 v32, v32, v56
    v_mul_f32 v33, v33, v57
    v_mfma_f32_16x16x32_bf16 v[48:51], a[116:119], v[44:47], v[48:51]
    v_mul_f32 v34, v34, v58
    v_mul_f32 v35, v35, v59
    v_cvt_pk_bf16_f32 v66, v12, v13
    v_cvt_pk_bf16_f32 v67, v14, v15
    buffer_store_dwordx4 v[64:67], v8, s[8:11], s59 offen offset:64
    v_mfma_f32_16x16x32_bf16 v[12:15], a[120:123], v[16:19], 0
    v_exp_f32 v32, v32
    v_exp_f32 v33, v33
    v_mfma_f32_16x16x32_bf16 v[12:15], a[124:127], v[20:23], v[12:15]
    v_exp_f32 v34, v34
    v_exp_f32 v35, v35
    v_mfma_f32_16x16x32_bf16 v[12:15], a[128:131], v[24:27], v[12:15]
    v_add_f32 v32, 1.0, v32
    v_add_f32 v33, 1.0, v33
    v_mfma_f32_16x16x32_bf16 v[12:15], a[132:135], v[28:31], v[12:15]
    v_add_f32 v34, 1.0, v34
    v_add_f32 v35, 1.0, v35
    v_mfma_f32_16x16x32_bf16 v[12:15], a[136:139], v[40:43], v[12:15]
    v_rcp_f32 v32, v32
    v_rcp_f32 v33, v33
    v_mfma_f32_16x16x32_bf16 v[12:15], a[140:143], v[44:47], v[12:15]
    v_rcp_f32 v34, v34
    v_rcp_f32 v35, v35
    v_cvt_pk_bf16_f32 v64, v48, v49
    v_cvt_pk_bf16_f32 v65, v50, v51
    v_mfma_f32_16x16x32_bf16 v[48:51], a[144:147], v[16:19], 0
    v_mul_f32 v56, v56, v32
    v_mul_f32 v57, v57, v33
    v_mfma_f32_16x16x32_bf16 v[48:51], a[148:151], v[20:23], v[48:51]
    v_mul_f32 v58, v58, v34
    v_mul_f32 v59, v59, v35
    v_mfma_f32_16x16x32_bf16 v[48:51], a[152:155], v[24:27], v[48:51]
    v_cvt_pk_bf16_f32 v36, v56, v57
    v_cvt_pk_bf16_f32 v37, v58, v59
    v_mfma_f32_16x16x32_bf16 v[48:51], a[156:159], v[28:31], v[48:51]
    v_add_u32 v4, s54, v5
    ds_write_b64 v4, v[36:37] offset:6144
    v_mfma_f32_16x16x32_bf16 v[48:51], a[160:163], v[40:43], v[48:51]
    v_fma_f32 v60, -v38, v76, v60
    v_fma_f32 v61, -v38, v77, v61
    v_mfma_f32_16x16x32_bf16 v[48:51], a[164:167], v[44:47], v[48:51]
    v_fma_f32 v62, -v38, v78, v62
    v_fma_f32 v63, -v38, v79, v63
    v_cvt_pk_bf16_f32 v66, v12, v13
    v_cvt_pk_bf16_f32 v67, v14, v15
    buffer_store_dwordx4 v[64:67], v8, s[8:11], s59 offen offset:128
    v_mfma_f32_16x16x32_bf16 v[12:15], a[168:171], v[16:19], 0
    v_mul_f32 v60, v60, v39
    v_mul_f32 v61, v61, v39
    v_mfma_f32_16x16x32_bf16 v[12:15], a[172:175], v[20:23], v[12:15]
    v_mul_f32 v62, v62, v39
    v_mul_f32 v63, v63, v39
    v_mfma_f32_16x16x32_bf16 v[12:15], a[176:179], v[24:27], v[12:15]
    v_mul_f32 v32, v60, v60
    v_mul_f32 v33, v61, v61
    v_mfma_f32_16x16x32_bf16 v[12:15], a[180:183], v[28:31], v[12:15]
    v_mul_f32 v34, v62, v62
    v_mul_f32 v35, v63, v63
    v_mfma_f32_16x16x32_bf16 v[12:15], a[184:187], v[40:43], v[12:15]
    v_fma_f32 v32, v32, s41, v10
    v_fma_f32 v33, v33, s41, v10
    v_mfma_f32_16x16x32_bf16 v[12:15], a[188:191], v[44:47], v[12:15]
    v_fma_f32 v34, v34, s41, v10
    v_fma_f32 v35, v35, s41, v10
    v_cvt_pk_bf16_f32 v64, v48, v49
    v_cvt_pk_bf16_f32 v65, v50, v51
    v_mfma_f32_16x16x32_bf16 v[48:51], a[192:195], v[16:19], 0
    v_mul_f32 v32, v32, v60
    v_mul_f32 v33, v33, v61
    v_mfma_f32_16x16x32_bf16 v[48:51], a[196:199], v[20:23], v[48:51]
    v_mul_f32 v34, v34, v62
    v_mul_f32 v35, v35, v63
    v_mfma_f32_16x16x32_bf16 v[48:51], a[200:203], v[24:27], v[48:51]
    v_exp_f32 v32, v32
    v_exp_f32 v33, v33
    v_mfma_f32_16x16x32_bf16 v[48:51], a[204:207], v[28:31], v[48:51]
    v_exp_f32 v34, v34
    v_exp_f32 v35, v35
    v_mfma_f32_16x16x32_bf16 v[48:51], a[208:211], v[40:43], v[48:51]
    v_add_f32 v32, 1.0, v32
    v_add_f32 v33, 1.0, v33
    v_mfma_f32_16x16x32_bf16 v[48:51], a[212:215], v[44:47], v[48:51]
    v_add_f32 v34, 1.0, v34
    v_add_f32 v35, 1.0, v35
    v_cvt_pk_bf16_f32 v66, v12, v13
    v_cvt_pk_bf16_f32 v67, v14, v15
    buffer_store_dwordx4 v[64:67], v8, s[8:11], s59 offen offset:192
    v_rcp_f32 v32, v32
    v_rcp_f32 v33, v33
    v_rcp_f32 v34, v34
    v_rcp_f32 v35, v35
    v_mul_f32 v60, v60, v32
    v_mul_f32 v61, v61, v33
    v_mul_f32 v62, v62, v34
    v_mul_f32 v63, v63, v35
    v_cvt_pk_bf16_f32 v36, v60, v61
    v_cvt_pk_bf16_f32 v37, v62, v63
    v_add_u32 v4, s55, v5
    ds_write_b64 v4, v[36:37] offset:6144
    v_cvt_pk_bf16_f32 v64, v48, v49
    v_cvt_pk_bf16_f32 v65, v50, v51
    buffer_store_dwordx2 v[64:65], v9, s[8:11], s59 offen
    s_waitcnt lgkmcnt(0)
    s_barrier
    ds_read_b128 v[16:19], v5 offset:6144
    ds_read_b128 v[20:23], v5 offset:7168
    ds_read_b128 v[24:27], v5 offset:8192
    ds_read_b128 v[28:31], v5 offset:9216
    ds_read_b128 v[32:35], v5 offset:10240
    ds_read_b128 v[36:39], v5 offset:11264
    s_add_u32 s59, s59, 18432
    s_waitcnt lgkmcnt(5)
    v_mfma_f32_16x16x32_bf16 v[40:43], a[0:3], v[16:19], 0
    s_waitcnt lgkmcnt(4)
    v_mfma_f32_16x16x32_bf16 v[40:43], a[4:7], v[20:23], v[40:43]
    s_waitcnt lgkmcnt(3)
    v_mfma_f32_16x16x32_bf16 v[40:43], a[8:11], v[24:27], v[40:43]
    s_waitcnt lgkmcnt(2)
    v_mfma_f32_16x16x32_bf16 v[40:43], a[12:15], v[28:31], v[40:43]
    s_waitcnt lgkmcnt(1)
    v_mfma_f32_16x16x32_bf16 v[40:43], a[16:19], v[32:35], v[40:43]
    s_waitcnt lgkmcnt(0)
    v_mfma_f32_16x16x32_bf16 v[40:43], a[20:23], v[36:39], v[40:43]
    v_mfma_f32_16x16x32_bf16 v[44:47], a[24:27], v[16:19], 0
    v_mfma_f32_16x16x32_bf16 v[44:47], a[28:31], v[20:23], v[44:47]
    v_mfma_f32_16x16x32_bf16 v[44:47], a[32:35], v[24:27], v[44:47]
    v_mfma_f32_16x16x32_bf16 v[44:47], a[36:39], v[28:31], v[44:47]
    v_mfma_f32_16x16x32_bf16 v[44:47], a[40:43], v[32:35], v[44:47]
    v_mfma_f32_16x16x32_bf16 v[44:47], a[44:47], v[36:39], v[44:47]
    v_cvt_pk_bf16_f32 v48, v40, v41
    v_cvt_pk_bf16_f32 v49, v42, v43
    v_mfma_f32_16x16x32_bf16 v[40:43], a[48:51], v[16:19], 0
    v_mfma_f32_16x16x32_bf16 v[40:43], a[52:55], v[20:23], v[40:43]
    v_mfma_f32_16x16x32_bf16 v[40:43], a[56:59], v[24:27], v[40:43]
    v_mfma_f32_16x16x32_bf16 v[40:43], a[60:63], v[28:31], v[40:43]
    v_mfma_f32_16x16x32_bf16 v[40:43], a[64:67], v[32:35], v[40:43]
    v_mfma_f32_16x16x32_bf16 v[40:43], a[68:71], v[36:39], v[40:43]
    v_cvt_pk_bf16_f32 v50, v44, v45
    v_cvt_pk_bf16_f32 v51, v46, v47
    buffer_store_dwordx4 v[48:51], v8, s[8:11], s59 offen offset:0
    v_mfma_f32_16x16x32_bf16 v[44:47], a[72:75], v[16:19], 0
    v_mfma_f32_16x16x32_bf16 v[44:47], a[76:79], v[20:23], v[44:47]
    v_mfma_f32_16x16x32_bf16 v[44:47], a[80:83], v[24:27], v[44:47]
    v_mfma_f32_16x16x32_bf16 v[44:47], a[84:87], v[28:31], v[44:47]
    v_mfma_f32_16x16x32_bf16 v[44:47], a[88:91], v[32:35], v[44:47]
    v_mfma_f32_16x16x32_bf16 v[44:47], a[92:95], v[36:39], v[44:47]
    v_cvt_pk_bf16_f32 v48, v40, v41
    v_cvt_pk_bf16_f32 v49, v42, v43
    v_mfma_f32_16x16x32_bf16 v[40:43], a[96:99], v[16:19], 0
    v_mfma_f32_16x16x32_bf16 v[40:43], a[100:103], v[20:23], v[40:43]
    v_mfma_f32_16x16x32_bf16 v[40:43], a[104:107], v[24:27], v[40:43]
    v_mfma_f32_16x16x32_bf16 v[40:43], a[108:111], v[28:31], v[40:43]
    v_mfma_f32_16x16x32_bf16 v[40:43], a[112:115], v[32:35], v[40:43]
    v_mfma_f32_16x16x32_bf16 v[40:43], a[116:119], v[36:39], v[40:43]
    v_cvt_pk_bf16_f32 v50, v44, v45
    v_cvt_pk_bf16_f32 v51, v46, v47
    buffer_store_dwordx4 v[48:51], v8, s[8:11], s59 offen offset:64
    v_mfma_f32_16x16x32_bf16 v[44:47], a[120:123], v[16:19], 0
    v_mfma_f32_16x16x32_bf16 v[44:47], a[124:127], v[20:23], v[44:47]
    v_mfma_f32_16x16x32_bf16 v[44:47], a[128:131], v[24:27], v[44:47]
    v_mfma_f32_16x16x32_bf16 v[44:47], a[132:135], v[28:31], v[44:47]
    v_mfma_f32_16x16x32_bf16 v[44:47], a[136:139], v[32:35], v[44:47]
    v_mfma_f32_16x16x32_bf16 v[44:47], a[140:143], v[36:39], v[44:47]
    v_cvt_pk_bf16_f32 v48, v40, v41
    v_cvt_pk_bf16_f32 v49, v42, v43
    v_mfma_f32_16x16x32_bf16 v[40:43], a[144:147], v[16:19], 0
    v_mfma_f32_16x16x32_bf16 v[40:43], a[148:151], v[20:23], v[40:43]
    v_mfma_f32_16x16x32_bf16 v[40:43], a[152:155], v[24:27], v[40:43]
    v_mfma_f32_16x16x32_bf16 v[40:43], a[156:159], v[28:31], v[40:43]
    v_mfma_f32_16x16x32_bf16 v[40:43], a[160:163], v[32:35], v[40:43]
    v_mfma_f32_16x16x32_bf16 v[40:43], a[164:167], v[36:39], v[40:43]
    v_cvt_pk_bf16_f32 v50, v44, v45
    v_cvt_pk_bf16_f32 v51, v46, v47
    buffer_store_dwordx4 v[48:51], v8, s[8:11], s59 offen offset:128
    v_mfma_f32_16x16x32_bf16 v[44:47], a[168:171], v[16:19], 0
    v_mfma_f32_16x16x32_bf16 v[44:47], a[172:175], v[20:23], v[44:47]
    v_mfma_f32_16x16x32_bf16 v[44:47], a[176:179], v[24:27], v[44:47]
    v_mfma_f32_16x16x32_bf16 v[44:47], a[180:183], v[28:31], v[44:47]
    v_mfma_f32_16x16x32_bf16 v[44:47], a[184:187], v[32:35], v[44:47]
    v_mfma_f32_16x16x32_bf16 v[44:47], a[188:191], v[36:39], v[44:47]
    v_cvt_pk_bf16_f32 v48, v40, v41
    v_cvt_pk_bf16_f32 v49, v42, v43
    v_mfma_f32_16x16x32_bf16 v[40:43], a[192:195], v[16:19], 0
    v_mfma_f32_16x16x32_bf16 v[40:43], a[196:199], v[20:23], v[40:43]
    v_mfma_f32_16x16x32_bf16 v[40:43], a[200:203], v[24:27], v[40:43]
    v_mfma_f32_16x16x32_bf16 v[40:43], a[204:207], v[28:31], v[40:43]
    v_mfma_f32_16x16x32_bf16 v[40:43], a[208:211], v[32:35], v[40:43]
    v_mfma_f32_16x16x32_bf16 v[40:43], a[212:215], v[36:39], v[40:43]
    v_cvt_pk_bf16_f32 v50, v44, v45
    v_cvt_pk_bf16_f32 v51, v46, v47
    buffer_store_dwordx4 v[48:51], v8, s[8:11], s59 offen offset:192
    s_nop 4
    v_cvt_pk_bf16_f32 v48, v40, v41
    v_cvt_pk_bf16_f32 v49, v42, v43
    buffer_store_dwordx2 v[48:49], v9, s[8:11], s59 offen
    s_waitcnt vmcnt(0)
    s_barrier
    s_and_b32 s71, s44, 1
    s_lshl_b32 s72, s82, 1
    s_add_u32 s71, s71, s72
    s_lshl_b32 s71, s71, 7
    s_add_u32 s71, s71, 73442304
    s_add_u32 s72, s43, 1
    s_cmp_eq_u32 s22, 0
    s_cbranch_scc0 mlp_nopub
    v_mov_b32 v16, s72
    s_lshl_b32 s73, s79, 2
    v_mov_b32 v17, s73
    s_mov_b64 exec, 1
    buffer_store_dword v16, v17, s[8:11], s71 offen
    s_mov_b64 exec, -1
mlp_nopub:
    v_lshrrev_b32 v16, 2, v6
    v_and_b32 v17, 1, v6
    v_bfe_u32 v18, v6, 1, 1
    v_lshl_add_u32 v19, v16, 1, v17
    v_lshl_add_u32 v20, v7, 1, v18
    v_mul_u32_u24 v14, 36864, v20
    v_lshl_add_u32 v14, v19, 4, v14
    s_mul_i32 s50, s61, 1152
    v_lshlrev_b32 v21, 4, v19
    v_add_u32 v21, s50, v21
    v_add_u32 v21, 109051904, v21
    v_lshrrev_b32 v22, 2, v19
    v_lshlrev_b32 v22, 11, v22
    v_and_b32 v23, 3, v19
    v_lshl_add_u32 v22, v23, 8, v22
    s_lshr_b32 s50, s61, 4
    s_lshl_b32 s50, s50, 10
    s_and_b32 s51, s61, 15
    s_lshl_b32 s51, s51, 4
    s_add_u32 s50, s50, s51
    v_add_u32 v22, s50, v22
    v_add_u32 v22, 124780544, v22
    v_mov_b32 v23, 0x7fff0000
    v_cmp_eq_u32 vcc, 0, v20
    s_nop 1
    v_cndmask_b32 v15, v23, v21, vcc
    v_mov_b32 v13, 128
    v_cmp_eq_u32 vcc, 1, v20
    s_nop 1
    v_cndmask_b32 v15, v15, v22, vcc
    v_mov_b32 v24, 4096
    v_cndmask_b32 v13, v13, v24, vcc
    v_and_b32 v16, 1, v1
    v_lshlrev_b32 v16, 4, v16
    v_mov_b32 v17, 0x3f80
    v_lshlrev_b32 v16, v16, v17
    v_bfe_u32 v17, v1, 1, 2
    v_cmp_eq_u32 vcc, 0, v17
    s_nop 1
    v_cndmask_b32 v64, 0, v16, vcc
    v_cmp_eq_u32 vcc, 1, v17
    s_nop 1
    v_cndmask_b32 v65, 0, v16, vcc
    v_cmp_eq_u32 vcc, 2, v17
    s_nop 1
    v_cndmask_b32 v66, 0, v16, vcc
    v_cmp_eq_u32 vcc, 3, v17
    s_nop 1
    v_cndmask_b32 v67, 0, v16, vcc
    v_mad_u32_u24 v15, v13, s62, v15
    s_mul_i32 s74, s61, 1152
    s_add_u32 s74, s74, s58
    s_lshl_b32 s75, s62, 7
    s_add_u32 s74, s74, s75
    s_mul_i32 s76, s43, 36864
    v_and_b32 v17, 63, v0
    v_min_u32 v17, 23, v17
    v_lshlrev_b32 v17, 2, v17
    s_mov_b32 s73, 0
mlp_p5poll:
    buffer_load_dword v16, v17, s[8:11], s71 offen sc1
    s_add_u32 s73, s73, 1
    s_cmp_gt_u32 s73, 65536
    s_cbranch_scc1 mlp_timeout
    s_waitcnt vmcnt(0)
    v_cmp_ne_u32 vcc, s72, v16
    s_cbranch_vccnz mlp_p5poll
    s_add_u32 s77, s74, 0
    buffer_load_dwordx4 v[16:19], v14, s[8:11], s77 offen sc1
    s_add_u32 s77, s74, 294912
    buffer_load_dwordx4 v[20:23], v14, s[8:11], s77 offen sc1
    s_add_u32 s77, s74, 589824
    buffer_load_dwordx4 v[24:27], v14, s[8:11], s77 offen sc1
    buffer_load_dwordx4 v[28:31], v15, s[8:11], s76 offen sc1
    v_add_u32 v15, v15, v13
    s_add_u32 s77, s74, 128
    buffer_load_dwordx4 v[32:35], v14, s[8:11], s77 offen sc1
    s_add_u32 s77, s74, 295040
    buffer_load_dwordx4 v[36:39], v14, s[8:11], s77 offen sc1
    s_add_u32 s77, s74, 589952
    buffer_load_dwordx4 v[40:43], v14, s[8:11], s77 offen sc1
    buffer_load_dwordx4 v[44:47], v15, s[8:11], s76 offen sc1
    v_add_u32 v15, v15, v13
    s_add_u32 s77, s74, 256
    buffer_load_dwordx4 v[48:51], v14, s[8:11], s77 offen sc1
    s_add_u32 s77, s74, 295168
    buffer_load_dwordx4 v[52:55], v14, s[8:11], s77 offen sc1
    s_add_u32 s77, s74, 590080
    buffer_load_dwordx4 v[56:59], v14, s[8:11], s77 offen sc1
    buffer_load_dwordx4 v[60:63], v15, s[8:11], s76 offen sc1
    v_and_b32 v12, 7, v1
    v_lshl_add_u32 v12, v7, 4, v12
    v_lshlrev_b32 v12, 1, v12
    s_mul_i32 s50, s22, 384
    s_add_u32 s50, s50, 86016
    v_add_u32 v12, s50, v12
    s_waitcnt vmcnt(11)
    v_mfma_f32_16x16x32_bf16 v[8:11], v[16:19], v[64:67], 0
    s_waitcnt vmcnt(10)
    v_mfma_f32_16x16x32_bf16 v[8:11], v[20:23], v[64:67], v[8:11]
    s_waitcnt vmcnt(9)
    v_mfma_f32_16x16x32_bf16 v[8:11], v[24:27], v[64:67], v[8:11]
    s_waitcnt vmcnt(8)
    v_mfma_f32_16x16x32_bf16 v[8:11], v[28:31], v[64:67], v[8:11]
    s_waitcnt vmcnt(7)
    v_mfma_f32_16x16x32_bf16 v[16:19], v[32:35], v[64:67], 0
    s_waitcnt vmcnt(6)
    v_mfma_f32_16x16x32_bf16 v[16:19], v[36:39], v[64:67], v[16:19]
    s_waitcnt vmcnt(5)
    v_mfma_f32_16x16x32_bf16 v[16:19], v[40:43], v[64:67], v[16:19]
    s_waitcnt vmcnt(4)
    v_mfma_f32_16x16x32_bf16 v[16:19], v[44:47], v[64:67], v[16:19]
    s_waitcnt vmcnt(3)
    v_mfma_f32_16x16x32_bf16 v[20:23], v[48:51], v[64:67], 0
    s_waitcnt vmcnt(2)
    v_mfma_f32_16x16x32_bf16 v[20:23], v[52:55], v[64:67], v[20:23]
    s_waitcnt vmcnt(1)
    v_mfma_f32_16x16x32_bf16 v[20:23], v[56:59], v[64:67], v[20:23]
    s_waitcnt vmcnt(0)
    v_mfma_f32_16x16x32_bf16 v[20:23], v[60:63], v[64:67], v[20:23]
    v_pk_add_f32 v[8:9], v[8:9], v[10:11]
    v_cvt_pk_bf16_f32 v8, v8, v9
    ds_write_b16 v12, v8 offset:0
    ds_write_b16_d16_hi v12, v8 offset:16
    v_pk_add_f32 v[16:17], v[16:17], v[18:19]
    v_cvt_pk_bf16_f32 v16, v16, v17
    ds_write_b16 v12, v16 offset:128
    ds_write_b16_d16_hi v12, v16 offset:144
    v_pk_add_f32 v[20:21], v[20:21], v[22:23]
    v_cvt_pk_bf16_f32 v20, v20, v21
    ds_write_b16 v12, v20 offset:256
    ds_write_b16_d16_hi v12, v20 offset:272
    s_waitcnt lgkmcnt(0)
    v_lshlrev_b32 v12, 4, v1
    s_mul_i32 s50, s22, 384
    s_add_u32 s50, s50, 86016
    v_add_u32 v13, s50, v12
    ds_read_b128 v[16:19], v13
    v_mov_b32 v14, 0x7fff0000
    v_cmp_gt_u32 vcc, 24, v1
    s_nop 1
    v_cndmask_b32 v12, v14, v12, vcc
    s_lshl_b32 s75, s43, 5
    s_add_u32 s75, s75, s61
    s_mul_i32 s75, s75, 1152
    s_lshl_b32 s50, s62, 7
    s_add_u32 s75, s75, s50
    s_waitcnt lgkmcnt(0)
    buffer_store_dwordx4 v[16:19], v12, s[4:7], s75 offen
    s_add_u32 s43, s43, 3
    s_add_u32 s44, s44, 1
    s_cmp_lt_u32 s43, 64
    s_cbranch_scc1 mlp_loop
mlp_timeout:
    s_waitcnt vmcnt(0)
    s_branch L_exit
L_small:
    s_lshl_b32 s84, s82, 3
    s_add_u32 s84, s84, s79
    s_sub_u32 s84, s84, 24
    s_cmp_ge_u32 s84, 20
    s_cbranch_scc1 L_idle
    s_mul_hi_u32 s85, s84, 0x33333334
    s_mul_i32 s86, s85, 5
    s_sub_u32 s84, s84, s86
    s_and_b32 s86, s85, 1
    s_mul_i32 s81, s86, 5
    s_add_u32 s81, s81, s84
    s_lshl_b32 s81, s81, 7
    s_cmp_ge_u32 s85, 2
    s_cbranch_scc1 L_w2
    s_load_dwordx2 s[12:13], s[0:1], 64
    s_waitcnt lgkmcnt(0)
    s_and_b32 s13, s13, 0xffff
    s_mov_b32 s14, 663552
    s_mov_b32 s15, 0x20000
    s_add_u32 s81, s81, 73437184
    v_mov_b32 v1, 0
    v_mov_b32 v2, 0
    buffer_store_dword v1, v2, s[8:11], s81 offen sc1
    s_waitcnt vmcnt(0)
    s_barrier
    v_cmp_eq_u32 vcc, 0, v0
    s_and_saveexec_b64 s[20:21], vcc
    s_cbranch_execz w1_arr
    v_mov_b32 v1, 1
    v_mov_b32 v2, 192
    buffer_atomic_add v1, v2, s[16:19], 0 offen
w1_arr:
    s_mov_b64 exec, s[20:21]
    s_lshl_b32 s23, s84, 8
    v_and_b32 v1, 63, v0
    v_lshrrev_b32 v2, 6, v0
    s_nop 0
    v_readfirstlane_b32 s22, v2
    v_lshrrev_b32 v3, 4, v1
    v_and_b32 v4, 15, v1
    v_lshl_add_u32 v5, v2, 2, v3
    v_mul_u32_u24 v5, 1152, v5
    v_lshlrev_b32 v6, 2, v3
    v_xor_b32 v6, v4, v6
    v_lshl_add_u32 v5, v6, 4, v5
    v_add_u32 v5, s23, v5
    v_lshrrev_b32 v6, 1, v3
    v_and_b32 v7, 1, v3
    v_lshrrev_b32 v8, 2, v4
    v_and_b32 v9, 3, v1
    v_lshl_add_u32 v10, v6, 3, v8
    v_lshlrev_b32 v10, 8, v10
    v_lshlrev_b32 v11, 2, v2
    v_lshl_add_u32 v11, v7, 1, v11
    v_lshrrev_b32 v12, 1, v9
    v_add_u32 v11, v11, v12
    v_lshlrev_b32 v12, 2, v8
    v_xor_b32 v11, v11, v12
    v_lshl_add_u32 v10, v11, 4, v10
    v_and_b32 v12, 1, v9
    v_lshl_add_u32 v10, v12, 3, v10
    v_add_u32 v10, 73728, v10
    s_lshl_b32 s24, s22, 10
    s_add_u32 m0, s24, 73728
    s_mov_b32 s25, 0
    buffer_load_dwordx4 v5, s[12:15], s25 offen lds
    s_add_u32 m0, s24, 77824
    s_mov_b32 s25, 18432
    buffer_load_dwordx4 v5, s[12:15], s25 offen lds
    s_add_u32 m0, s24, 81920
    s_mov_b32 s25, 36864
    buffer_load_dwordx4 v5, s[12:15], s25 offen lds
    s_add_u32 m0, s24, 86016
    s_mov_b32 s25, 55296
    buffer_load_dwordx4 v5, s[12:15], s25 offen lds
    s_add_u32 m0, s24, 90112
    s_mov_b32 s25, 73728
    buffer_load_dwordx4 v5, s[12:15], s25 offen lds
    s_add_u32 m0, s24, 94208
    s_mov_b32 s25, 92160
    buffer_load_dwordx4 v5, s[12:15], s25 offen lds
    s_add_u32 m0, s24, 98304
    s_mov_b32 s25, 110592
    buffer_load_dwordx4 v5, s[12:15], s25 offen lds
    s_add_u32 m0, s24, 102400
    s_mov_b32 s25, 129024
    buffer_load_dwordx4 v5, s[12:15], s25 offen lds
    s_add_u32 m0, s24, 106496
    s_mov_b32 s25, 147456
    buffer_load_dwordx4 v5, s[12:15], s25 offen lds
    s_add_u32 m0, s24, 110592
    s_mov_b32 s25, 165888
    buffer_load_dwordx4 v5, s[12:15], s25 offen lds
    s_add_u32 m0, s24, 114688
    s_mov_b32 s25, 184320
    buffer_load_dwordx4 v5, s[12:15], s25 offen lds
    s_add_u32 m0, s24, 118784
    s_mov_b32 s25, 202752
    buffer_load_dwordx4 v5, s[12:15], s25 offen lds
    s_waitcnt vmcnt(8)
    s_barrier
    s_add_u32 m0, s24, 122880
    s_mov_b32 s25, 221184
    buffer_load_dwordx4 v5, s[12:15], s25 offen lds
    s_add_u32 m0, s24, 126976
    s_mov_b32 s25, 239616
    buffer_load_dwordx4 v5, s[12:15], s25 offen lds
    s_add_u32 m0, s24, 131072
    s_mov_b32 s25, 258048
    buffer_load_dwordx4 v5, s[12:15], s25 offen lds
    s_add_u32 m0, s24, 135168
    s_mov_b32 s25, 276480
    buffer_load_dwordx4 v5, s[12:15], s25 offen lds
    ds_read_b64_tr_b16 a[0:1], v10 offset:0
    ds_read_b64_tr_b16 a[2:3], v10 offset:1024
    ds_read_b64_tr_b16 a[4:5], v10 offset:4096
    ds_read_b64_tr_b16 a[6:7], v10 offset:5120
    ds_read_b64_tr_b16 a[8:9], v10 offset:8192
    ds_read_b64_tr_b16 a[10:11], v10 offset:9216
    ds_read_b64_tr_b16 a[12:13], v10 offset:12288
    ds_read_b64_tr_b16 a[14:15], v10 offset:13312
    s_waitcnt lgkmcnt(0)
    s_waitcnt vmcnt(8)
    s_barrier
    s_add_u32 m0, s24, 73728
    s_mov_b32 s25, 294912
    buffer_load_dwordx4 v5, s[12:15], s25 offen lds
    s_add_u32 m0, s24, 77824
    s_mov_b32 s25, 313344
    buffer_load_dwordx4 v5, s[12:15], s25 offen lds
    s_add_u32 m0, s24, 81920
    s_mov_b32 s25, 331776
    buffer_load_dwordx4 v5, s[12:15], s25 offen lds
    s_add_u32 m0, s24, 86016
    s_mov_b32 s25, 350208
    buffer_load_dwordx4 v5, s[12:15], s25 offen lds
    ds_read_b64_tr_b16 a[16:17], v10 offset:16384
    ds_read_b64_tr_b16 a[18:19], v10 offset:17408
    ds_read_b64_tr_b16 a[20:21], v10 offset:20480
    ds_read_b64_tr_b16 a[22:23], v10 offset:21504
    ds_read_b64_tr_b16 a[24:25], v10 offset:24576
    ds_read_b64_tr_b16 a[26:27], v10 offset:25600
    ds_read_b64_tr_b16 a[28:29], v10 offset:28672
    ds_read_b64_tr_b16 a[30:31], v10 offset:29696
    s_waitcnt lgkmcnt(0)
    s_waitcnt vmcnt(8)
    s_barrier
    s_add_u32 m0, s24, 90112
    s_mov_b32 s25, 368640
    buffer_load_dwordx4 v5, s[12:15], s25 offen lds
    s_add_u32 m0, s24, 94208
    s_mov_b32 s25, 387072
    buffer_load_dwordx4 v5, s[12:15], s25 offen lds
    s_add_u32 m0, s24, 98304
    s_mov_b32 s25, 405504
    buffer_load_dwordx4 v5, s[12:15], s25 offen lds
    s_add_u32 m0, s24, 102400
    s_mov_b32 s25, 423936
    buffer_load_dwordx4 v5, s[12:15], s25 offen lds
    ds_read_b64_tr_b16 a[32:33], v10 offset:32768
    ds_read_b64_tr_b16 a[34:35], v10 offset:33792
    ds_read_b64_tr_b16 a[36:37], v10 offset:36864
    ds_read_b64_tr_b16 a[38:39], v10 offset:37888
    ds_read_b64_tr_b16 a[40:41], v10 offset:40960
    ds_read_b64_tr_b16 a[42:43], v10 offset:41984
    ds_read_b64_tr_b16 a[44:45], v10 offset:45056
    ds_read_b64_tr_b16 a[46:47], v10 offset:46080
    s_waitcnt lgkmcnt(0)
    s_waitcnt vmcnt(8)
    s_barrier
    s_add_u32 m0, s24, 106496
    s_mov_b32 s25, 442368
    buffer_load_dwordx4 v5, s[12:15], s25 offen lds
    s_add_u32 m0, s24, 110592
    s_mov_b32 s25, 460800
    buffer_load_dwordx4 v5, s[12:15], s25 offen lds
    s_add_u32 m0, s24, 114688
    s_mov_b32 s25, 479232
    buffer_load_dwordx4 v5, s[12:15], s25 offen lds
    s_add_u32 m0, s24, 118784
    s_mov_b32 s25, 497664
    buffer_load_dwordx4 v5, s[12:15], s25 offen lds
    ds_read_b64_tr_b16 a[48:49], v10 offset:49152
    ds_read_b64_tr_b16 a[50:51], v10 offset:50176
    ds_read_b64_tr_b16 a[52:53], v10 offset:53248
    ds_read_b64_tr_b16 a[54:55], v10 offset:54272
    ds_read_b64_tr_b16 a[56:57], v10 offset:57344
    ds_read_b64_tr_b16 a[58:59], v10 offset:58368
    ds_read_b64_tr_b16 a[60:61], v10 offset:61440
    ds_read_b64_tr_b16 a[62:63], v10 offset:62464
    s_waitcnt lgkmcnt(0)
    s_waitcnt vmcnt(8)
    s_barrier
    s_add_u32 m0, s24, 122880
    s_mov_b32 s25, 516096
    buffer_load_dwordx4 v5, s[12:15], s25 offen lds
    s_add_u32 m0, s24, 126976
    s_mov_b32 s25, 534528
    buffer_load_dwordx4 v5, s[12:15], s25 offen lds
    s_add_u32 m0, s24, 131072
    s_mov_b32 s25, 552960
    buffer_load_dwordx4 v5, s[12:15], s25 offen lds
    s_add_u32 m0, s24, 135168
    s_mov_b32 s25, 571392
    buffer_load_dwordx4 v5, s[12:15], s25 offen lds
    ds_read_b64_tr_b16 a[64:65], v10 offset:0
    ds_read_b64_tr_b16 a[66:67], v10 offset:1024
    ds_read_b64_tr_b16 a[68:69], v10 offset:4096
    ds_read_b64_tr_b16 a[70:71], v10 offset:5120
    ds_read_b64_tr_b16 a[72:73], v10 offset:8192
    ds_read_b64_tr_b16 a[74:75], v10 offset:9216
    ds_read_b64_tr_b16 a[76:77], v10 offset:12288
    ds_read_b64_tr_b16 a[78:79], v10 offset:13312
    s_waitcnt lgkmcnt(0)
    s_waitcnt vmcnt(8)
    s_barrier
    s_add_u32 m0, s24, 73728
    s_mov_b32 s25, 589824
    buffer_load_dwordx4 v5, s[12:15], s25 offen lds
    s_add_u32 m0, s24, 77824
    s_mov_b32 s25, 608256
    buffer_load_dwordx4 v5, s[12:15], s25 offen lds
    s_add_u32 m0, s24, 81920
    s_mov_b32 s25, 626688
    buffer_load_dwordx4 v5, s[12:15], s25 offen lds
    s_add_u32 m0, s24, 86016
    s_mov_b32 s25, 645120
    buffer_load_dwordx4 v5, s[12:15], s25 offen lds
    ds_read_b64_tr_b16 a[80:81], v10 offset:16384
    ds_read_b64_tr_b16 a[82:83], v10 offset:17408
    ds_read_b64_tr_b16 a[84:85], v10 offset:20480
    ds_read_b64_tr_b16 a[86:87], v10 offset:21504
    ds_read_b64_tr_b16 a[88:89], v10 offset:24576
    ds_read_b64_tr_b16 a[90:91], v10 offset:25600
    ds_read_b64_tr_b16 a[92:93], v10 offset:28672
    ds_read_b64_tr_b16 a[94:95], v10 offset:29696
    s_waitcnt lgkmcnt(0)
    s_waitcnt vmcnt(8)
    s_barrier
    ds_read_b64_tr_b16 a[96:97], v10 offset:32768
    ds_read_b64_tr_b16 a[98:99], v10 offset:33792
    ds_read_b64_tr_b16 a[100:101], v10 offset:36864
    ds_read_b64_tr_b16 a[102:103], v10 offset:37888
    ds_read_b64_tr_b16 a[104:105], v10 offset:40960
    ds_read_b64_tr_b16 a[106:107], v10 offset:41984
    ds_read_b64_tr_b16 a[108:109], v10 offset:45056
    ds_read_b64_tr_b16 a[110:111], v10 offset:46080
    s_waitcnt lgkmcnt(0)
    s_waitcnt vmcnt(4)
    s_barrier
    ds_read_b64_tr_b16 a[112:113], v10 offset:49152
    ds_read_b64_tr_b16 a[114:115], v10 offset:50176
    ds_read_b64_tr_b16 a[116:117], v10 offset:53248
    ds_read_b64_tr_b16 a[118:119], v10 offset:54272
    ds_read_b64_tr_b16 a[120:121], v10 offset:57344
    ds_read_b64_tr_b16 a[122:123], v10 offset:58368
    ds_read_b64_tr_b16 a[124:125], v10 offset:61440
    ds_read_b64_tr_b16 a[126:127], v10 offset:62464
    s_waitcnt lgkmcnt(0)
    s_waitcnt vmcnt(0)
    s_barrier
    ds_read_b64_tr_b16 a[128:129], v10 offset:0
    ds_read_b64_tr_b16 a[130:131], v10 offset:1024
    ds_read_b64_tr_b16 a[132:133], v10 offset:4096
    ds_read_b64_tr_b16 a[134:135], v10 offset:5120
    ds_read_b64_tr_b16 a[136:137], v10 offset:8192
    ds_read_b64_tr_b16 a[138:139], v10 offset:9216
    ds_read_b64_tr_b16 a[140:141], v10 offset:12288
    ds_read_b64_tr_b16 a[142:143], v10 offset:13312
    s_waitcnt lgkmcnt(0)
    v_lshlrev_b32 v12, 4, v1
    v_mul_u32_u24 v13, 9216, v2
    v_add_u32 v13, v13, v12
    s_mul_i32 s26, s22, 9216
    s_mov_b32 s30, s86
    v_and_b32 v15, 31, v1
    v_lshlrev_b32 v15, 5, v15
    v_lshrrev_b32 v6, 5, v1
    v_lshl_add_u32 v15, v6, 4, v15
    s_lshl_b32 s27, s84, 3
    s_lshl_b32 s28, s22, 1
    s_add_u32 s27, s27, s28
    s_lshl_b32 s27, s27, 16
    s_add_u32 s27, s27, 118489088
    s_mul_i32 s31, s86, 5
    s_add_u32 s31, s31, s84
    s_lshl_b32 s31, s31, 7
    s_add_u32 s31, s31, 73437184
    s_mov_b32 s40, 0xbdd2d3e8
    v_mov_b32 v62, 0xc0135761
    s_lshl_b32 s28, s84, 2
    s_add_u32 s28, s28, s22
    v_mov_b32 v6, 0x7fff0000
    s_cmp_ge_u32 s28, 18
    s_cbranch_scc0 w1_colok
    v_mov_b32 v15, v6
w1_colok:
    v_mov_b32 v57, 192
    s_mov_b32 s90, 0
w1_wa:
    buffer_load_dword v56, v57, s[16:19], 0 offen sc1
    s_add_u32 s90, s90, 1
    s_cmp_gt_u32 s90, 65536
    s_cbranch_scc1 L_exit
    s_waitcnt vmcnt(0)
    v_readfirstlane_b32 s91, v56
    s_cmp_ge_u32 s91, 256
    s_cbranch_scc1 w1_wa_ok
    s_sleep 4
    s_branch w1_wa
w1_wa_ok:
w1_loop:
    s_mul_hi_u32 s39, s30, 0x55555556
    s_mul_i32 s39, s39, 3
    s_sub_u32 s39, s30, s39
    s_lshl_b32 s39, s39, 12
    s_add_u32 s39, s39, 73424896
    s_add_u32 s91, s30, 1
    v_and_b32 v250, 63, v0
    v_min_u32 v250, 31, v250
    v_mul_u32_u24 v250, 128, v250
    s_mov_b32 s90, 0
w1_pl_h:
    buffer_load_dword v251, v250, s[8:11], s39 offen sc1
    s_add_u32 s90, s90, 1
    s_cmp_gt_u32 s90, 65536
    s_cbranch_scc1 w1_timeout
    s_waitcnt vmcnt(0)
    v_cmp_gt_u32 vcc, s91, v251
    s_cbranch_vccz w1_pl_ok_h
    s_sleep 2
    s_branch w1_pl_h
w1_pl_ok_h:
    s_mul_i32 s29, s30, 36864
    s_add_u32 s29, s29, 115343360
    s_add_u32 m0, s26, 0
    s_add_u32 s32, s29, 0
    buffer_load_dwordx4 v13, s[8:11], s32 offen offset:0 sc1 lds
    buffer_load_dwordx4 v13, s[8:11], s32 offen offset:1024 sc1 lds
    buffer_load_dwordx4 v13, s[8:11], s32 offen offset:2048 sc1 lds
    buffer_load_dwordx4 v13, s[8:11], s32 offen offset:3072 sc1 lds
    s_add_u32 m0, s26, 4096
    s_add_u32 s32, s29, 4096
    buffer_load_dwordx4 v13, s[8:11], s32 offen offset:0 sc1 lds
    buffer_load_dwordx4 v13, s[8:11], s32 offen offset:1024 sc1 lds
    buffer_load_dwordx4 v13, s[8:11], s32 offen offset:2048 sc1 lds
    buffer_load_dwordx4 v13, s[8:11], s32 offen offset:3072 sc1 lds
    s_add_u32 m0, s26, 8192
    s_add_u32 s32, s29, 8192
    buffer_load_dwordx4 v13, s[8:11], s32 offen offset:0 sc1 lds
    s_waitcnt vmcnt(0)
    s_barrier
    ds_read_b128 v[16:19], v12 offset:0
    ds_read_b128 v[20:23], v12 offset:1024
    ds_read_b128 v[24:27], v12 offset:2048
    ds_read_b128 v[28:31], v12 offset:3072
    s_waitcnt lgkmcnt(3)
    v_mfma_f32_32x32x16_bf16 v[32:47], a[0:3], v[16:19], 0
    ds_read_b128 v[16:19], v12 offset:4096
    s_waitcnt lgkmcnt(3)
    v_mfma_f32_32x32x16_bf16 v[32:47], a[4:7], v[20:23], v[32:47]
    ds_read_b128 v[20:23], v12 offset:5120
    s_waitcnt lgkmcnt(3)
    v_mfma_f32_32x32x16_bf16 v[32:47], a[8:11], v[24:27], v[32:47]
    ds_read_b128 v[24:27], v12 offset:6144
    s_waitcnt lgkmcnt(3)
    v_mfma_f32_32x32x16_bf16 v[32:47], a[12:15], v[28:31], v[32:47]
    ds_read_b128 v[28:31], v12 offset:7168
    s_waitcnt lgkmcnt(3)
    v_mfma_f32_32x32x16_bf16 v[32:47], a[16:19], v[16:19], v[32:47]
    ds_read_b128 v[16:19], v12 offset:8192
    s_waitcnt lgkmcnt(3)
    v_mfma_f32_32x32x16_bf16 v[32:47], a[20:23], v[20:23], v[32:47]
    ds_read_b128 v[20:23], v12 offset:9216
    s_waitcnt lgkmcnt(3)
    v_mfma_f32_32x32x16_bf16 v[32:47], a[24:27], v[24:27], v[32:47]
    ds_read_b128 v[24:27], v12 offset:10240
    s_waitcnt lgkmcnt(3)
    v_mfma_f32_32x32x16_bf16 v[32:47], a[28:31], v[28:31], v[32:47]
    ds_read_b128 v[28:31], v12 offset:11264
    s_waitcnt lgkmcnt(3)
    v_mfma_f32_32x32x16_bf16 v[32:47], a[32:35], v[16:19], v[32:47]
    ds_read_b128 v[16:19], v12 offset:12288
    s_waitcnt lgkmcnt(3)
    v_mfma_f32_32x32x16_bf16 v[32:47], a[36:39], v[20:23], v[32:47]
    ds_read_b128 v[20:23], v12 offset:13312
    s_waitcnt lgkmcnt(3)
    v_mfma_f32_32x32x16_bf16 v[32:47], a[40:43], v[24:27], v[32:47]
    ds_read_b128 v[24:27], v12 offset:14336
    s_waitcnt lgkmcnt(3)
    v_mfma_f32_32x32x16_bf16 v[32:47], a[44:47], v[28:31], v[32:47]
    ds_read_b128 v[28:31], v12 offset:15360
    s_waitcnt lgkmcnt(3)
    v_mfma_f32_32x32x16_bf16 v[32:47], a[48:51], v[16:19], v[32:47]
    ds_read_b128 v[16:19], v12 offset:16384
    s_waitcnt lgkmcnt(3)
    v_mfma_f32_32x32x16_bf16 v[32:47], a[52:55], v[20:23], v[32:47]
    ds_read_b128 v[20:23], v12 offset:17408
    s_waitcnt lgkmcnt(3)
    v_mfma_f32_32x32x16_bf16 v[32:47], a[56:59], v[24:27], v[32:47]
    ds_read_b128 v[24:27], v12 offset:18432
    s_waitcnt lgkmcnt(3)
    v_mfma_f32_32x32x16_bf16 v[32:47], a[60:63], v[28:31], v[32:47]
    ds_read_b128 v[28:31], v12 offset:19456
    s_waitcnt lgkmcnt(3)
    v_mfma_f32_32x32x16_bf16 v[32:47], a[64:67], v[16:19], v[32:47]
    ds_read_b128 v[16:19], v12 offset:20480
    s_waitcnt lgkmcnt(3)
    v_mfma_f32_32x32x16_bf16 v[32:47], a[68:71], v[20:23], v[32:47]
    ds_read_b128 v[20:23], v12 offset:21504
    s_waitcnt lgkmcnt(3)
    v_mfma_f32_32x32x16_bf16 v[32:47], a[72:75], v[24:27], v[32:47]
    ds_read_b128 v[24:27], v12 offset:22528
    s_waitcnt lgkmcnt(3)
    v_mfma_f32_32x32x16_bf16 v[32:47], a[76:79], v[28:31], v[32:47]
    ds_read_b128 v[28:31], v12 offset:23552
    s_waitcnt lgkmcnt(3)
    v_mfma_f32_32x32x16_bf16 v[32:47], a[80:83], v[16:19], v[32:47]
    ds_read_b128 v[16:19], v12 offset:24576
    s_waitcnt lgkmcnt(3)
    v_mfma_f32_32x32x16_bf16 v[32:47], a[84:87], v[20:23], v[32:47]
    ds_read_b128 v[20:23], v12 offset:25600
    s_waitcnt lgkmcnt(3)
    v_mfma_f32_32x32x16_bf16 v[32:47], a[88:91], v[24:27], v[32:47]
    ds_read_b128 v[24:27], v12 offset:26624
    s_waitcnt lgkmcnt(3)
    v_mfma_f32_32x32x16_bf16 v[32:47], a[92:95], v[28:31], v[32:47]
    ds_read_b128 v[28:31], v12 offset:27648
    s_waitcnt lgkmcnt(3)
    v_mfma_f32_32x32x16_bf16 v[32:47], a[96:99], v[16:19], v[32:47]
    ds_read_b128 v[16:19], v12 offset:28672
    s_waitcnt lgkmcnt(3)
    v_mfma_f32_32x32x16_bf16 v[32:47], a[100:103], v[20:23], v[32:47]
    ds_read_b128 v[20:23], v12 offset:29696
    s_waitcnt lgkmcnt(3)
    v_mfma_f32_32x32x16_bf16 v[32:47], a[104:107], v[24:27], v[32:47]
    ds_read_b128 v[24:27], v12 offset:30720
    s_waitcnt lgkmcnt(3)
    v_mfma_f32_32x32x16_bf16 v[32:47], a[108:111], v[28:31], v[32:47]
    ds_read_b128 v[28:31], v12 offset:31744
    s_waitcnt lgkmcnt(3)
    v_mfma_f32_32x32x16_bf16 v[32:47], a[112:115], v[16:19], v[32:47]
    ds_read_b128 v[16:19], v12 offset:32768
    s_waitcnt lgkmcnt(3)
    v_mfma_f32_32x32x16_bf16 v[32:47], a[116:119], v[20:23], v[32:47]
    ds_read_b128 v[20:23], v12 offset:33792
    s_waitcnt lgkmcnt(3)
    v_mfma_f32_32x32x16_bf16 v[32:47], a[120:123], v[24:27], v[32:47]
    ds_read_b128 v[24:27], v12 offset:34816
    s_waitcnt lgkmcnt(3)
    v_mfma_f32_32x32x16_bf16 v[32:47], a[124:127], v[28:31], v[32:47]
    ds_read_b128 v[28:31], v12 offset:35840
    s_waitcnt lgkmcnt(3)
    v_mfma_f32_32x32x16_bf16 v[32:47], a[128:131], v[16:19], v[32:47]
    s_waitcnt lgkmcnt(2)
    v_mfma_f32_32x32x16_bf16 v[32:47], a[132:135], v[20:23], v[32:47]
    s_waitcnt lgkmcnt(1)
    v_mfma_f32_32x32x16_bf16 v[32:47], a[136:139], v[24:27], v[32:47]
    s_waitcnt lgkmcnt(0)
    v_mfma_f32_32x32x16_bf16 v[32:47], a[140:143], v[28:31], v[32:47]
    s_nop 11
    v_mul_f32 v64, v32, v32
    v_mul_f32 v65, v33, v33
    v_mul_f32 v66, v34, v34
    v_mul_f32 v67, v35, v35
    v_mul_f32 v68, v36, v36
    v_mul_f32 v69, v37, v37
    v_mul_f32 v70, v38, v38
    v_mul_f32 v71, v39, v39
    v_mul_f32 v72, v40, v40
    v_mul_f32 v73, v41, v41
    v_mul_f32 v74, v42, v42
    v_mul_f32 v75, v43, v43
    v_mul_f32 v76, v44, v44
    v_mul_f32 v77, v45, v45
    v_mul_f32 v78, v46, v46
    v_mul_f32 v79, v47, v47
    v_fma_f32 v64, v64, s40, v62
    v_fma_f32 v65, v65, s40, v62
    v_fma_f32 v66, v66, s40, v62
    v_fma_f32 v67, v67, s40, v62
    v_fma_f32 v68, v68, s40, v62
    v_fma_f32 v69, v69, s40, v62
    v_fma_f32 v70, v70, s40, v62
    v_fma_f32 v71, v71, s40, v62
    v_fma_f32 v72, v72, s40, v62
    v_fma_f32 v73, v73, s40, v62
    v_fma_f32 v74, v74, s40, v62
    v_fma_f32 v75, v75, s40, v62
    v_fma_f32 v76, v76, s40, v62
    v_fma_f32 v77, v77, s40, v62
    v_fma_f32 v78, v78, s40, v62
    v_fma_f32 v79, v79, s40, v62
    v_mul_f32 v64, v64, v32
    v_mul_f32 v65, v65, v33
    v_mul_f32 v66, v66, v34
    v_mul_f32 v67, v67, v35
    v_mul_f32 v68, v68, v36
    v_mul_f32 v69, v69, v37
    v_mul_f32 v70, v70, v38
    v_mul_f32 v71, v71, v39
    v_mul_f32 v72, v72, v40
    v_mul_f32 v73, v73, v41
    v_mul_f32 v74, v74, v42
    v_mul_f32 v75, v75, v43
    v_mul_f32 v76, v76, v44
    v_mul_f32 v77, v77, v45
    v_mul_f32 v78, v78, v46
    v_mul_f32 v79, v79, v47
    v_exp_f32 v64, v64
    v_exp_f32 v65, v65
    v_exp_f32 v66, v66
    v_exp_f32 v67, v67
    v_exp_f32 v68, v68
    v_exp_f32 v69, v69
    v_exp_f32 v70, v70
    v_exp_f32 v71, v71
    v_exp_f32 v72, v72
    v_exp_f32 v73, v73
    v_exp_f32 v74, v74
    v_exp_f32 v75, v75
    v_exp_f32 v76, v76
    v_exp_f32 v77, v77
    v_exp_f32 v78, v78
    v_exp_f32 v79, v79
    v_add_f32 v64, 1.0, v64
    v_add_f32 v65, 1.0, v65
    v_add_f32 v66, 1.0, v66
    v_add_f32 v67, 1.0, v67
    v_add_f32 v68, 1.0, v68
    v_add_f32 v69, 1.0, v69
    v_add_f32 v70, 1.0, v70
    v_add_f32 v71, 1.0, v71
    v_add_f32 v72, 1.0, v72
    v_add_f32 v73, 1.0, v73
    v_add_f32 v74, 1.0, v74
    v_add_f32 v75, 1.0, v75
    v_add_f32 v76, 1.0, v76
    v_add_f32 v77, 1.0, v77
    v_add_f32 v78, 1.0, v78
    v_add_f32 v79, 1.0, v79
    v_rcp_f32 v64, v64
    v_rcp_f32 v65, v65
    v_rcp_f32 v66, v66
    v_rcp_f32 v67, v67
    v_rcp_f32 v68, v68
    v_rcp_f32 v69, v69
    v_rcp_f32 v70, v70
    v_rcp_f32 v71, v71
    v_rcp_f32 v72, v72
    v_rcp_f32 v73, v73
    v_rcp_f32 v74, v74
    v_rcp_f32 v75, v75
    v_rcp_f32 v76, v76
    v_rcp_f32 v77, v77
    v_rcp_f32 v78, v78
    v_rcp_f32 v79, v79
    v_mul_f32 v32, v32, v64
    v_mul_f32 v33, v33, v65
    v_mul_f32 v34, v34, v66
    v_mul_f32 v35, v35, v67
    v_mul_f32 v36, v36, v68
    v_mul_f32 v37, v37, v69
    v_mul_f32 v38, v38, v70
    v_mul_f32 v39, v39, v71
    v_mul_f32 v40, v40, v72
    v_mul_f32 v41, v41, v73
    v_mul_f32 v42, v42, v74
    v_mul_f32 v43, v43, v75
    v_mul_f32 v44, v44, v76
    v_mul_f32 v45, v45, v77
    v_mul_f32 v46, v46, v78
    v_mul_f32 v47, v47, v79
    v_cvt_pk_bf16_f32 v48, v32, v33
    v_cvt_pk_bf16_f32 v49, v34, v35
    v_cvt_pk_bf16_f32 v50, v36, v37
    v_cvt_pk_bf16_f32 v51, v38, v39
    v_cvt_pk_bf16_f32 v52, v40, v41
    v_cvt_pk_bf16_f32 v53, v42, v43
    v_cvt_pk_bf16_f32 v54, v44, v45
    v_cvt_pk_bf16_f32 v55, v46, v47
    v_permlane32_swap_b32 v48, v50
    v_permlane32_swap_b32 v49, v51
    v_permlane32_swap_b32 v52, v54
    v_permlane32_swap_b32 v53, v55
    s_lshl_b32 s28, s30, 10
    s_add_u32 s28, s28, s27
    buffer_store_dwordx4 v[48:51], v15, s[8:11], s28 offen sc1
    s_add_u32 s28, s28, 65536
    buffer_store_dwordx4 v[52:55], v15, s[8:11], s28 offen sc1
    s_waitcnt vmcnt(0)
    s_barrier
    s_cmp_eq_u32 s22, 0
    s_cbranch_scc0 w1_nopub
    s_add_u32 s34, s30, 1
    v_mov_b32 v56, s34
    v_mov_b32 v57, 0
    s_mov_b64 exec, 1
    buffer_store_dword v56, v57, s[8:11], s31 offen sc1
    s_mov_b64 exec, -1
w1_nopub:
    s_add_u32 s30, s30, 2
    s_cmp_lt_u32 s30, 64
    s_cbranch_scc1 w1_loop
w1_timeout:
    s_branch L_exit
L_w2:
    s_load_dwordx2 s[12:13], s[0:1], 72
    s_waitcnt lgkmcnt(0)
    s_and_b32 s13, s13, 0xffff
    s_mov_b32 s14, 663552
    s_mov_b32 s15, 0x20000
    s_add_u32 s81, s81, 73438464
    v_mov_b32 v1, 0
    v_mov_b32 v2, 0
    buffer_store_dword v1, v2, s[8:11], s81 offen sc1
    s_waitcnt vmcnt(0)
    s_barrier
    v_cmp_eq_u32 vcc, 0, v0
    s_and_saveexec_b64 s[20:21], vcc
    s_cbranch_execz w2_arr
    v_mov_b32 v1, 1
    v_mov_b32 v2, 192
    buffer_atomic_add v1, v2, s[16:19], 0 offen
w2_arr:
    s_mov_b64 exec, s[20:21]
    s_lshl_b32 s23, s84, 8
    v_and_b32 v1, 63, v0
    v_lshrrev_b32 v2, 6, v0
    s_nop 0
    v_readfirstlane_b32 s22, v2
    v_lshrrev_b32 v3, 4, v1
    v_and_b32 v4, 15, v1
    v_lshl_add_u32 v5, v2, 2, v3
    v_mul_u32_u24 v5, 1152, v5
    v_lshlrev_b32 v6, 2, v3
    v_xor_b32 v6, v4, v6
    v_lshl_add_u32 v5, v6, 4, v5
    v_add_u32 v5, s23, v5
    v_lshrrev_b32 v6, 1, v3
    v_and_b32 v7, 1, v3
    v_lshrrev_b32 v8, 2, v4
    v_and_b32 v9, 3, v1
    v_lshl_add_u32 v10, v6, 3, v8
    v_lshlrev_b32 v10, 8, v10
    v_lshlrev_b32 v11, 2, v2
    v_lshl_add_u32 v11, v7, 1, v11
    v_lshrrev_b32 v12, 1, v9
    v_add_u32 v11, v11, v12
    v_lshlrev_b32 v12, 2, v8
    v_xor_b32 v11, v11, v12
    v_lshl_add_u32 v10, v11, 4, v10
    v_and_b32 v12, 1, v9
    v_lshl_add_u32 v10, v12, 3, v10
    v_add_u32 v10, 73728, v10
    s_lshl_b32 s24, s22, 10
    s_add_u32 m0, s24, 73728
    s_mov_b32 s25, 0
    buffer_load_dwordx4 v5, s[12:15], s25 offen lds
    s_add_u32 m0, s24, 77824
    s_mov_b32 s25, 18432
    buffer_load_dwordx4 v5, s[12:15], s25 offen lds
    s_add_u32 m0, s24, 81920
    s_mov_b32 s25, 36864
    buffer_load_dwordx4 v5, s[12:15], s25 offen lds
    s_add_u32 m0, s24, 86016
    s_mov_b32 s25, 55296
    buffer_load_dwordx4 v5, s[12:15], s25 offen lds
    s_add_u32 m0, s24, 90112
    s_mov_b32 s25, 73728
    buffer_load_dwordx4 v5, s[12:15], s25 offen lds
    s_add_u32 m0, s24, 94208
    s_mov_b32 s25, 92160
    buffer_load_dwordx4 v5, s[12:15], s25 offen lds
    s_add_u32 m0, s24, 98304
    s_mov_b32 s25, 110592
    buffer_load_dwordx4 v5, s[12:15], s25 offen lds
    s_add_u32 m0, s24, 102400
    s_mov_b32 s25, 129024
    buffer_load_dwordx4 v5, s[12:15], s25 offen lds
    s_add_u32 m0, s24, 106496
    s_mov_b32 s25, 147456
    buffer_load_dwordx4 v5, s[12:15], s25 offen lds
    s_add_u32 m0, s24, 110592
    s_mov_b32 s25, 165888
    buffer_load_dwordx4 v5, s[12:15], s25 offen lds
    s_add_u32 m0, s24, 114688
    s_mov_b32 s25, 184320
    buffer_load_dwordx4 v5, s[12:15], s25 offen lds
    s_add_u32 m0, s24, 118784
    s_mov_b32 s25, 202752
    buffer_load_dwordx4 v5, s[12:15], s25 offen lds
    s_waitcnt vmcnt(8)
    s_barrier
    s_add_u32 m0, s24, 122880
    s_mov_b32 s25, 221184
    buffer_load_dwordx4 v5, s[12:15], s25 offen lds
    s_add_u32 m0, s24, 126976
    s_mov_b32 s25, 239616
    buffer_load_dwordx4 v5, s[12:15], s25 offen lds
    s_add_u32 m0, s24, 131072
    s_mov_b32 s25, 258048
    buffer_load_dwordx4 v5, s[12:15], s25 offen lds
    s_add_u32 m0, s24, 135168
    s_mov_b32 s25, 276480
    buffer_load_dwordx4 v5, s[12:15], s25 offen lds
    ds_read_b64_tr_b16 a[0:1], v10 offset:0
    ds_read_b64_tr_b16 a[2:3], v10 offset:1024
    ds_read_b64_tr_b16 a[4:5], v10 offset:4096
    ds_read_b64_tr_b16 a[6:7], v10 offset:5120
    ds_read_b64_tr_b16 a[8:9], v10 offset:8192
    ds_read_b64_tr_b16 a[10:11], v10 offset:9216
    ds_read_b64_tr_b16 a[12:13], v10 offset:12288
    ds_read_b64_tr_b16 a[14:15], v10 offset:13312
    s_waitcnt lgkmcnt(0)
    s_waitcnt vmcnt(8)
    s_barrier
    s_add_u32 m0, s24, 73728
    s_mov_b32 s25, 294912
    buffer_load_dwordx4 v5, s[12:15], s25 offen lds
    s_add_u32 m0, s24, 77824
    s_mov_b32 s25, 313344
    buffer_load_dwordx4 v5, s[12:15], s25 offen lds
    s_add_u32 m0, s24, 81920
    s_mov_b32 s25, 331776
    buffer_load_dwordx4 v5, s[12:15], s25 offen lds
    s_add_u32 m0, s24, 86016
    s_mov_b32 s25, 350208
    buffer_load_dwordx4 v5, s[12:15], s25 offen lds
    ds_read_b64_tr_b16 a[16:17], v10 offset:16384
    ds_read_b64_tr_b16 a[18:19], v10 offset:17408
    ds_read_b64_tr_b16 a[20:21], v10 offset:20480
    ds_read_b64_tr_b16 a[22:23], v10 offset:21504
    ds_read_b64_tr_b16 a[24:25], v10 offset:24576
    ds_read_b64_tr_b16 a[26:27], v10 offset:25600
    ds_read_b64_tr_b16 a[28:29], v10 offset:28672
    ds_read_b64_tr_b16 a[30:31], v10 offset:29696
    s_waitcnt lgkmcnt(0)
    s_waitcnt vmcnt(8)
    s_barrier
    s_add_u32 m0, s24, 90112
    s_mov_b32 s25, 368640
    buffer_load_dwordx4 v5, s[12:15], s25 offen lds
    s_add_u32 m0, s24, 94208
    s_mov_b32 s25, 387072
    buffer_load_dwordx4 v5, s[12:15], s25 offen lds
    s_add_u32 m0, s24, 98304
    s_mov_b32 s25, 405504
    buffer_load_dwordx4 v5, s[12:15], s25 offen lds
    s_add_u32 m0, s24, 102400
    s_mov_b32 s25, 423936
    buffer_load_dwordx4 v5, s[12:15], s25 offen lds
    ds_read_b64_tr_b16 a[32:33], v10 offset:32768
    ds_read_b64_tr_b16 a[34:35], v10 offset:33792
    ds_read_b64_tr_b16 a[36:37], v10 offset:36864
    ds_read_b64_tr_b16 a[38:39], v10 offset:37888
    ds_read_b64_tr_b16 a[40:41], v10 offset:40960
    ds_read_b64_tr_b16 a[42:43], v10 offset:41984
    ds_read_b64_tr_b16 a[44:45], v10 offset:45056
    ds_read_b64_tr_b16 a[46:47], v10 offset:46080
    s_waitcnt lgkmcnt(0)
    s_waitcnt vmcnt(8)
    s_barrier
    s_add_u32 m0, s24, 106496
    s_mov_b32 s25, 442368
    buffer_load_dwordx4 v5, s[12:15], s25 offen lds
    s_add_u32 m0, s24, 110592
    s_mov_b32 s25, 460800
    buffer_load_dwordx4 v5, s[12:15], s25 offen lds
    s_add_u32 m0, s24, 114688
    s_mov_b32 s25, 479232
    buffer_load_dwordx4 v5, s[12:15], s25 offen lds
    s_add_u32 m0, s24, 118784
    s_mov_b32 s25, 497664
    buffer_load_dwordx4 v5, s[12:15], s25 offen lds
    ds_read_b64_tr_b16 a[48:49], v10 offset:49152
    ds_read_b64_tr_b16 a[50:51], v10 offset:50176
    ds_read_b64_tr_b16 a[52:53], v10 offset:53248
    ds_read_b64_tr_b16 a[54:55], v10 offset:54272
    ds_read_b64_tr_b16 a[56:57], v10 offset:57344
    ds_read_b64_tr_b16 a[58:59], v10 offset:58368
    ds_read_b64_tr_b16 a[60:61], v10 offset:61440
    ds_read_b64_tr_b16 a[62:63], v10 offset:62464
    s_waitcnt lgkmcnt(0)
    s_waitcnt vmcnt(8)
    s_barrier
    s_add_u32 m0, s24, 122880
    s_mov_b32 s25, 516096
    buffer_load_dwordx4 v5, s[12:15], s25 offen lds
    s_add_u32 m0, s24, 126976
    s_mov_b32 s25, 534528
    buffer_load_dwordx4 v5, s[12:15], s25 offen lds
    s_add_u32 m0, s24, 131072
    s_mov_b32 s25, 552960
    buffer_load_dwordx4 v5, s[12:15], s25 offen lds
    s_add_u32 m0, s24, 135168
    s_mov_b32 s25, 571392
    buffer_load_dwordx4 v5, s[12:15], s25 offen lds
    ds_read_b64_tr_b16 a[64:65], v10 offset:0
    ds_read_b64_tr_b16 a[66:67], v10 offset:1024
    ds_read_b64_tr_b16 a[68:69], v10 offset:4096
    ds_read_b64_tr_b16 a[70:71], v10 offset:5120
    ds_read_b64_tr_b16 a[72:73], v10 offset:8192
    ds_read_b64_tr_b16 a[74:75], v10 offset:9216
    ds_read_b64_tr_b16 a[76:77], v10 offset:12288
    ds_read_b64_tr_b16 a[78:79], v10 offset:13312
    s_waitcnt lgkmcnt(0)
    s_waitcnt vmcnt(8)
    s_barrier
    s_add_u32 m0, s24, 73728
    s_mov_b32 s25, 589824
    buffer_load_dwordx4 v5, s[12:15], s25 offen lds
    s_add_u32 m0, s24, 77824
    s_mov_b32 s25, 608256
    buffer_load_dwordx4 v5, s[12:15], s25 offen lds
    s_add_u32 m0, s24, 81920
    s_mov_b32 s25, 626688
    buffer_load_dwordx4 v5, s[12:15], s25 offen lds
    s_add_u32 m0, s24, 86016
    s_mov_b32 s25, 645120
    buffer_load_dwordx4 v5, s[12:15], s25 offen lds
    ds_read_b64_tr_b16 a[80:81], v10 offset:16384
    ds_read_b64_tr_b16 a[82:83], v10 offset:17408
    ds_read_b64_tr_b16 a[84:85], v10 offset:20480
    ds_read_b64_tr_b16 a[86:87], v10 offset:21504
    ds_read_b64_tr_b16 a[88:89], v10 offset:24576
    ds_read_b64_tr_b16 a[90:91], v10 offset:25600
    ds_read_b64_tr_b16 a[92:93], v10 offset:28672
    ds_read_b64_tr_b16 a[94:95], v10 offset:29696
    s_waitcnt lgkmcnt(0)
    s_waitcnt vmcnt(8)
    s_barrier
    ds_read_b64_tr_b16 a[96:97], v10 offset:32768
    ds_read_b64_tr_b16 a[98:99], v10 offset:33792
    ds_read_b64_tr_b16 a[100:101], v10 offset:36864
    ds_read_b64_tr_b16 a[102:103], v10 offset:37888
    ds_read_b64_tr_b16 a[104:105], v10 offset:40960
    ds_read_b64_tr_b16 a[106:107], v10 offset:41984
    ds_read_b64_tr_b16 a[108:109], v10 offset:45056
    ds_read_b64_tr_b16 a[110:111], v10 offset:46080
    s_waitcnt lgkmcnt(0)
    s_waitcnt vmcnt(4)
    s_barrier
    ds_read_b64_tr_b16 a[112:113], v10 offset:49152
    ds_read_b64_tr_b16 a[114:115], v10 offset:50176
    ds_read_b64_tr_b16 a[116:117], v10 offset:53248
    ds_read_b64_tr_b16 a[118:119], v10 offset:54272
    ds_read_b64_tr_b16 a[120:121], v10 offset:57344
    ds_read_b64_tr_b16 a[122:123], v10 offset:58368
    ds_read_b64_tr_b16 a[124:125], v10 offset:61440
    ds_read_b64_tr_b16 a[126:127], v10 offset:62464
    s_waitcnt lgkmcnt(0)
    s_waitcnt vmcnt(0)
    s_barrier
    ds_read_b64_tr_b16 a[128:129], v10 offset:0
    ds_read_b64_tr_b16 a[130:131], v10 offset:1024
    ds_read_b64_tr_b16 a[132:133], v10 offset:4096
    ds_read_b64_tr_b16 a[134:135], v10 offset:5120
    ds_read_b64_tr_b16 a[136:137], v10 offset:8192
    ds_read_b64_tr_b16 a[138:139], v10 offset:9216
    ds_read_b64_tr_b16 a[140:141], v10 offset:12288
    ds_read_b64_tr_b16 a[142:143], v10 offset:13312
    s_waitcnt lgkmcnt(0)
    v_lshlrev_b32 v12, 4, v1
    v_mul_u32_u24 v13, 9216, v2
    v_add_u32 v13, v13, v12
    s_mul_i32 s26, s22, 9216
    s_mov_b32 s30, s86
    v_and_b32 v15, 31, v1
    v_lshrrev_b32 v6, 5, v1
    v_mul_u32_u24 v63, 1152, v15
    s_lshl_b32 s28, s84, 8
    s_lshl_b32 s27, s22, 6
    s_add_u32 s28, s28, s27
    v_add_u32 v63, s28, v63
    v_lshl_add_u32 v63, v6, 3, v63
    v_lshlrev_b32 v74, 3, v15
    v_lshl_add_u32 v74, v2, 8, v74
    v_lshrrev_b32 v7, 4, v15
    v_lshlrev_b32 v7, 10, v7
    v_and_b32 v8, 15, v15
    v_lshl_add_u32 v7, v8, 4, v7
    v_lshl_add_u32 v15, v6, 8, v7
    s_lshl_b32 s27, s84, 2
    s_add_u32 s27, s27, s22
    s_mov_b32 s42, s27
    s_lshl_b32 s27, s27, 11
    v_add_u32 v15, s27, v15
    s_mul_i32 s31, s86, 5
    s_add_u32 s31, s31, s84
    s_lshl_b32 s31, s31, 7
    s_add_u32 s31, s31, 73438464
    v_mov_b32 v6, 0x7fff0000
    s_cmp_ge_u32 s42, 18
    s_cbranch_scc0 w2_colok
    v_mov_b32 v15, v6
    v_mov_b32 v63, v6
w2_colok:
    v_min_u32 v75, 9, v1
    v_cmp_lt_u32 vcc, 4, v75
    s_nop 1
    v_cndmask_b32 v76, 0, 1, vcc
    v_lshlrev_b32 v75, 7, v75
    v_mul_u32_u24 v77, 40, v0
    s_lshl_b32 s28, s84, 3
    v_add_u32 v77, s28, v77
    v_cmp_gt_u32 vcc, 32, v0
    s_nop 1
    v_cndmask_b32 v77, v6, v77, vcc
    s_mov_b32 s36, -1
    s_cmp_eq_u32 s22, 1
    s_cselect_b32 s36, 1, s36
    s_cmp_eq_u32 s22, 2
    s_cselect_b32 s36, -2, s36
    s_cmp_eq_u32 s22, 3
    s_cselect_b32 s36, 2, s36
    v_and_b32 v58, 31, v1
    v_add_u32 v58, s36, v58
    v_lshrrev_b32 v59, 5, v1
    v_lshlrev_b32 v59, 4, v59
    v_mov_b32 v57, 192
    s_mov_b32 s90, 0
w2_wa:
    buffer_load_dword v56, v57, s[16:19], 0 offen sc1
    s_add_u32 s90, s90, 1
    s_cmp_gt_u32 s90, 65536
    s_cbranch_scc1 L_exit
    s_waitcnt vmcnt(0)
    v_readfirstlane_b32 s91, v56
    s_cmp_ge_u32 s91, 256
    s_cbranch_scc1 w2_wa_ok
    s_sleep 4
    s_branch w2_wa
w2_wa_ok:
w2_loop:
    s_add_u32 s37, s30, 1
    s_add_u32 s38, s30, 2
    s_cmp_ge_u32 s37, 64
    s_cselect_b32 s38, s30, s38
    s_and_b32 s39, s30, 1
    v_mov_b32 v78, s38
    v_mov_b32 v79, s37
    v_cmp_eq_u32 vcc, s39, v76
    s_nop 1
    v_cndmask_b32 v78, v78, v79, vcc
    s_mov_b32 s39, 73437184
    s_mov_b32 s90, 0
w2_pe:
    buffer_load_dword v79, v75, s[8:11], s39 offen sc1
    s_add_u32 s90, s90, 1
    s_cmp_gt_u32 s90, 65536
    s_cbranch_scc1 w2_timeout
    s_waitcnt vmcnt(0)
    v_cmp_gt_u32 vcc, v78, v79
    s_cbranch_vccz w2_pe_ok
    s_sleep 2
    s_branch w2_pe
w2_pe_ok:
    s_lshl_b32 s32, s30, 5
    v_add_u32 v60, s32, v58
    v_lshl_add_u32 v61, v60, 5, v59
    v_cmp_gt_u32 vcc, 0x800, v60
    v_mov_b32 v60, 0x7fff0000
    s_nop 0
    v_cndmask_b32 v61, v60, v61, vcc
    s_mul_i32 s32, s22, 589824
    s_add_u32 s32, s32, 118489088
    s_add_u32 m0, s26, 0
    s_nop 0
    buffer_load_dwordx4 v61, s[8:11], s32 offen sc1 lds
    s_add_u32 m0, s26, 1024
    s_add_u32 s32, s32, 65536
    buffer_load_dwordx4 v61, s[8:11], s32 offen sc1 lds
    s_add_u32 m0, s26, 2048
    s_add_u32 s32, s32, 65536
    buffer_load_dwordx4 v61, s[8:11], s32 offen sc1 lds
    s_add_u32 m0, s26, 3072
    s_add_u32 s32, s32, 65536
    buffer_load_dwordx4 v61, s[8:11], s32 offen sc1 lds
    s_add_u32 m0, s26, 4096
    s_add_u32 s32, s32, 65536
    buffer_load_dwordx4 v61, s[8:11], s32 offen sc1 lds
    s_add_u32 m0, s26, 5120
    s_add_u32 s32, s32, 65536
    buffer_load_dwordx4 v61, s[8:11], s32 offen sc1 lds
    s_add_u32 m0, s26, 6144
    s_add_u32 s32, s32, 65536
    buffer_load_dwordx4 v61, s[8:11], s32 offen sc1 lds
    s_add_u32 m0, s26, 7168
    s_add_u32 s32, s32, 65536
    buffer_load_dwordx4 v61, s[8:11], s32 offen sc1 lds
    s_add_u32 m0, s26, 8192
    s_add_u32 s32, s32, 65536
    buffer_load_dwordx4 v61, s[8:11], s32 offen sc1 lds
    s_mul_i32 s41, s30, 36864
    s_add_u32 s41, s41, 112197632
    buffer_load_dwordx2 v[64:65], v63, s[8:11], s41 offen offset:0 sc1
    buffer_load_dwordx2 v[66:67], v63, s[8:11], s41 offen offset:16 sc1
    buffer_load_dwordx2 v[68:69], v63, s[8:11], s41 offen offset:32 sc1
    buffer_load_dwordx2 v[70:71], v63, s[8:11], s41 offen offset:48 sc1
    s_waitcnt vmcnt(4)
    s_barrier
    ds_read_b128 v[16:19], v12 offset:0
    ds_read_b128 v[20:23], v12 offset:1024
    ds_read_b128 v[24:27], v12 offset:2048
    ds_read_b128 v[28:31], v12 offset:3072
    s_waitcnt lgkmcnt(3)
    v_mfma_f32_32x32x16_bf16 v[32:47], a[0:3], v[16:19], 0
    ds_read_b128 v[16:19], v12 offset:4096
    s_waitcnt lgkmcnt(3)
    v_mfma_f32_32x32x16_bf16 v[32:47], a[4:7], v[20:23], v[32:47]
    ds_read_b128 v[20:23], v12 offset:5120
    s_waitcnt lgkmcnt(3)
    v_mfma_f32_32x32x16_bf16 v[32:47], a[8:11], v[24:27], v[32:47]
    ds_read_b128 v[24:27], v12 offset:6144
    s_waitcnt lgkmcnt(3)
    v_mfma_f32_32x32x16_bf16 v[32:47], a[12:15], v[28:31], v[32:47]
    ds_read_b128 v[28:31], v12 offset:7168
    s_waitcnt lgkmcnt(3)
    v_mfma_f32_32x32x16_bf16 v[32:47], a[16:19], v[16:19], v[32:47]
    ds_read_b128 v[16:19], v12 offset:8192
    s_waitcnt lgkmcnt(3)
    v_mfma_f32_32x32x16_bf16 v[32:47], a[20:23], v[20:23], v[32:47]
    ds_read_b128 v[20:23], v12 offset:9216
    s_waitcnt lgkmcnt(3)
    v_mfma_f32_32x32x16_bf16 v[32:47], a[24:27], v[24:27], v[32:47]
    ds_read_b128 v[24:27], v12 offset:10240
    s_waitcnt lgkmcnt(3)
    v_mfma_f32_32x32x16_bf16 v[32:47], a[28:31], v[28:31], v[32:47]
    ds_read_b128 v[28:31], v12 offset:11264
    s_waitcnt lgkmcnt(3)
    v_mfma_f32_32x32x16_bf16 v[32:47], a[32:35], v[16:19], v[32:47]
    ds_read_b128 v[16:19], v12 offset:12288
    s_waitcnt lgkmcnt(3)
    v_mfma_f32_32x32x16_bf16 v[32:47], a[36:39], v[20:23], v[32:47]
    ds_read_b128 v[20:23], v12 offset:13312
    s_waitcnt lgkmcnt(3)
    v_mfma_f32_32x32x16_bf16 v[32:47], a[40:43], v[24:27], v[32:47]
    ds_read_b128 v[24:27], v12 offset:14336
    s_waitcnt lgkmcnt(3)
    v_mfma_f32_32x32x16_bf16 v[32:47], a[44:47], v[28:31], v[32:47]
    ds_read_b128 v[28:31], v12 offset:15360
    s_waitcnt lgkmcnt(3)
    v_mfma_f32_32x32x16_bf16 v[32:47], a[48:51], v[16:19], v[32:47]
    ds_read_b128 v[16:19], v12 offset:16384
    s_waitcnt lgkmcnt(3)
    v_mfma_f32_32x32x16_bf16 v[32:47], a[52:55], v[20:23], v[32:47]
    ds_read_b128 v[20:23], v12 offset:17408
    s_waitcnt lgkmcnt(3)
    v_mfma_f32_32x32x16_bf16 v[32:47], a[56:59], v[24:27], v[32:47]
    ds_read_b128 v[24:27], v12 offset:18432
    s_waitcnt lgkmcnt(3)
    v_mfma_f32_32x32x16_bf16 v[32:47], a[60:63], v[28:31], v[32:47]
    ds_read_b128 v[28:31], v12 offset:19456
    s_waitcnt lgkmcnt(3)
    v_mfma_f32_32x32x16_bf16 v[32:47], a[64:67], v[16:19], v[32:47]
    ds_read_b128 v[16:19], v12 offset:20480
    s_waitcnt lgkmcnt(3)
    v_mfma_f32_32x32x16_bf16 v[32:47], a[68:71], v[20:23], v[32:47]
    ds_read_b128 v[20:23], v12 offset:21504
    s_waitcnt lgkmcnt(3)
    v_mfma_f32_32x32x16_bf16 v[32:47], a[72:75], v[24:27], v[32:47]
    ds_read_b128 v[24:27], v12 offset:22528
    s_waitcnt lgkmcnt(3)
    v_mfma_f32_32x32x16_bf16 v[32:47], a[76:79], v[28:31], v[32:47]
    ds_read_b128 v[28:31], v12 offset:23552
    s_waitcnt lgkmcnt(3)
    v_mfma_f32_32x32x16_bf16 v[32:47], a[80:83], v[16:19], v[32:47]
    ds_read_b128 v[16:19], v12 offset:24576
    s_waitcnt lgkmcnt(3)
    v_mfma_f32_32x32x16_bf16 v[32:47], a[84:87], v[20:23], v[32:47]
    ds_read_b128 v[20:23], v12 offset:25600
    s_waitcnt lgkmcnt(3)
    v_mfma_f32_32x32x16_bf16 v[32:47], a[88:91], v[24:27], v[32:47]
    ds_read_b128 v[24:27], v12 offset:26624
    s_waitcnt lgkmcnt(3)
    v_mfma_f32_32x32x16_bf16 v[32:47], a[92:95], v[28:31], v[32:47]
    ds_read_b128 v[28:31], v12 offset:27648
    s_waitcnt lgkmcnt(3)
    v_mfma_f32_32x32x16_bf16 v[32:47], a[96:99], v[16:19], v[32:47]
    ds_read_b128 v[16:19], v12 offset:28672
    s_waitcnt lgkmcnt(3)
    v_mfma_f32_32x32x16_bf16 v[32:47], a[100:103], v[20:23], v[32:47]
    ds_read_b128 v[20:23], v12 offset:29696
    s_waitcnt lgkmcnt(3)
    v_mfma_f32_32x32x16_bf16 v[32:47], a[104:107], v[24:27], v[32:47]
    ds_read_b128 v[24:27], v12 offset:30720
    s_waitcnt lgkmcnt(3)
    v_mfma_f32_32x32x16_bf16 v[32:47], a[108:111], v[28:31], v[32:47]
    ds_read_b128 v[28:31], v12 offset:31744
    s_waitcnt lgkmcnt(3)
    v_mfma_f32_32x32x16_bf16 v[32:47], a[112:115], v[16:19], v[32:47]
    ds_read_b128 v[16:19], v12 offset:32768
    s_waitcnt lgkmcnt(3)
    v_mfma_f32_32x32x16_bf16 v[32:47], a[116:119], v[20:23], v[32:47]
    ds_read_b128 v[20:23], v12 offset:33792
    s_waitcnt lgkmcnt(3)
    v_mfma_f32_32x32x16_bf16 v[32:47], a[120:123], v[24:27], v[32:47]
    ds_read_b128 v[24:27], v12 offset:34816
    s_waitcnt lgkmcnt(3)
    v_mfma_f32_32x32x16_bf16 v[32:47], a[124:127], v[28:31], v[32:47]
    ds_read_b128 v[28:31], v12 offset:35840
    s_waitcnt lgkmcnt(3)
    v_mfma_f32_32x32x16_bf16 v[32:47], a[128:131], v[16:19], v[32:47]
    s_waitcnt lgkmcnt(2)
    v_mfma_f32_32x32x16_bf16 v[32:47], a[132:135], v[20:23], v[32:47]
    s_waitcnt lgkmcnt(1)
    v_mfma_f32_32x32x16_bf16 v[32:47], a[136:139], v[24:27], v[32:47]
    s_waitcnt lgkmcnt(0)
    v_mfma_f32_32x32x16_bf16 v[32:47], a[140:143], v[28:31], v[32:47]
    s_waitcnt vmcnt(0)
    v_lshlrev_b32 v72, 16, v64
    v_and_b32 v73, 0xffff0000, v64
    s_nop 8
    v_add_f32 v32, v32, v72
    v_add_f32 v33, v33, v73
    v_lshlrev_b32 v72, 16, v65
    v_and_b32 v73, 0xffff0000, v65
    v_add_f32 v34, v34, v72
    v_add_f32 v35, v35, v73
    v_lshlrev_b32 v72, 16, v66
    v_and_b32 v73, 0xffff0000, v66
    v_add_f32 v36, v36, v72
    v_add_f32 v37, v37, v73
    v_lshlrev_b32 v72, 16, v67
    v_and_b32 v73, 0xffff0000, v67
    v_add_f32 v38, v38, v72
    v_add_f32 v39, v39, v73
    v_lshlrev_b32 v72, 16, v68
    v_and_b32 v73, 0xffff0000, v68
    v_add_f32 v40, v40, v72
    v_add_f32 v41, v41, v73
    v_lshlrev_b32 v72, 16, v69
    v_and_b32 v73, 0xffff0000, v69
    v_add_f32 v42, v42, v72
    v_add_f32 v43, v43, v73
    v_lshlrev_b32 v72, 16, v70
    v_and_b32 v73, 0xffff0000, v70
    v_add_f32 v44, v44, v72
    v_add_f32 v45, v45, v73
    v_lshlrev_b32 v72, 16, v71
    v_and_b32 v73, 0xffff0000, v71
    v_add_f32 v46, v46, v72
    v_add_f32 v47, v47, v73
    v_cvt_pk_bf16_f32 v48, v32, v33
    v_cvt_pk_bf16_f32 v49, v34, v35
    v_cvt_pk_bf16_f32 v50, v36, v37
    v_cvt_pk_bf16_f32 v51, v38, v39
    v_cvt_pk_bf16_f32 v52, v40, v41
    v_cvt_pk_bf16_f32 v53, v42, v43
    v_cvt_pk_bf16_f32 v54, v44, v45
    v_cvt_pk_bf16_f32 v55, v46, v47
    v_permlane32_swap_b32 v48, v50
    v_permlane32_swap_b32 v49, v51
    v_permlane32_swap_b32 v52, v54
    v_permlane32_swap_b32 v53, v55
    s_mul_i32 s28, s30, 36864
    s_add_u32 s28, s28, 124780544
    buffer_store_dwordx4 v[48:51], v15, s[8:11], s28 offen sc1
    buffer_store_dwordx4 v[52:55], v15, s[8:11], s28 offen offset:512 sc1
    v_mov_b64 v[72:73], 0
    v_lshlrev_b32 v32, 16, v48
    v_and_b32 v33, 0xffff0000, v48
    v_add_f32 v72, v72, v32
    v_fmac_f32 v73, v32, v32
    v_add_f32 v72, v72, v33
    v_fmac_f32 v73, v33, v33
    v_lshlrev_b32 v32, 16, v49
    v_and_b32 v33, 0xffff0000, v49
    v_add_f32 v72, v72, v32
    v_fmac_f32 v73, v32, v32
    v_add_f32 v72, v72, v33
    v_fmac_f32 v73, v33, v33
    v_lshlrev_b32 v32, 16, v50
    v_and_b32 v33, 0xffff0000, v50
    v_add_f32 v72, v72, v32
    v_fmac_f32 v73, v32, v32
    v_add_f32 v72, v72, v33
    v_fmac_f32 v73, v33, v33
    v_lshlrev_b32 v32, 16, v51
    v_and_b32 v33, 0xffff0000, v51
    v_add_f32 v72, v72, v32
    v_fmac_f32 v73, v32, v32
    v_add_f32 v72, v72, v33
    v_fmac_f32 v73, v33, v33
    v_lshlrev_b32 v32, 16, v52
    v_and_b32 v33, 0xffff0000, v52
    v_add_f32 v72, v72, v32
    v_fmac_f32 v73, v32, v32
    v_add_f32 v72, v72, v33
    v_fmac_f32 v73, v33, v33
    v_lshlrev_b32 v32, 16, v53
    v_and_b32 v33, 0xffff0000, v53
    v_add_f32 v72, v72, v32
    v_fmac_f32 v73, v32, v32
    v_add_f32 v72, v72, v33
    v_fmac_f32 v73, v33, v33
    v_lshlrev_b32 v32, 16, v54
    v_and_b32 v33, 0xffff0000, v54
    v_add_f32 v72, v72, v32
    v_fmac_f32 v73, v32, v32
    v_add_f32 v72, v72, v33
    v_fmac_f32 v73, v33, v33
    v_lshlrev_b32 v32, 16, v55
    v_and_b32 v33, 0xffff0000, v55
    v_add_f32 v72, v72, v32
    v_fmac_f32 v73, v32, v32
    v_add_f32 v72, v72, v33
    v_fmac_f32 v73, v33, v33
    s_cmp_ge_u32 s42, 18
    s_cbranch_scc0 w2_stok
    v_mov_b64 v[72:73], 0
w2_stok:
    v_mov_b64 v[34:35], v[72:73]
    s_nop 1
    v_permlane32_swap_b32 v72, v34
    v_permlane32_swap_b32 v73, v35
    v_pk_add_f32 v[72:73], v[72:73], v[34:35]
    ds_write_b64 v74, v[72:73] offset:36864
    s_waitcnt lgkmcnt(0)
    s_barrier
    v_lshlrev_b32 v32, 3, v1
    ds_read_b64 v[34:35], v32 offset:36864
    ds_read_b64 v[36:37], v32 offset:37120
    ds_read_b64 v[38:39], v32 offset:37376
    ds_read_b64 v[40:41], v32 offset:37632
    s_waitcnt lgkmcnt(0)
    v_pk_add_f32 v[34:35], v[34:35], v[36:37]
    v_pk_add_f32 v[38:39], v[38:39], v[40:41]
    v_pk_add_f32 v[34:35], v[34:35], v[38:39]
    s_mul_i32 s28, s30, 1280
    s_add_u32 s28, s28, 127926272
    buffer_store_dwordx2 v[34:35], v77, s[8:11], s28 offen sc1
    s_waitcnt vmcnt(0)
    s_barrier
    s_cmp_eq_u32 s22, 0
    s_cbranch_scc0 w2_nopub
    s_add_u32 s34, s30, 1
    v_mov_b32 v56, s34
    v_mov_b32 v57, 0
    s_mov_b64 exec, 1
    buffer_store_dword v56, v57, s[8:11], s31 offen sc1
    s_mov_b64 exec, -1
w2_nopub:
    s_add_u32 s30, s30, 2
    s_cmp_lt_u32 s30, 64
    s_cbranch_scc1 w2_loop
w2_timeout:
    s_branch L_exit
L_idle:
    s_waitcnt vmcnt(0)
    s_barrier
    v_cmp_eq_u32 vcc, 0, v0
    s_and_saveexec_b64 s[20:21], vcc
    s_cbranch_execz idle_arr
    v_mov_b32 v1, 1
    v_mov_b32 v2, 192
    buffer_atomic_add v1, v2, s[16:19], 0 offen
idle_arr:
    s_mov_b64 exec, s[20:21]
L_exit:
    s_endpgm
.section .rodata,"a"
.p2align 6
.amdhsa_kernel sequential_preLN__memory_aug_recurrent_mem_tr__mixer_s_mlp__prompt_kernel
  .amdhsa_next_free_vgpr 512
  .amdhsa_next_free_sgpr 102
  .amdhsa_accum_offset 256
  .amdhsa_group_segment_fixed_size 0
  .amdhsa_kernarg_size 120
  .amdhsa_user_sgpr_count 2
  .amdhsa_user_sgpr_kernarg_segment_ptr 1
  .amdhsa_system_sgpr_workgroup_id_x 1
.end_amdhsa_kernel
.text
```
